```python
import torch

def _softmax(x, axis=-1):
    return torch.softmax(x, dim=axis)

def _gelu(x):
    return torch.nn.functional.gelu(x, approximate='tanh')

def _silu(x):
    return torch.nn.functional.silu(x)

def _sigmoid(x):
    return torch.sigmoid(x)

def _layernorm(x, axis=-1, eps=1e-05):
    m = x.mean(dim=axis, keepdim=True)
    v = x.var(dim=axis, keepdim=True, unbiased=False)
    return (x - m) / torch.sqrt(v + eps)

def _scatter_add(tgt, idx, src, axis=0):
    return tgt.clone().index_add_(axis, idx, src)

def _segment_sum(src, seg, n):
    out = torch.zeros((n,) + src.shape[1:], dtype=src.dtype)
    return out.index_add_(0, seg, src)

def _pad(x, pw):
    flat = tuple((v for pair in reversed(pw) for v in pair))
    return torch.nn.functional.pad(x, flat)
kernel_name = 'adaLN_cond__mha_block_cached__swiglu_ffn__decode'

def setup_inputs():

    _w = lambda a: (lambda t: t.to(torch.bfloat16) if t.is_floating_point() else t)(torch.as_tensor(a))

    def _A_setup():
        B, Sq, D = (1, 1, 640)
        H, Sk, Dh = (32, 32768, 192)
        return {'x': _w((lambda *s: torch.randn(*s, dtype=torch.bfloat16) * 0.1)(B, Sq, D)), 'k_cache': _w((lambda *s: torch.randn(*s, dtype=torch.bfloat16) * 0.8)(B, H, Sk, Dh)), 'v_cache': _w((lambda *s: torch.randn(*s, dtype=torch.bfloat16) * 0.8)(B, H, Sk, Dh)), 'wq': _w((lambda *s: torch.randn(*s, dtype=torch.bfloat16) * 0.8)(D, H * Dh) * D ** (-0.5)), 'wo': _w((lambda *s: torch.randn(*s, dtype=torch.bfloat16) * 0.8)(H * Dh, D) * (H * Dh) ** (-0.5))}
    _A_in = _A_setup()

    def _B_setup():
        B, S, D, F = (1, 1, 640, 1536)
        return {'x': _w((lambda *s: torch.randn(*s, dtype=torch.bfloat16) * 0.1)(B, S, D)), 'w_gate': _w((lambda *s: torch.randn(*s, dtype=torch.bfloat16) * 0.1)(D, F)), 'w_up': _w((lambda *s: torch.randn(*s, dtype=torch.bfloat16) * 0.1)(D, F)), 'w_down': _w((lambda *s: torch.randn(*s, dtype=torch.bfloat16) * 0.1)(F, D))}
    _B_in = _B_setup()
    return {'A_x': _A_in['x'], 'A_k_cache': _A_in['k_cache'], 'A_v_cache': _A_in['v_cache'], 'A_wq': _A_in['wq'], 'A_wo': _A_in['wo'], 'B_x': _B_in['x'], 'B_w_gate': _B_in['w_gate'], 'B_w_up': _B_in['w_up'], 'B_w_down': _B_in['w_down'], 'c': _w((lambda *s: torch.randn(*s, dtype=torch.bfloat16) * 0.8)(1, 640) * 8.0), 'w_mod': _w((lambda *s: torch.randn(*s, dtype=torch.bfloat16) * 0.8)(640, 6 * 640) * 640 ** (-0.5) * 8.0)}

def reference(A_x, A_k_cache, A_v_cache, A_wq, A_wo, B_x, B_w_gate, B_w_up, B_w_down, c, w_mod):

    def _A_ref(x, k_cache, v_cache, wq, wo):
        B, Sq, D = x.shape
        H, Dh = (32, 192)
        q = (lambda x, *d: x.permute(*d))((x @ wq).reshape(B, Sq, H, Dh), 0, 2, 1, 3)
        scores = torch.einsum('bhqd,bhkd->bhqk', q, k_cache) * Dh ** (-0.5)
        p = _softmax(scores, axis=-1)
        o = torch.einsum('bhqk,bhkd->bhqd', p, v_cache)
        return (lambda x, *d: x.permute(*d))(o, 0, 2, 1, 3).reshape(B, Sq, H * Dh) @ wo

    def _B_ref(x, w_gate, w_up, w_down):
        g = _silu(x @ w_gate)
        u = x @ w_up
        return g * u @ w_down
    x = A_x
    mod = (_silu(c) @ w_mod).reshape(c.shape[0], 6, 1, -1)
    sa, ca, ga, sb, cb, gb = (mod[:, 0].clone(), mod[:, 1].clone(), mod[:, 2].clone(), mod[:, 3].clone(), mod[:, 4].clone(), mod[:, 5].clone())
    h = _layernorm(x, axis=-1) * (1 + ca) + sa
    x = x + ga * _A_ref(h, A_k_cache, A_v_cache, A_wq, A_wo)
    h = _layernorm(x, axis=-1) * (1 + cb) + sb
    x = x + gb * _B_ref(h, B_w_gate, B_w_up, B_w_down)
    return x
```

```asm
; @launch grid=(256,1,1) block=(512,1,1) lds=147456
.amdgcn_target "amdgcn-amd-amdhsa--gfx950"
.text
.globl adaLN_cond__mha_block_cached__swiglu_ffn__decode_kernel
.p2align 8
.type adaLN_cond__mha_block_cached__swiglu_ffn__decode_kernel,@function
adaLN_cond__mha_block_cached__swiglu_ffn__decode_kernel:
    s_cmp_ge_u32 s2, 256
    s_cbranch_scc1 L_exit
    s_load_dwordx16 s[16:31], s[0:1], 0
    s_load_dwordx8 s[32:39], s[0:1], 64
    s_load_dwordx4 s[40:43], s[0:1], 96
    s_getpc_b64 s[6:7]
L_pcbase:
    s_lshr_b32 s8, s2, 3
    s_lshl_b32 s8, s8, 11
    v_lshl_add_u32 v3, v0, 4, s8
    v_min_u32 v3, L_code_end-L_pcbase-16, v3
    v_cmp_gt_u32 vcc, 0x80, v0
    s_and_saveexec_b64 s[4:5], vcc
    s_cbranch_execz L_m_1
    global_load_dwordx4 v[252:255], v3, s[6:7]
L_m_1:
    s_mov_b64 exec, s[4:5]
    v_lshrrev_b32 v3, 6, v0
    v_and_b32 v1, 63, v0
    v_readfirstlane_b32 s3, v3
    s_and_b32 s44, s2, 7
    s_lshr_b32 s45, s2, 3
    s_lshr_b32 s97, s44, 1
    s_lshl_b32 s46, s97, 3
    s_lshr_b32 s98, s45, 2
    s_add_u32 s46, s46, s98
    s_and_b32 s47, s45, 3
    s_lshl_b32 s47, s47, 1
    s_and_b32 s97, s44, 1
    s_add_u32 s47, s47, s97
    s_lshl_b32 s96, s46, 3
    s_add_u32 s96, s96, s47
    s_lshr_b32 s6, s44, 1
    s_and_b32 s7, s44, 1
    s_lshr_b32 s8, s45, 2
    s_and_b32 s9, s45, 3
    s_mov_b32 s100, s8
    s_mov_b32 s94, 0
    s_mov_b32 s95, 0
    s_cmp_eq_u32 s7, 1
    s_cbranch_scc1 L_r_6
    s_mov_b32 s97, s8
    s_cmp_eq_u32 s9, 0
    s_cbranch_scc1 L_r_5
    s_cmp_eq_u32 s9, 3
    s_cbranch_scc1 L_r_4
    s_lshl_b32 s97, s8, 1
    s_add_u32 s97, s97, s9
    s_sub_u32 s97, s97, 1
    s_branch L_r_3
L_r_6:
    s_cmp_lg_u32 s9, 0
    s_cbranch_scc0 L_r_6a
    s_mul_i32 s97, s8, 3
    s_add_u32 s97, s97, s9
    s_add_u32 s97, s97, 15
    s_branch L_r_3
L_r_6a:
    s_lshr_b32 s97, s8, 1
    s_add_u32 s97, s97, 8
    s_and_b32 s98, s8, 1
    s_cbranch_scc1 L_r_4
L_r_5:
    s_mov_b32 s92, 0
    s_mul_i32 s93, s6, 12
    s_add_u32 s93, s93, s97
    s_branch L_r_2
L_r_3:
    s_mov_b32 s92, 1
    s_mul_i32 s93, s6, 40
    s_add_u32 s93, s93, s97
    s_mul_i32 s94, s93, 205
    s_lshr_b32 s94, s94, 11
    s_mul_i32 s97, s94, 10
    s_sub_u32 s95, s93, s97
    s_branch L_r_2
L_r_4:
    s_lshl_b32 s93, s97, 2
    s_add_u32 s93, s93, s6
    s_mov_b32 s92, 3
    s_cmp_ge_u32 s93, 10
    s_cbranch_scc1 L_r_2
    s_mov_b32 s92, 2
L_r_2:
    s_and_b32 s97, s100, 1
    s_mov_b32 s6, 0x8b7a7a47
    s_cselect_b32 s6, 0x7a7a7986, s6
    s_lshl_b32 s97, s47, 2
    s_lshr_b32 s6, s6, s97
    s_and_b32 s6, s6, 15
    s_add_u32 s62, s6, 56
    s_and_b32 s97, s100, 1
    s_mov_b32 s6, 0x150b0700
    s_mov_b32 s7, 0x382d261c
    s_cselect_b32 s6, 0x170e0600, s6
    s_cselect_b32 s7, 0x392f281e, s7
    s_lshl_b32 s97, s47, 3
    s_lshr_b64 s[6:7], s[6:7], s97
    s_and_b32 s6, s6, 255
    s_mul_i32 s97, s47, 56
    s_add_u32 s100, s6, s97
    s_mov_b32 s12, s100
    s_mul_i32 s97, s2, 1093
    s_lshr_b32 s14, s97, 16
    s_mul_i32 s97, s14, 60
    s_sub_u32 s15, s2, s97
    v_and_b32 v3, 7, v1
    v_cmp_eq_u32 s[64:65], 0, v3
    v_cmp_eq_u32 s[66:67], 1, v3
    v_cmp_eq_u32 s[68:69], 2, v3
    v_cmp_eq_u32 s[70:71], 3, v3
    v_cmp_eq_u32 s[72:73], 4, v3
    v_cmp_eq_u32 s[74:75], 5, v3
    v_cmp_eq_u32 s[76:77], 6, v3
    v_cmp_eq_u32 s[78:79], 7, v3
    v_lshrrev_b32 v4, 3, v1
    v_mul_u32_u24 v4, 384, v4
    v_lshl_add_u32 v2, v3, 4, v4
    s_waitcnt lgkmcnt(0)
    s_lshl_b32 s97, s46, 9
    s_add_u32 s97, s97, s12
    s_mul_i32 s98, s97, 24576
    s_mul_hi_u32 s99, s97, 24576
    s_add_u32 s48, s18, s98
    s_addc_u32 s49, s19, s99
    s_mov_b32 s50, 0
    s_mov_b32 s51, 0x20000
    s_add_u32 s52, s20, s98
    s_addc_u32 s53, s21, s99
    s_mov_b32 s54, 0
    s_mov_b32 s55, 0x20000
    s_add_u32 s56, s20, s98
    s_addc_u32 s57, s21, s99
    s_mov_b32 s58, 0
    s_mov_b32 s59, 0x20000
    s_mul_i32 s50, s62, 24576
    s_mov_b32 s54, s50
    s_mul_i32 s61, s3, 3072
    s_cmp_eq_u32 s3, 0
    s_cbranch_scc1 L_vw_7
    s_mov_b32 s58, s50
L_vw_7:
    s_mov_b32 s60, s61
    v_lshrrev_b32 v3, 3, v1
    v_and_b32 v4, 7, v1
    s_mov_b32 s80, s34
    s_mov_b32 s81, s35
    s_mov_b32 s82, 1280
    s_mov_b32 s83, 0x20000
    s_mov_b32 s84, s36
    s_mov_b32 s85, s37
    s_mov_b32 s86, 4915200
    s_mov_b32 s87, 0x20000
    s_cmp_lt_u32 s2, 240
    s_cbranch_scc1 L_nm_8
    s_mov_b32 s86, 0
L_nm_8:
    s_mul_i32 s97, s14, 160
    s_lshl_b32 s98, s3, 3
    s_add_u32 s97, s97, s98
    v_add_u32 v5, s97, v3
    v_lshlrev_b32 v6, 1, v5
    v_mul_u32_u24 v7, 7680, v5
    v_lshl_add_u32 v7, v4, 4, v7
    s_lshl_b32 s97, s15, 7
    buffer_load_ushort v52, v6, s[80:83], 0 offen offset:0
    buffer_load_dwordx4 v[16:19], v7, s[84:87], s97 offen nt
    s_add_u32 s97, s97, 491520
    buffer_load_ushort v53, v6, s[80:83], 0 offen offset:128
    buffer_load_dwordx4 v[20:23], v7, s[84:87], s97 offen nt
    s_add_u32 s97, s97, 491520
    s_cmp_lt_u32 s3, 4
    s_cbranch_scc1 L_nm_9
    v_mov_b32 v7, 0x7ffffff0
    v_mov_b32 v6, 0x7ffffff0
L_nm_9:
    buffer_load_ushort v54, v6, s[80:83], 0 offen offset:256
    buffer_load_dwordx4 v[24:27], v7, s[84:87], s97 offen nt
    s_mov_b32 s88, s22
    s_mov_b32 s89, s23
    s_mov_b32 s90, 7864320
    s_mov_b32 s91, 0x20000
    s_mul_i32 s97, s47, 80
    s_lshl_b32 s98, s3, 3
    s_add_u32 s97, s97, s98
    v_add_u32 v5, s97, v3
    v_mul_u32_u24 v7, 12288, v5
    v_lshl_add_u32 v7, v4, 4, v7
    s_mul_i32 s97, s46, 384
    buffer_load_dwordx4 v[28:31], v7, s[88:91], s97 offen offset:0 nt
    buffer_load_dwordx4 v[32:35], v7, s[88:91], s97 offen offset:128 nt
    buffer_load_dwordx4 v[36:39], v7, s[88:91], s97 offen offset:256 nt
    s_cmp_lt_u32 s3, 2
    s_cbranch_scc1 L_nm_10
    v_mov_b32 v7, 0x7ffffff0
L_nm_10:
    s_add_u32 s97, s97, 786432
    buffer_load_dwordx4 v[40:43], v7, s[88:91], s97 offen offset:0 nt
    buffer_load_dwordx4 v[44:47], v7, s[88:91], s97 offen offset:128 nt
    buffer_load_dwordx4 v[48:51], v7, s[88:91], s97 offen offset:256 nt
    s_cmp_lg_u32 s3, 0
    s_cbranch_scc1 L_nw0_11
    v_mov_b32 v3, 688128
    global_load_dword v99, v3, s[42:43] sc1
    v_add_u32 v3, 0, v1
    v_min_u32 v3, 159, v3
    v_lshlrev_b32 v3, 3, v3
    global_load_dwordx2 v[64:65], v3, s[16:17]
    v_add_u32 v3, 64, v1
    v_min_u32 v3, 159, v3
    v_lshlrev_b32 v3, 3, v3
    global_load_dwordx2 v[66:67], v3, s[16:17]
    v_add_u32 v3, 128, v1
    v_min_u32 v3, 159, v3
    v_lshlrev_b32 v3, 3, v3
    global_load_dwordx2 v[68:69], v3, s[16:17]
    v_mov_b32 v8, -1
    v_mov_b32 v9, -1
    v_mov_b32 v10, -1
    v_mov_b32 v11, -1
    v_lshlrev_b32 v4, 4, v1
    s_mul_i32 s97, s96, 768
    s_add_u32 s98, s97, 65536
    s_add_u32 s99, s97, 475136
    v_add_u32 v5, s98, v4
    v_add_u32 v7, s99, v4
    s_lshl_b32 s98, s96, 6
    s_add_u32 s98, s98, 32000
    v_add_u32 v6, s98, v4
    v_cmp_le_u32 vcc, 48, v1
    s_nop 1
    v_cndmask_b32 v5, v5, v6, vcc
    v_cmp_gt_u32 vcc, 52, v1
    s_and_saveexec_b64 s[4:5], vcc
    s_cbranch_execz L_m_12
    global_store_dwordx4 v5, v[8:11], s[42:43] sc1
L_m_12:
    s_mov_b64 exec, s[4:5]
    s_min_u32 s98, s2, 39
    s_lshl_b32 s98, s98, 8
    s_add_u32 s98, s98, 4352
    v_add_u32 v6, s98, v4
    v_cmp_le_u32 vcc, 48, v1
    s_nop 1
    v_cndmask_b32 v7, v7, v6, vcc
    v_cmp_gt_u32 vcc, 48, v1
    s_cmp_ge_u32 s2, 40
    s_cbranch_scc1 L_nm_13
    s_mov_b64 vcc, -1
L_nm_13:
    s_and_saveexec_b64 s[4:5], vcc
    s_cbranch_execz L_m_14
    global_store_dwordx4 v7, v[8:11], s[42:43] sc1
L_m_14:
    s_mov_b64 exec, s[4:5]
    s_mul_i32 s97, s14, 15360
    s_lshl_b32 s98, s15, 8
    s_add_u32 s97, s97, s98
    s_add_u32 s97, s97, 409600
    v_add_u32 v5, s97, v4
    s_mul_i32 s97, s94, 2560
    s_lshl_b32 s98, s95, 8
    s_add_u32 s97, s97, s98
    s_add_u32 s97, s97, 327424
    v_add_u32 v6, s97, v4
    v_cmp_le_u32 vcc, 16, v1
    s_nop 1
    v_cndmask_b32 v5, v5, v6, vcc
    v_cmp_gt_u32 vcc, 16, v1
    s_cmp_lg_u32 s92, 1
    s_cbranch_scc1 L_nm_15
    v_cmp_gt_u32 vcc, 32, v1
L_nm_15:
    s_and_saveexec_b64 s[4:5], vcc
    s_cbranch_execz L_m_16
    global_store_dwordx4 v5, v[8:11], s[42:43] sc1
L_m_16:
    s_mov_b64 exec, s[4:5]
    s_cmp_lg_u32 s92, 0
    s_cbranch_scc1 L_nm_17
    s_mul_i32 s97, s93, 2560
    s_add_u32 s97, s97, 720896
    v_add_u32 v5, s97, v4
    global_store_dwordx4 v5, v[8:11], s[42:43] sc1
    global_store_dwordx4 v5, v[8:11], s[42:43] offset:1024 sc1
    v_cmp_gt_u32 vcc, 32, v1
    s_and_saveexec_b64 s[4:5], vcc
    s_cbranch_execz L_m_18
    global_store_dwordx4 v5, v[8:11], s[42:43] offset:2048 sc1
L_m_18:
    s_mov_b64 exec, s[4:5]
L_nm_17:
    s_waitcnt vmcnt(3)
    v_lshlrev_b32 v70, 16, v64
    v_and_b32 v71, 0xffff0000, v64
    v_lshlrev_b32 v72, 16, v65
    v_and_b32 v73, 0xffff0000, v65
    v_lshlrev_b32 v74, 16, v66
    v_and_b32 v75, 0xffff0000, v66
    v_lshlrev_b32 v76, 16, v67
    v_and_b32 v77, 0xffff0000, v67
    v_lshlrev_b32 v78, 16, v68
    v_and_b32 v79, 0xffff0000, v68
    v_lshlrev_b32 v80, 16, v69
    v_and_b32 v81, 0xffff0000, v69
    v_cmp_gt_u32 s[6:7], 32, v1
    v_mov_b32 v90, 0
    s_nop 0
    v_cndmask_b32 v82, v90, v78, s[6:7]
    v_cndmask_b32 v83, v90, v79, s[6:7]
    v_cndmask_b32 v84, v90, v80, s[6:7]
    v_cndmask_b32 v85, v90, v81, s[6:7]
    v_add_f32 v90, v70, v71
    v_add_f32 v90, v90, v72
    v_add_f32 v90, v90, v73
    v_add_f32 v90, v90, v74
    v_add_f32 v90, v90, v75
    v_add_f32 v90, v90, v76
    v_add_f32 v90, v90, v77
    v_add_f32 v90, v90, v82
    v_add_f32 v90, v90, v83
    v_add_f32 v90, v90, v84
    v_add_f32 v90, v90, v85
    s_nop 1
    v_add_f32_dpp v90, v90, v90 quad_perm:[1,0,3,2] row_mask:0xf bank_mask:0xf
    s_nop 1
    v_add_f32_dpp v90, v90, v90 quad_perm:[2,3,0,1] row_mask:0xf bank_mask:0xf
    s_nop 1
    v_add_f32_dpp v90, v90, v90 row_half_mirror row_mask:0xf bank_mask:0xf
    s_nop 1
    v_add_f32_dpp v90, v90, v90 row_mirror row_mask:0xf bank_mask:0xf
    v_mov_b32 v92, v90
    s_nop 1
    v_permlane16_swap_b32 v90, v92
    s_nop 1
    v_add_f32 v90, v90, v92
    v_mov_b32 v92, v90
    s_nop 1
    v_permlane32_swap_b32 v90, v92
    s_nop 1
    v_add_f32 v90, v90, v92
    v_mul_f32 v90, 0x3acccccd, v90
    v_mov_b32 v91, 0
    v_mov_b32 v95, 0
    v_sub_f32 v93, v70, v90
    v_fmac_f32 v91, v93, v93
    v_sub_f32 v93, v71, v90
    v_fmac_f32 v91, v93, v93
    v_sub_f32 v93, v72, v90
    v_fmac_f32 v91, v93, v93
    v_sub_f32 v93, v73, v90
    v_fmac_f32 v91, v93, v93
    v_sub_f32 v93, v74, v90
    v_fmac_f32 v91, v93, v93
    v_sub_f32 v93, v75, v90
    v_fmac_f32 v91, v93, v93
    v_sub_f32 v93, v76, v90
    v_fmac_f32 v91, v93, v93
    v_sub_f32 v93, v77, v90
    v_fmac_f32 v91, v93, v93
    v_sub_f32 v93, v82, v90
    v_mul_f32 v94, v93, v93
    v_cndmask_b32 v94, v95, v94, s[6:7]
    v_add_f32 v91, v91, v94
    v_sub_f32 v93, v83, v90
    v_mul_f32 v94, v93, v93
    v_cndmask_b32 v94, v95, v94, s[6:7]
    v_add_f32 v91, v91, v94
    v_sub_f32 v93, v84, v90
    v_mul_f32 v94, v93, v93
    v_cndmask_b32 v94, v95, v94, s[6:7]
    v_add_f32 v91, v91, v94
    v_sub_f32 v93, v85, v90
    v_mul_f32 v94, v93, v93
    v_cndmask_b32 v94, v95, v94, s[6:7]
    v_add_f32 v91, v91, v94
    s_nop 1
    v_add_f32_dpp v91, v91, v91 quad_perm:[1,0,3,2] row_mask:0xf bank_mask:0xf
    s_nop 1
    v_add_f32_dpp v91, v91, v91 quad_perm:[2,3,0,1] row_mask:0xf bank_mask:0xf
    s_nop 1
    v_add_f32_dpp v91, v91, v91 row_half_mirror row_mask:0xf bank_mask:0xf
    s_nop 1
    v_add_f32_dpp v91, v91, v91 row_mirror row_mask:0xf bank_mask:0xf
    v_mov_b32 v92, v91
    s_nop 1
    v_permlane16_swap_b32 v91, v92
    s_nop 1
    v_add_f32 v91, v91, v92
    v_mov_b32 v92, v91
    s_nop 1
    v_permlane32_swap_b32 v91, v92
    s_nop 1
    v_add_f32 v91, v91, v92
    v_mul_f32 v91, 0x3acccccd, v91
    v_cvt_pk_bf16_f32 v90, v90, v90
    v_and_b32 v90, 0xffff0000, v90
    v_cvt_pk_bf16_f32 v91, v91, v91
    v_and_b32 v91, 0xffff0000, v91
    v_add_f32 v91, 0x3727c5ac, v91
    v_cvt_pk_bf16_f32 v91, v91, v91
    v_and_b32 v91, 0xffff0000, v91
    v_sqrt_f32 v92, v91
    s_nop 0
    v_rcp_f32 v93, v92
    v_fma_f32 v94, -v92, v92, v91
    v_mul_f32 v93, 0.5, v93
    v_fma_f32 v91, v94, v93, v92
    v_cvt_pk_bf16_f32 v91, v91, v91
    v_and_b32 v91, 0xffff0000, v91
    v_sub_f32 v70, v70, v90
    v_cvt_pk_bf16_f32 v70, v70, v70
    v_and_b32 v70, 0xffff0000, v70
    v_rcp_f32 v93, v91
    s_nop 0
    v_mul_f32 v94, v70, v93
    v_fma_f32 v92, -v94, v91, v70
    v_fma_f32 v92, v92, v93, v94
    v_cvt_pk_bf16_f32 v70, v92, v92
    v_and_b32 v70, 0xffff0000, v70
    v_sub_f32 v71, v71, v90
    v_cvt_pk_bf16_f32 v71, v71, v71
    v_and_b32 v71, 0xffff0000, v71
    v_rcp_f32 v93, v91
    s_nop 0
    v_mul_f32 v94, v71, v93
    v_fma_f32 v92, -v94, v91, v71
    v_fma_f32 v92, v92, v93, v94
    v_cvt_pk_bf16_f32 v71, v92, v92
    v_and_b32 v71, 0xffff0000, v71
    v_sub_f32 v72, v72, v90
    v_cvt_pk_bf16_f32 v72, v72, v72
    v_and_b32 v72, 0xffff0000, v72
    v_rcp_f32 v93, v91
    s_nop 0
    v_mul_f32 v94, v72, v93
    v_fma_f32 v92, -v94, v91, v72
    v_fma_f32 v92, v92, v93, v94
    v_cvt_pk_bf16_f32 v72, v92, v92
    v_and_b32 v72, 0xffff0000, v72
    v_sub_f32 v73, v73, v90
    v_cvt_pk_bf16_f32 v73, v73, v73
    v_and_b32 v73, 0xffff0000, v73
    v_rcp_f32 v93, v91
    s_nop 0
    v_mul_f32 v94, v73, v93
    v_fma_f32 v92, -v94, v91, v73
    v_fma_f32 v92, v92, v93, v94
    v_cvt_pk_bf16_f32 v73, v92, v92
    v_and_b32 v73, 0xffff0000, v73
    v_sub_f32 v74, v74, v90
    v_cvt_pk_bf16_f32 v74, v74, v74
    v_and_b32 v74, 0xffff0000, v74
    v_rcp_f32 v93, v91
    s_nop 0
    v_mul_f32 v94, v74, v93
    v_fma_f32 v92, -v94, v91, v74
    v_fma_f32 v92, v92, v93, v94
    v_cvt_pk_bf16_f32 v74, v92, v92
    v_and_b32 v74, 0xffff0000, v74
    v_sub_f32 v75, v75, v90
    v_cvt_pk_bf16_f32 v75, v75, v75
    v_and_b32 v75, 0xffff0000, v75
    v_rcp_f32 v93, v91
    s_nop 0
    v_mul_f32 v94, v75, v93
    v_fma_f32 v92, -v94, v91, v75
    v_fma_f32 v92, v92, v93, v94
    v_cvt_pk_bf16_f32 v75, v92, v92
    v_and_b32 v75, 0xffff0000, v75
    v_sub_f32 v76, v76, v90
    v_cvt_pk_bf16_f32 v76, v76, v76
    v_and_b32 v76, 0xffff0000, v76
    v_rcp_f32 v93, v91
    s_nop 0
    v_mul_f32 v94, v76, v93
    v_fma_f32 v92, -v94, v91, v76
    v_fma_f32 v92, v92, v93, v94
    v_cvt_pk_bf16_f32 v76, v92, v92
    v_and_b32 v76, 0xffff0000, v76
    v_sub_f32 v77, v77, v90
    v_cvt_pk_bf16_f32 v77, v77, v77
    v_and_b32 v77, 0xffff0000, v77
    v_rcp_f32 v93, v91
    s_nop 0
    v_mul_f32 v94, v77, v93
    v_fma_f32 v92, -v94, v91, v77
    v_fma_f32 v92, v92, v93, v94
    v_cvt_pk_bf16_f32 v77, v92, v92
    v_and_b32 v77, 0xffff0000, v77
    v_sub_f32 v78, v78, v90
    v_cvt_pk_bf16_f32 v78, v78, v78
    v_and_b32 v78, 0xffff0000, v78
    v_rcp_f32 v93, v91
    s_nop 0
    v_mul_f32 v94, v78, v93
    v_fma_f32 v92, -v94, v91, v78
    v_fma_f32 v92, v92, v93, v94
    v_cvt_pk_bf16_f32 v78, v92, v92
    v_and_b32 v78, 0xffff0000, v78
    v_sub_f32 v79, v79, v90
    v_cvt_pk_bf16_f32 v79, v79, v79
    v_and_b32 v79, 0xffff0000, v79
    v_rcp_f32 v93, v91
    s_nop 0
    v_mul_f32 v94, v79, v93
    v_fma_f32 v92, -v94, v91, v79
    v_fma_f32 v92, v92, v93, v94
    v_cvt_pk_bf16_f32 v79, v92, v92
    v_and_b32 v79, 0xffff0000, v79
    v_sub_f32 v80, v80, v90
    v_cvt_pk_bf16_f32 v80, v80, v80
    v_and_b32 v80, 0xffff0000, v80
    v_rcp_f32 v93, v91
    s_nop 0
    v_mul_f32 v94, v80, v93
    v_fma_f32 v92, -v94, v91, v80
    v_fma_f32 v92, v92, v93, v94
    v_cvt_pk_bf16_f32 v80, v92, v92
    v_and_b32 v80, 0xffff0000, v80
    v_sub_f32 v81, v81, v90
    v_cvt_pk_bf16_f32 v81, v81, v81
    v_and_b32 v81, 0xffff0000, v81
    v_rcp_f32 v93, v91
    s_nop 0
    v_mul_f32 v94, v81, v93
    v_fma_f32 v92, -v94, v91, v81
    v_fma_f32 v92, v92, v93, v94
    v_cvt_pk_bf16_f32 v81, v92, v92
    v_and_b32 v81, 0xffff0000, v81
L_nw0_11:
    s_cmp_eq_u32 s3, 0
    s_cbranch_scc1 L_w_19
    s_waitcnt vmcnt(6)
L_w_19:
    v_mov_b32 v4, 0
    v_mov_b32 v5, 0
    v_mov_b32 v6, 0
    v_mov_b32 v7, 0
    v_mov_b32 v8, 0
    v_mov_b32 v9, 0
    v_mov_b32 v10, 0
    v_mov_b32 v11, 0
    v_lshlrev_b32 v12, 16, v52
    v_sub_f32 v63, 0, v12
    v_min_f32 v63, 0x42b00000, v63
    v_max_f32 v63, 0xc2b00000, v63
    v_mul_f32 v13, 0x3fb8aa3b, v63
    v_exp_f32 v14, v13
    s_mov_b32 s97, 0x3fb8aa3b
    v_fma_f32 v13, v63, s97, -v13
    s_mov_b32 s97, 0x32a57060
    v_fma_f32 v13, v63, s97, v13
    v_mul_f32 v13, 0x3f317218, v13
    v_fma_f32 v14, v14, v13, v14
    v_add_f32 v14, 1.0, v14
    v_rcp_f32 v13, v14
    s_nop 0
    v_mul_f32 v63, v12, v13
    v_fma_f32 v61, -v63, v14, v12
    v_fma_f32 v61, v61, v13, v63
    v_cvt_pk_bf16_f32 v61, v61, v61
    v_and_b32 v62, 0xffff0000, v61
    v_lshrrev_b32 v61, 16, v61
    v_dot2c_f32_bf16 v4, v16, v61
    v_dot2c_f32_bf16 v5, v16, v62
    v_dot2c_f32_bf16 v6, v17, v61
    v_dot2c_f32_bf16 v7, v17, v62
    v_dot2c_f32_bf16 v8, v18, v61
    v_dot2c_f32_bf16 v9, v18, v62
    v_dot2c_f32_bf16 v10, v19, v61
    v_dot2c_f32_bf16 v11, v19, v62
    v_lshlrev_b32 v12, 16, v53
    v_sub_f32 v63, 0, v12
    v_min_f32 v63, 0x42b00000, v63
    v_max_f32 v63, 0xc2b00000, v63
    v_mul_f32 v13, 0x3fb8aa3b, v63
    v_exp_f32 v14, v13
    s_mov_b32 s97, 0x3fb8aa3b
    v_fma_f32 v13, v63, s97, -v13
    s_mov_b32 s97, 0x32a57060
    v_fma_f32 v13, v63, s97, v13
    v_mul_f32 v13, 0x3f317218, v13
    v_fma_f32 v14, v14, v13, v14
    v_add_f32 v14, 1.0, v14
    v_rcp_f32 v13, v14
    s_nop 0
    v_mul_f32 v63, v12, v13
    v_fma_f32 v61, -v63, v14, v12
    v_fma_f32 v61, v61, v13, v63
    v_cvt_pk_bf16_f32 v61, v61, v61
    v_and_b32 v62, 0xffff0000, v61
    v_lshrrev_b32 v61, 16, v61
    v_dot2c_f32_bf16 v4, v20, v61
    v_dot2c_f32_bf16 v5, v20, v62
    v_dot2c_f32_bf16 v6, v21, v61
    v_dot2c_f32_bf16 v7, v21, v62
    v_dot2c_f32_bf16 v8, v22, v61
    v_dot2c_f32_bf16 v9, v22, v62
    v_dot2c_f32_bf16 v10, v23, v61
    v_dot2c_f32_bf16 v11, v23, v62
    v_lshlrev_b32 v12, 16, v54
    v_sub_f32 v63, 0, v12
    v_min_f32 v63, 0x42b00000, v63
    v_max_f32 v63, 0xc2b00000, v63
    v_mul_f32 v13, 0x3fb8aa3b, v63
    v_exp_f32 v14, v13
    s_mov_b32 s97, 0x3fb8aa3b
    v_fma_f32 v13, v63, s97, -v13
    s_mov_b32 s97, 0x32a57060
    v_fma_f32 v13, v63, s97, v13
    v_mul_f32 v13, 0x3f317218, v13
    v_fma_f32 v14, v14, v13, v14
    v_add_f32 v14, 1.0, v14
    v_rcp_f32 v13, v14
    s_nop 0
    v_mul_f32 v63, v12, v13
    v_fma_f32 v61, -v63, v14, v12
    v_fma_f32 v61, v61, v13, v63
    v_cvt_pk_bf16_f32 v61, v61, v61
    v_and_b32 v62, 0xffff0000, v61
    v_lshrrev_b32 v61, 16, v61
    v_dot2c_f32_bf16 v4, v24, v61
    v_dot2c_f32_bf16 v5, v24, v62
    v_dot2c_f32_bf16 v6, v25, v61
    v_dot2c_f32_bf16 v7, v25, v62
    v_dot2c_f32_bf16 v8, v26, v61
    v_dot2c_f32_bf16 v9, v26, v62
    v_dot2c_f32_bf16 v10, v27, v61
    v_dot2c_f32_bf16 v11, v27, v62
    s_nop 2
    v_permlane32_swap_b32 v4, v8
    v_permlane32_swap_b32 v5, v9
    v_permlane32_swap_b32 v6, v10
    v_permlane32_swap_b32 v7, v11
    s_nop 1
    v_add_f32 v4, v4, v8
    v_add_f32 v5, v5, v9
    v_add_f32 v6, v6, v10
    v_add_f32 v7, v7, v11
    s_nop 2
    v_permlane16_swap_b32 v4, v6
    v_permlane16_swap_b32 v5, v7
    s_nop 1
    v_add_f32 v4, v4, v6
    v_add_f32 v5, v5, v7
    s_nop 1
    v_add_f32_dpp v4, v4, v4 row_ror:8 row_mask:0xf bank_mask:0xf
    v_add_f32_dpp v5, v5, v5 row_ror:8 row_mask:0xf bank_mask:0xf
    v_lshrrev_b32 v12, 4, v1
    v_lshlrev_b32 v12, 3, v12
    v_and_b32 v13, 7, v1
    v_lshl_add_u32 v12, v13, 5, v12
    s_lshl_b32 s97, s3, 8
    v_add_u32 v12, s97, v12
    v_and_b32 v13, 8, v1
    v_cmp_eq_u32 vcc, 0, v13
    s_and_saveexec_b64 s[4:5], vcc
    s_cbranch_execz L_m_21
    ds_write_b64 v12, v[4:5] offset:0
L_m_21:
    s_mov_b64 exec, s[4:5]
    s_waitcnt lgkmcnt(0)
    s_barrier
    s_cmp_lg_u32 s3, 0
    s_cbranch_scc1 L_nw0_22
    v_lshlrev_b32 v12, 2, v1
    ds_read_b32 v100, v12 offset:0
    ds_read_b32 v101, v12 offset:256
    ds_read_b32 v102, v12 offset:512
    ds_read_b32 v103, v12 offset:768
    ds_read_b32 v104, v12 offset:1024
    ds_read_b32 v105, v12 offset:1280
    ds_read_b32 v106, v12 offset:1536
    ds_read_b32 v107, v12 offset:1792
    s_waitcnt lgkmcnt(0)
    v_add_f32 v100, v100, v104
    v_add_f32 v101, v101, v105
    v_add_f32 v102, v102, v106
    v_add_f32 v103, v103, v107
    v_add_f32 v100, v100, v102
    v_add_f32 v101, v101, v103
    v_add_f32 v100, v100, v101
    s_mul_i32 s97, s14, 15360
    s_lshl_b32 s98, s15, 8
    s_add_u32 s97, s97, s98
    v_add_u32 v12, s97, v12
    s_add_u32 s10, s42, 409600
    s_addc_u32 s11, s43, 0
    s_cmp_ge_u32 s2, 240
    s_cbranch_scc1 L_nm_23
    global_store_dword v12, v100, s[10:11] sc1
L_nm_23:
    s_waitcnt vmcnt(0)
    v_readfirstlane_b32 s101, v99
    s_add_u32 s101, s101, 1
    s_mul_i32 s97, s2, 32
    s_add_u32 s97, s97, 692224
    v_mov_b32 v3, s97
    v_mov_b32 v4, s101
    v_cmp_eq_u32 vcc, 0, v1
    s_and_saveexec_b64 s[4:5], vcc
    s_cbranch_execz L_m_24
    global_store_dword v3, v4, s[42:43] sc1
L_m_24:
    s_mov_b64 exec, s[4:5]
L_nw0_22:
    s_barrier
    s_cmp_eq_u32 s3, 0
    s_cbranch_scc1 L_win_25
    buffer_load_dwordx4 v[64:67], v2, s[48:51], s60 offen offset:0 nt
    buffer_load_dwordx4 v[68:71], v2, s[48:51], s60 offen offset:128 nt
    buffer_load_dwordx4 v[72:75], v2, s[48:51], s60 offen offset:256 nt
    s_add_u32 s60, s60, 24576
    buffer_load_dwordx4 v[76:79], v2, s[48:51], s60 offen offset:0 nt
    buffer_load_dwordx4 v[80:83], v2, s[48:51], s60 offen offset:128 nt
    buffer_load_dwordx4 v[84:87], v2, s[48:51], s60 offen offset:256 nt
    s_add_u32 s60, s60, 24576
L_win_25:
    s_cmp_lg_u32 s3, 0
    s_cbranch_scc1 L_nw0_26
    v_mul_u32_u24 v3, 128, v1
    v_add_u32 v3, 692224, v3
    s_mov_b32 s63, 0
L_spin_27:
    global_load_dword v4, v3, s[42:43] offset:0 sc1
    global_load_dword v5, v3, s[42:43] offset:32 sc1
    global_load_dword v6, v3, s[42:43] offset:64 sc1
    global_load_dword v7, v3, s[42:43] offset:96 sc1
    s_waitcnt vmcnt(0)
    v_cmp_ne_u32 vcc, s101, v4
    v_cmp_ne_u32 s[6:7], s101, v5
    s_or_b64 vcc, vcc, s[6:7]
    v_cmp_ne_u32 s[6:7], s101, v6
    s_or_b64 vcc, vcc, s[6:7]
    v_cmp_ne_u32 s[6:7], s101, v7
    s_or_b64 vcc, vcc, s[6:7]
    s_nop 1
    s_cbranch_vccz L_spun_28
    s_add_u32 s63, s63, 1
    s_cmp_ge_u32 s63, 65536
    s_cbranch_scc1 L_spun_28
    s_sleep 2
    s_branch L_spin_27
L_spun_28:
    v_add_u32 v3, 0, v1
    v_min_u32 v3, 159, v3
    v_lshlrev_b32 v3, 4, v3
    s_add_u32 s10, s42, 409600
    s_addc_u32 s11, s43, 0
    global_load_dwordx4 v[100:103], v3, s[10:11] offset:0 sc1
    global_load_dwordx4 v[116:119], v3, s[10:11] offset:2560 sc1
    s_add_u32 s10, s42, 424960
    s_addc_u32 s11, s43, 0
    global_load_dwordx4 v[104:107], v3, s[10:11] offset:0 sc1
    global_load_dwordx4 v[120:123], v3, s[10:11] offset:2560 sc1
    s_add_u32 s10, s42, 440320
    s_addc_u32 s11, s43, 0
    global_load_dwordx4 v[108:111], v3, s[10:11] offset:0 sc1
    global_load_dwordx4 v[124:127], v3, s[10:11] offset:2560 sc1
    s_add_u32 s10, s42, 455680
    s_addc_u32 s11, s43, 0
    global_load_dwordx4 v[112:115], v3, s[10:11] offset:0 sc1
    global_load_dwordx4 v[128:131], v3, s[10:11] offset:2560 sc1
    v_add_u32 v3, 64, v1
    v_min_u32 v3, 159, v3
    v_lshlrev_b32 v3, 4, v3
    s_add_u32 s10, s42, 409600
    s_addc_u32 s11, s43, 0
    global_load_dwordx4 v[132:135], v3, s[10:11] offset:0 sc1
    global_load_dwordx4 v[148:151], v3, s[10:11] offset:2560 sc1
    s_add_u32 s10, s42, 424960
    s_addc_u32 s11, s43, 0
    global_load_dwordx4 v[136:139], v3, s[10:11] offset:0 sc1
    global_load_dwordx4 v[152:155], v3, s[10:11] offset:2560 sc1
    s_add_u32 s10, s42, 440320
    s_addc_u32 s11, s43, 0
    global_load_dwordx4 v[140:143], v3, s[10:11] offset:0 sc1
    global_load_dwordx4 v[156:159], v3, s[10:11] offset:2560 sc1
    s_add_u32 s10, s42, 455680
    s_addc_u32 s11, s43, 0
    global_load_dwordx4 v[144:147], v3, s[10:11] offset:0 sc1
    global_load_dwordx4 v[160:163], v3, s[10:11] offset:2560 sc1
    v_add_u32 v3, 128, v1
    v_min_u32 v3, 159, v3
    v_lshlrev_b32 v3, 4, v3
    s_add_u32 s10, s42, 409600
    s_addc_u32 s11, s43, 0
    global_load_dwordx4 v[164:167], v3, s[10:11] offset:0 sc1
    global_load_dwordx4 v[180:183], v3, s[10:11] offset:2560 sc1
    s_add_u32 s10, s42, 424960
    s_addc_u32 s11, s43, 0
    global_load_dwordx4 v[168:171], v3, s[10:11] offset:0 sc1
    global_load_dwordx4 v[184:187], v3, s[10:11] offset:2560 sc1
    s_add_u32 s10, s42, 440320
    s_addc_u32 s11, s43, 0
    global_load_dwordx4 v[172:175], v3, s[10:11] offset:0 sc1
    global_load_dwordx4 v[188:191], v3, s[10:11] offset:2560 sc1
    s_add_u32 s10, s42, 455680
    s_addc_u32 s11, s43, 0
    global_load_dwordx4 v[176:179], v3, s[10:11] offset:0 sc1
    global_load_dwordx4 v[192:195], v3, s[10:11] offset:2560 sc1
L_nw0_26:
    s_barrier
    s_cmp_eq_u32 s3, 0
    s_cbranch_scc1 L_win_29
    buffer_load_dwordx4 v[88:91], v2, s[48:51], s60 offen offset:0 nt
    buffer_load_dwordx4 v[92:95], v2, s[48:51], s60 offen offset:128 nt
    buffer_load_dwordx4 v[96:99], v2, s[48:51], s60 offen offset:256 nt
    s_add_u32 s60, s60, 24576
    s_waitcnt vmcnt(6)
    buffer_load_dwordx4 v[100:103], v2, s[48:51], s60 offen offset:0 nt
    buffer_load_dwordx4 v[104:107], v2, s[48:51], s60 offen offset:128 nt
    buffer_load_dwordx4 v[108:111], v2, s[48:51], s60 offen offset:256 nt
    s_add_u32 s60, s60, 24576
    s_waitcnt vmcnt(6)
    buffer_load_dwordx4 v[112:115], v2, s[48:51], s60 offen offset:0 nt
    buffer_load_dwordx4 v[116:119], v2, s[48:51], s60 offen offset:128 nt
    buffer_load_dwordx4 v[120:123], v2, s[48:51], s60 offen offset:256 nt
    s_add_u32 s60, s60, 24576
L_win_29:
    s_cmp_lg_u32 s3, 0
    s_cbranch_scc1 L_nw0_30
    s_mov_b32 s63, 0
L_spin_31:
    s_waitcnt vmcnt(0)
    v_max_u32 v92, v100, v101
    v_max3_u32 v92, v92, v102, v103
    v_max3_u32 v92, v92, v104, v105
    v_max3_u32 v92, v92, v106, v107
    v_max3_u32 v92, v92, v108, v109
    v_max3_u32 v92, v92, v110, v111
    v_max3_u32 v92, v92, v112, v113
    v_max3_u32 v92, v92, v114, v115
    v_max3_u32 v92, v92, v116, v117
    v_max3_u32 v92, v92, v118, v119
    v_max3_u32 v92, v92, v120, v121
    v_max3_u32 v92, v92, v122, v123
    v_max3_u32 v92, v92, v124, v125
    v_max3_u32 v92, v92, v126, v127
    v_max3_u32 v92, v92, v128, v129
    v_max3_u32 v92, v92, v130, v131
    v_max3_u32 v92, v92, v132, v133
    v_max3_u32 v92, v92, v134, v135
    v_max3_u32 v92, v92, v136, v137
    v_max3_u32 v92, v92, v138, v139
    v_max3_u32 v92, v92, v140, v141
    v_max3_u32 v92, v92, v142, v143
    v_max3_u32 v92, v92, v144, v145
    v_max3_u32 v92, v92, v146, v147
    v_max3_u32 v92, v92, v148, v149
    v_max3_u32 v92, v92, v150, v151
    v_max3_u32 v92, v92, v152, v153
    v_max3_u32 v92, v92, v154, v155
    v_max3_u32 v92, v92, v156, v157
    v_max3_u32 v92, v92, v158, v159
    v_max3_u32 v92, v92, v160, v161
    v_max3_u32 v92, v92, v162, v163
    v_max3_u32 v92, v92, v164, v165
    v_max3_u32 v92, v92, v166, v167
    v_max3_u32 v92, v92, v168, v169
    v_max3_u32 v92, v92, v170, v171
    v_max3_u32 v92, v92, v172, v173
    v_max3_u32 v92, v92, v174, v175
    v_max3_u32 v92, v92, v176, v177
    v_max3_u32 v92, v92, v178, v179
    v_max3_u32 v92, v92, v180, v181
    v_max3_u32 v92, v92, v182, v183
    v_max3_u32 v92, v92, v184, v185
    v_max3_u32 v92, v92, v186, v187
    v_max3_u32 v92, v92, v188, v189
    v_max3_u32 v92, v92, v190, v191
    v_max3_u32 v92, v92, v192, v193
    v_max3_u32 v92, v92, v194, v195
    v_cmp_eq_u32 vcc, -1, v92
    s_nop 1
    s_cbranch_vccz L_sok_32
    s_add_u32 s63, s63, 1
    s_cmp_ge_u32 s63, 65536
    s_cbranch_scc1 L_sok_32
    v_add_u32 v3, 0, v1
    v_min_u32 v3, 159, v3
    v_lshlrev_b32 v3, 4, v3
    s_add_u32 s10, s42, 409600
    s_addc_u32 s11, s43, 0
    global_load_dwordx4 v[100:103], v3, s[10:11] offset:0 sc1
    global_load_dwordx4 v[116:119], v3, s[10:11] offset:2560 sc1
    s_add_u32 s10, s42, 424960
    s_addc_u32 s11, s43, 0
    global_load_dwordx4 v[104:107], v3, s[10:11] offset:0 sc1
    global_load_dwordx4 v[120:123], v3, s[10:11] offset:2560 sc1
    s_add_u32 s10, s42, 440320
    s_addc_u32 s11, s43, 0
    global_load_dwordx4 v[108:111], v3, s[10:11] offset:0 sc1
    global_load_dwordx4 v[124:127], v3, s[10:11] offset:2560 sc1
    s_add_u32 s10, s42, 455680
    s_addc_u32 s11, s43, 0
    global_load_dwordx4 v[112:115], v3, s[10:11] offset:0 sc1
    global_load_dwordx4 v[128:131], v3, s[10:11] offset:2560 sc1
    v_add_u32 v3, 64, v1
    v_min_u32 v3, 159, v3
    v_lshlrev_b32 v3, 4, v3
    s_add_u32 s10, s42, 409600
    s_addc_u32 s11, s43, 0
    global_load_dwordx4 v[132:135], v3, s[10:11] offset:0 sc1
    global_load_dwordx4 v[148:151], v3, s[10:11] offset:2560 sc1
    s_add_u32 s10, s42, 424960
    s_addc_u32 s11, s43, 0
    global_load_dwordx4 v[136:139], v3, s[10:11] offset:0 sc1
    global_load_dwordx4 v[152:155], v3, s[10:11] offset:2560 sc1
    s_add_u32 s10, s42, 440320
    s_addc_u32 s11, s43, 0
    global_load_dwordx4 v[140:143], v3, s[10:11] offset:0 sc1
    global_load_dwordx4 v[156:159], v3, s[10:11] offset:2560 sc1
    s_add_u32 s10, s42, 455680
    s_addc_u32 s11, s43, 0
    global_load_dwordx4 v[144:147], v3, s[10:11] offset:0 sc1
    global_load_dwordx4 v[160:163], v3, s[10:11] offset:2560 sc1
    v_add_u32 v3, 128, v1
    v_min_u32 v3, 159, v3
    v_lshlrev_b32 v3, 4, v3
    s_add_u32 s10, s42, 409600
    s_addc_u32 s11, s43, 0
    global_load_dwordx4 v[164:167], v3, s[10:11] offset:0 sc1
    global_load_dwordx4 v[180:183], v3, s[10:11] offset:2560 sc1
    s_add_u32 s10, s42, 424960
    s_addc_u32 s11, s43, 0
    global_load_dwordx4 v[168:171], v3, s[10:11] offset:0 sc1
    global_load_dwordx4 v[184:187], v3, s[10:11] offset:2560 sc1
    s_add_u32 s10, s42, 440320
    s_addc_u32 s11, s43, 0
    global_load_dwordx4 v[172:175], v3, s[10:11] offset:0 sc1
    global_load_dwordx4 v[188:191], v3, s[10:11] offset:2560 sc1
    s_add_u32 s10, s42, 455680
    s_addc_u32 s11, s43, 0
    global_load_dwordx4 v[176:179], v3, s[10:11] offset:0 sc1
    global_load_dwordx4 v[192:195], v3, s[10:11] offset:2560 sc1
    s_branch L_spin_31
L_sok_32:
    v_add_f32 v100, v100, v108
    v_add_f32 v101, v101, v109
    v_add_f32 v102, v102, v110
    v_add_f32 v103, v103, v111
    v_add_f32 v104, v104, v112
    v_add_f32 v105, v105, v113
    v_add_f32 v106, v106, v114
    v_add_f32 v107, v107, v115
    v_add_f32 v100, v100, v104
    v_add_f32 v101, v101, v105
    v_add_f32 v102, v102, v106
    v_add_f32 v103, v103, v107
    v_cvt_pk_bf16_f32 v100, v100, v100
    v_and_b32 v100, 0xffff0000, v100
    v_cvt_pk_bf16_f32 v101, v101, v101
    v_and_b32 v101, 0xffff0000, v101
    v_cvt_pk_bf16_f32 v102, v102, v102
    v_and_b32 v102, 0xffff0000, v102
    v_cvt_pk_bf16_f32 v103, v103, v103
    v_and_b32 v103, 0xffff0000, v103
    v_add_f32 v116, v116, v124
    v_add_f32 v117, v117, v125
    v_add_f32 v118, v118, v126
    v_add_f32 v119, v119, v127
    v_add_f32 v120, v120, v128
    v_add_f32 v121, v121, v129
    v_add_f32 v122, v122, v130
    v_add_f32 v123, v123, v131
    v_add_f32 v116, v116, v120
    v_add_f32 v117, v117, v121
    v_add_f32 v118, v118, v122
    v_add_f32 v119, v119, v123
    v_cvt_pk_bf16_f32 v116, v116, v116
    v_and_b32 v116, 0xffff0000, v116
    v_cvt_pk_bf16_f32 v117, v117, v117
    v_and_b32 v117, 0xffff0000, v117
    v_cvt_pk_bf16_f32 v118, v118, v118
    v_and_b32 v118, 0xffff0000, v118
    v_cvt_pk_bf16_f32 v119, v119, v119
    v_and_b32 v119, 0xffff0000, v119
    v_add_f32 v92, 1.0, v116
    v_cvt_pk_bf16_f32 v92, v92, v92
    v_and_b32 v92, 0xffff0000, v92
    v_mul_f32 v70, v70, v92
    v_cvt_pk_bf16_f32 v70, v70, v70
    v_and_b32 v70, 0xffff0000, v70
    v_add_f32 v70, v70, v100
    v_cvt_pk_bf16_f32 v70, v70, v70
    v_and_b32 v70, 0xffff0000, v70
    v_add_f32 v92, 1.0, v117
    v_cvt_pk_bf16_f32 v92, v92, v92
    v_and_b32 v92, 0xffff0000, v92
    v_mul_f32 v71, v71, v92
    v_cvt_pk_bf16_f32 v71, v71, v71
    v_and_b32 v71, 0xffff0000, v71
    v_add_f32 v71, v71, v101
    v_cvt_pk_bf16_f32 v71, v71, v71
    v_and_b32 v71, 0xffff0000, v71
    v_add_f32 v92, 1.0, v118
    v_cvt_pk_bf16_f32 v92, v92, v92
    v_and_b32 v92, 0xffff0000, v92
    v_mul_f32 v72, v72, v92
    v_cvt_pk_bf16_f32 v72, v72, v72
    v_and_b32 v72, 0xffff0000, v72
    v_add_f32 v72, v72, v102
    v_cvt_pk_bf16_f32 v72, v72, v72
    v_and_b32 v72, 0xffff0000, v72
    v_add_f32 v92, 1.0, v119
    v_cvt_pk_bf16_f32 v92, v92, v92
    v_and_b32 v92, 0xffff0000, v92
    v_mul_f32 v73, v73, v92
    v_cvt_pk_bf16_f32 v73, v73, v73
    v_and_b32 v73, 0xffff0000, v73
    v_add_f32 v73, v73, v103
    v_cvt_pk_bf16_f32 v73, v73, v73
    v_and_b32 v73, 0xffff0000, v73
    v_cvt_pk_bf16_f32 v92, v70, v71
    v_cvt_pk_bf16_f32 v93, v72, v73
    v_lshlrev_b32 v3, 3, v1
    ds_write_b64 v3, v[92:93] offset:4096
    v_add_f32 v132, v132, v140
    v_add_f32 v133, v133, v141
    v_add_f32 v134, v134, v142
    v_add_f32 v135, v135, v143
    v_add_f32 v136, v136, v144
    v_add_f32 v137, v137, v145
    v_add_f32 v138, v138, v146
    v_add_f32 v139, v139, v147
    v_add_f32 v132, v132, v136
    v_add_f32 v133, v133, v137
    v_add_f32 v134, v134, v138
    v_add_f32 v135, v135, v139
    v_cvt_pk_bf16_f32 v132, v132, v132
    v_and_b32 v132, 0xffff0000, v132
    v_cvt_pk_bf16_f32 v133, v133, v133
    v_and_b32 v133, 0xffff0000, v133
    v_cvt_pk_bf16_f32 v134, v134, v134
    v_and_b32 v134, 0xffff0000, v134
    v_cvt_pk_bf16_f32 v135, v135, v135
    v_and_b32 v135, 0xffff0000, v135
    v_add_f32 v148, v148, v156
    v_add_f32 v149, v149, v157
    v_add_f32 v150, v150, v158
    v_add_f32 v151, v151, v159
    v_add_f32 v152, v152, v160
    v_add_f32 v153, v153, v161
    v_add_f32 v154, v154, v162
    v_add_f32 v155, v155, v163
    v_add_f32 v148, v148, v152
    v_add_f32 v149, v149, v153
    v_add_f32 v150, v150, v154
    v_add_f32 v151, v151, v155
    v_cvt_pk_bf16_f32 v148, v148, v148
    v_and_b32 v148, 0xffff0000, v148
    v_cvt_pk_bf16_f32 v149, v149, v149
    v_and_b32 v149, 0xffff0000, v149
    v_cvt_pk_bf16_f32 v150, v150, v150
    v_and_b32 v150, 0xffff0000, v150
    v_cvt_pk_bf16_f32 v151, v151, v151
    v_and_b32 v151, 0xffff0000, v151
    v_add_f32 v92, 1.0, v148
    v_cvt_pk_bf16_f32 v92, v92, v92
    v_and_b32 v92, 0xffff0000, v92
    v_mul_f32 v74, v74, v92
    v_cvt_pk_bf16_f32 v74, v74, v74
    v_and_b32 v74, 0xffff0000, v74
    v_add_f32 v74, v74, v132
    v_cvt_pk_bf16_f32 v74, v74, v74
    v_and_b32 v74, 0xffff0000, v74
    v_add_f32 v92, 1.0, v149
    v_cvt_pk_bf16_f32 v92, v92, v92
    v_and_b32 v92, 0xffff0000, v92
    v_mul_f32 v75, v75, v92
    v_cvt_pk_bf16_f32 v75, v75, v75
    v_and_b32 v75, 0xffff0000, v75
    v_add_f32 v75, v75, v133
    v_cvt_pk_bf16_f32 v75, v75, v75
    v_and_b32 v75, 0xffff0000, v75
    v_add_f32 v92, 1.0, v150
    v_cvt_pk_bf16_f32 v92, v92, v92
    v_and_b32 v92, 0xffff0000, v92
    v_mul_f32 v76, v76, v92
    v_cvt_pk_bf16_f32 v76, v76, v76
    v_and_b32 v76, 0xffff0000, v76
    v_add_f32 v76, v76, v134
    v_cvt_pk_bf16_f32 v76, v76, v76
    v_and_b32 v76, 0xffff0000, v76
    v_add_f32 v92, 1.0, v151
    v_cvt_pk_bf16_f32 v92, v92, v92
    v_and_b32 v92, 0xffff0000, v92
    v_mul_f32 v77, v77, v92
    v_cvt_pk_bf16_f32 v77, v77, v77
    v_and_b32 v77, 0xffff0000, v77
    v_add_f32 v77, v77, v135
    v_cvt_pk_bf16_f32 v77, v77, v77
    v_and_b32 v77, 0xffff0000, v77
    v_cvt_pk_bf16_f32 v92, v74, v75
    v_cvt_pk_bf16_f32 v93, v76, v77
    v_lshlrev_b32 v3, 3, v1
    ds_write_b64 v3, v[92:93] offset:4608
    v_add_f32 v164, v164, v172
    v_add_f32 v165, v165, v173
    v_add_f32 v166, v166, v174
    v_add_f32 v167, v167, v175
    v_add_f32 v168, v168, v176
    v_add_f32 v169, v169, v177
    v_add_f32 v170, v170, v178
    v_add_f32 v171, v171, v179
    v_add_f32 v164, v164, v168
    v_add_f32 v165, v165, v169
    v_add_f32 v166, v166, v170
    v_add_f32 v167, v167, v171
    v_cvt_pk_bf16_f32 v164, v164, v164
    v_and_b32 v164, 0xffff0000, v164
    v_cvt_pk_bf16_f32 v165, v165, v165
    v_and_b32 v165, 0xffff0000, v165
    v_cvt_pk_bf16_f32 v166, v166, v166
    v_and_b32 v166, 0xffff0000, v166
    v_cvt_pk_bf16_f32 v167, v167, v167
    v_and_b32 v167, 0xffff0000, v167
    v_add_f32 v180, v180, v188
    v_add_f32 v181, v181, v189
    v_add_f32 v182, v182, v190
    v_add_f32 v183, v183, v191
    v_add_f32 v184, v184, v192
    v_add_f32 v185, v185, v193
    v_add_f32 v186, v186, v194
    v_add_f32 v187, v187, v195
    v_add_f32 v180, v180, v184
    v_add_f32 v181, v181, v185
    v_add_f32 v182, v182, v186
    v_add_f32 v183, v183, v187
    v_cvt_pk_bf16_f32 v180, v180, v180
    v_and_b32 v180, 0xffff0000, v180
    v_cvt_pk_bf16_f32 v181, v181, v181
    v_and_b32 v181, 0xffff0000, v181
    v_cvt_pk_bf16_f32 v182, v182, v182
    v_and_b32 v182, 0xffff0000, v182
    v_cvt_pk_bf16_f32 v183, v183, v183
    v_and_b32 v183, 0xffff0000, v183
    v_add_f32 v92, 1.0, v180
    v_cvt_pk_bf16_f32 v92, v92, v92
    v_and_b32 v92, 0xffff0000, v92
    v_mul_f32 v78, v78, v92
    v_cvt_pk_bf16_f32 v78, v78, v78
    v_and_b32 v78, 0xffff0000, v78
    v_add_f32 v78, v78, v164
    v_cvt_pk_bf16_f32 v78, v78, v78
    v_and_b32 v78, 0xffff0000, v78
    v_add_f32 v92, 1.0, v181
    v_cvt_pk_bf16_f32 v92, v92, v92
    v_and_b32 v92, 0xffff0000, v92
    v_mul_f32 v79, v79, v92
    v_cvt_pk_bf16_f32 v79, v79, v79
    v_and_b32 v79, 0xffff0000, v79
    v_add_f32 v79, v79, v165
    v_cvt_pk_bf16_f32 v79, v79, v79
    v_and_b32 v79, 0xffff0000, v79
    v_add_f32 v92, 1.0, v182
    v_cvt_pk_bf16_f32 v92, v92, v92
    v_and_b32 v92, 0xffff0000, v92
    v_mul_f32 v80, v80, v92
    v_cvt_pk_bf16_f32 v80, v80, v80
    v_and_b32 v80, 0xffff0000, v80
    v_add_f32 v80, v80, v166
    v_cvt_pk_bf16_f32 v80, v80, v80
    v_and_b32 v80, 0xffff0000, v80
    v_add_f32 v92, 1.0, v183
    v_cvt_pk_bf16_f32 v92, v92, v92
    v_and_b32 v92, 0xffff0000, v92
    v_mul_f32 v81, v81, v92
    v_cvt_pk_bf16_f32 v81, v81, v81
    v_and_b32 v81, 0xffff0000, v81
    v_add_f32 v81, v81, v167
    v_cvt_pk_bf16_f32 v81, v81, v81
    v_and_b32 v81, 0xffff0000, v81
    v_cvt_pk_bf16_f32 v92, v78, v79
    v_cvt_pk_bf16_f32 v93, v80, v81
    v_lshlrev_b32 v3, 3, v1
    v_cmp_gt_u32 vcc, 32, v1
    s_and_saveexec_b64 s[4:5], vcc
    s_cbranch_execz L_m_33
    ds_write_b64 v3, v[92:93] offset:5120
L_m_33:
    s_mov_b64 exec, s[4:5]
    s_waitcnt lgkmcnt(0)
L_nw0_30:
    s_barrier
    s_waitcnt vmcnt(15)
    v_lshrrev_b32 v3, 3, v1
    s_mul_i32 s97, s47, 80
    s_lshl_b32 s98, s3, 3
    s_add_u32 s97, s97, s98
    v_add_u32 v3, s97, v3
    v_min_u32 v4, 575, v3
    v_lshlrev_b32 v3, 1, v3
    v_lshlrev_b32 v4, 1, v4
    ds_read_u16 v60, v3 offset:4096
    ds_read_u16 v62, v4 offset:4224
    v_mov_b32 v4, 0
    v_mov_b32 v5, 0
    v_mov_b32 v6, 0
    v_mov_b32 v7, 0
    v_mov_b32 v8, 0
    v_mov_b32 v9, 0
    v_mov_b32 v10, 0
    v_mov_b32 v11, 0
    v_mov_b32 v12, 0
    v_mov_b32 v13, 0
    v_mov_b32 v14, 0
    v_mov_b32 v16, 0
    v_mov_b32 v17, 0
    v_mov_b32 v18, 0
    v_mov_b32 v19, 0
    v_mov_b32 v20, 0
    v_mov_b32 v21, 0
    v_mov_b32 v22, 0
    v_mov_b32 v23, 0
    v_mov_b32 v24, 0
    v_mov_b32 v25, 0
    v_mov_b32 v26, 0
    v_mov_b32 v27, 0
    v_mov_b32 v52, 0
    s_waitcnt lgkmcnt(0)
    v_lshlrev_b32 v61, 16, v60
    v_lshlrev_b32 v63, 16, v62
    v_dot2c_f32_bf16 v4, v28, v60
    v_dot2c_f32_bf16 v5, v28, v61
    v_dot2c_f32_bf16 v6, v29, v60
    v_dot2c_f32_bf16 v7, v29, v61
    v_dot2c_f32_bf16 v8, v30, v60
    v_dot2c_f32_bf16 v9, v30, v61
    v_dot2c_f32_bf16 v10, v31, v60
    v_dot2c_f32_bf16 v11, v31, v61
    v_dot2c_f32_bf16 v12, v32, v60
    v_dot2c_f32_bf16 v13, v32, v61
    v_dot2c_f32_bf16 v14, v33, v60
    v_dot2c_f32_bf16 v16, v33, v61
    v_dot2c_f32_bf16 v17, v34, v60
    v_dot2c_f32_bf16 v18, v34, v61
    v_dot2c_f32_bf16 v19, v35, v60
    v_dot2c_f32_bf16 v20, v35, v61
    v_dot2c_f32_bf16 v21, v36, v60
    v_dot2c_f32_bf16 v22, v36, v61
    v_dot2c_f32_bf16 v23, v37, v60
    v_dot2c_f32_bf16 v24, v37, v61
    v_dot2c_f32_bf16 v25, v38, v60
    v_dot2c_f32_bf16 v26, v38, v61
    v_dot2c_f32_bf16 v27, v39, v60
    v_dot2c_f32_bf16 v52, v39, v61
    v_dot2c_f32_bf16 v4, v40, v62
    v_dot2c_f32_bf16 v5, v40, v63
    v_dot2c_f32_bf16 v6, v41, v62
    v_dot2c_f32_bf16 v7, v41, v63
    v_dot2c_f32_bf16 v8, v42, v62
    v_dot2c_f32_bf16 v9, v42, v63
    v_dot2c_f32_bf16 v10, v43, v62
    v_dot2c_f32_bf16 v11, v43, v63
    v_dot2c_f32_bf16 v12, v44, v62
    v_dot2c_f32_bf16 v13, v44, v63
    v_dot2c_f32_bf16 v14, v45, v62
    v_dot2c_f32_bf16 v16, v45, v63
    v_dot2c_f32_bf16 v17, v46, v62
    v_dot2c_f32_bf16 v18, v46, v63
    v_dot2c_f32_bf16 v19, v47, v62
    v_dot2c_f32_bf16 v20, v47, v63
    v_dot2c_f32_bf16 v21, v48, v62
    v_dot2c_f32_bf16 v22, v48, v63
    v_dot2c_f32_bf16 v23, v49, v62
    v_dot2c_f32_bf16 v24, v49, v63
    v_dot2c_f32_bf16 v25, v50, v62
    v_dot2c_f32_bf16 v26, v50, v63
    v_dot2c_f32_bf16 v27, v51, v62
    v_dot2c_f32_bf16 v52, v51, v63
    s_nop 2
    v_permlane32_swap_b32 v4, v17
    v_permlane32_swap_b32 v5, v18
    v_permlane32_swap_b32 v6, v19
    v_permlane32_swap_b32 v7, v20
    v_permlane32_swap_b32 v8, v21
    v_permlane32_swap_b32 v9, v22
    v_permlane32_swap_b32 v10, v23
    v_permlane32_swap_b32 v11, v24
    v_permlane32_swap_b32 v12, v25
    v_permlane32_swap_b32 v13, v26
    v_permlane32_swap_b32 v14, v27
    v_permlane32_swap_b32 v16, v52
    s_nop 1
    v_add_f32 v4, v4, v17
    v_add_f32 v5, v5, v18
    v_add_f32 v6, v6, v19
    v_add_f32 v7, v7, v20
    v_add_f32 v8, v8, v21
    v_add_f32 v9, v9, v22
    v_add_f32 v10, v10, v23
    v_add_f32 v11, v11, v24
    v_add_f32 v12, v12, v25
    v_add_f32 v13, v13, v26
    v_add_f32 v14, v14, v27
    v_add_f32 v16, v16, v52
    s_nop 2
    v_permlane16_swap_b32 v4, v10
    v_permlane16_swap_b32 v5, v11
    v_permlane16_swap_b32 v6, v12
    v_permlane16_swap_b32 v7, v13
    v_permlane16_swap_b32 v8, v14
    v_permlane16_swap_b32 v9, v16
    s_nop 1
    v_add_f32 v4, v4, v10
    v_add_f32 v5, v5, v11
    v_add_f32 v6, v6, v12
    v_add_f32 v7, v7, v13
    v_add_f32 v8, v8, v14
    v_add_f32 v9, v9, v16
    s_nop 1
    v_add_f32_dpp v4, v4, v4 row_ror:8 row_mask:0xf bank_mask:0xf
    v_add_f32_dpp v5, v5, v5 row_ror:8 row_mask:0xf bank_mask:0xf
    v_add_f32_dpp v6, v6, v6 row_ror:8 row_mask:0xf bank_mask:0xf
    v_add_f32_dpp v7, v7, v7 row_ror:8 row_mask:0xf bank_mask:0xf
    v_add_f32_dpp v8, v8, v8 row_ror:8 row_mask:0xf bank_mask:0xf
    v_add_f32_dpp v9, v9, v9 row_ror:8 row_mask:0xf bank_mask:0xf
    v_lshrrev_b32 v3, 4, v1
    v_mul_u32_u24 v3, 6, v3
    v_and_b32 v60, 7, v1
    v_lshlrev_b32 v60, 5, v60
    s_mul_i32 s97, s3, 768
    v_add_u32 v60, s97, v60
    v_and_b32 v61, 8, v1
    v_cmp_eq_u32 vcc, 0, v61
    s_and_saveexec_b64 s[4:5], vcc
    s_cbranch_execz L_m_34
    v_add_u32 v61, 0, v3
    v_lshrrev_b32 v62, 3, v61
    v_and_b32 v61, 7, v61
    v_lshlrev_b32 v62, 8, v62
    v_lshl_add_u32 v61, v61, 2, v62
    v_add_u32 v61, v61, v60
    ds_write_b32 v61, v4 offset:8192
    v_add_u32 v61, 1, v3
    v_lshrrev_b32 v62, 3, v61
    v_and_b32 v61, 7, v61
    v_lshlrev_b32 v62, 8, v62
    v_lshl_add_u32 v61, v61, 2, v62
    v_add_u32 v61, v61, v60
    ds_write_b32 v61, v5 offset:8192
    v_add_u32 v61, 2, v3
    v_lshrrev_b32 v62, 3, v61
    v_and_b32 v61, 7, v61
    v_lshlrev_b32 v62, 8, v62
    v_lshl_add_u32 v61, v61, 2, v62
    v_add_u32 v61, v61, v60
    ds_write_b32 v61, v6 offset:8192
    v_add_u32 v61, 3, v3
    v_lshrrev_b32 v62, 3, v61
    v_and_b32 v61, 7, v61
    v_lshlrev_b32 v62, 8, v62
    v_lshl_add_u32 v61, v61, 2, v62
    v_add_u32 v61, v61, v60
    ds_write_b32 v61, v7 offset:8192
    v_add_u32 v61, 4, v3
    v_lshrrev_b32 v62, 3, v61
    v_and_b32 v61, 7, v61
    v_lshlrev_b32 v62, 8, v62
    v_lshl_add_u32 v61, v61, 2, v62
    v_add_u32 v61, v61, v60
    ds_write_b32 v61, v8 offset:8192
    v_add_u32 v61, 5, v3
    v_lshrrev_b32 v62, 3, v61
    v_and_b32 v61, 7, v61
    v_lshlrev_b32 v62, 8, v62
    v_lshl_add_u32 v61, v61, 2, v62
    v_add_u32 v61, v61, v60
    ds_write_b32 v61, v9 offset:8192
L_m_34:
    s_mov_b64 exec, s[4:5]
    s_waitcnt lgkmcnt(0)
    s_barrier
    s_cmp_eq_u32 s3, 0
    s_cbranch_scc1 L_dma_35
    s_cmp_eq_u32 s92, 0
    s_cbranch_scc1 L_dffn_36
    s_cmp_lg_u32 s92, 1
    s_cbranch_scc1 L_dend_37
    s_mov_b32 s80, s24
    s_mov_b32 s81, s25
    s_mov_b32 s82, 7864320
    s_mov_b32 s83, 0x20000
    v_lshrrev_b32 v3, 3, v0
    v_mul_u32_u24 v3, 1280, v3
    v_and_b32 v4, 7, v0
    v_lshl_add_u32 v3, v4, 4, v3
    s_mul_i32 s97, s94, 491520
    s_lshl_b32 s98, s95, 7
    s_add_u32 s97, s97, s98
    s_lshl_b32 s99, s3, 10
    s_add_u32 s99, s99, 24576
    s_mov_b32 m0, s99
    s_nop 0
    buffer_load_dwordx4 v3, s[80:83], s97 offen nt lds
    s_add_u32 s97, s97, 81920
    s_add_u32 s99, s99, 8192
    s_mov_b32 m0, s99
    s_nop 0
    buffer_load_dwordx4 v3, s[80:83], s97 offen nt lds
    s_add_u32 s97, s97, 81920
    s_add_u32 s99, s99, 8192
    s_mov_b32 m0, s99
    s_nop 0
    buffer_load_dwordx4 v3, s[80:83], s97 offen nt lds
    s_add_u32 s97, s97, 81920
    s_add_u32 s99, s99, 8192
    s_mov_b32 m0, s99
    s_nop 0
    buffer_load_dwordx4 v3, s[80:83], s97 offen nt lds
    s_add_u32 s97, s97, 81920
    s_add_u32 s99, s99, 8192
    s_mov_b32 m0, s99
    s_nop 0
    buffer_load_dwordx4 v3, s[80:83], s97 offen nt lds
    s_add_u32 s97, s97, 81920
    s_add_u32 s99, s99, 8192
    s_mov_b32 m0, s99
    s_nop 0
    buffer_load_dwordx4 v3, s[80:83], s97 offen nt lds
    s_add_u32 s97, s97, 81920
    s_add_u32 s99, s99, 8192
    s_branch L_dend_37
L_dffn_36:
    s_mov_b32 s80, s28
    s_mov_b32 s81, s29
    s_mov_b32 s82, 1966080
    s_mov_b32 s83, 0x20000
    s_cmp_ge_u32 s3, 4
    s_cbranch_scc1 L_sk_38
    s_branch L_j_39
L_sk_38:
    s_mov_b32 s80, s30
    s_mov_b32 s81, s31
L_j_39:
    v_lshrrev_b32 v3, 2, v0
    v_and_b32 v3, 63, v3
    v_mul_u32_u24 v3, 3072, v3
    v_and_b32 v4, 3, v0
    v_lshl_add_u32 v3, v4, 4, v3
    s_lshl_b32 s97, s93, 6
    s_lshl_b32 s99, s3, 10
    s_add_u32 s99, s99, 24576
    s_mov_b32 m0, s99
    s_nop 0
    buffer_load_dwordx4 v3, s[80:83], s97 offen nt lds
    s_add_u32 s97, s97, 196608
    s_add_u32 s99, s99, 8192
    s_mov_b32 m0, s99
    s_nop 0
    buffer_load_dwordx4 v3, s[80:83], s97 offen nt lds
    s_add_u32 s97, s97, 196608
    s_add_u32 s99, s99, 8192
    s_mov_b32 m0, s99
    s_nop 0
    buffer_load_dwordx4 v3, s[80:83], s97 offen nt lds
    s_add_u32 s97, s97, 196608
    s_add_u32 s99, s99, 8192
    s_mov_b32 m0, s99
    s_nop 0
    buffer_load_dwordx4 v3, s[80:83], s97 offen nt lds
    s_add_u32 s97, s97, 196608
    s_add_u32 s99, s99, 8192
    s_mov_b32 m0, s99
    s_nop 0
    buffer_load_dwordx4 v3, s[80:83], s97 offen nt lds
    s_add_u32 s97, s97, 196608
    s_add_u32 s99, s99, 8192
    s_mov_b32 m0, s99
    s_nop 0
    buffer_load_dwordx4 v3, s[80:83], s97 offen nt lds
    s_add_u32 s97, s97, 196608
    s_add_u32 s99, s99, 8192
    s_mov_b32 m0, s99
    s_nop 0
    buffer_load_dwordx4 v3, s[80:83], s97 offen nt lds
    s_add_u32 s97, s97, 196608
    s_add_u32 s99, s99, 8192
    s_mov_b32 m0, s99
    s_nop 0
    buffer_load_dwordx4 v3, s[80:83], s97 offen nt lds
    s_add_u32 s97, s97, 196608
    s_add_u32 s99, s99, 8192
    s_mov_b32 m0, s99
    s_nop 0
    buffer_load_dwordx4 v3, s[80:83], s97 offen nt lds
    s_add_u32 s97, s97, 196608
    s_add_u32 s99, s99, 8192
    s_mov_b32 m0, s99
    s_nop 0
    buffer_load_dwordx4 v3, s[80:83], s97 offen nt lds
    s_add_u32 s97, s97, 196608
    s_add_u32 s99, s99, 8192
    s_cmp_ge_u32 s3, 5
    s_cbranch_scc1 L_sk_40
    s_mov_b32 s80, s32
    s_mov_b32 s81, s33
    s_mov_b32 s82, 1966080
    s_mov_b32 s83, 0x20000
    v_mul_u32_u24 v3, 205, v0
    v_lshrrev_b32 v3, 14, v3
    v_mul_u32_u24 v4, 80, v3
    v_sub_u32 v4, v0, v4
    v_mul_u32_u24 v3, 1280, v3
    v_lshl_add_u32 v3, v4, 4, v3
    s_mul_i32 s97, s93, 40960
    s_lshl_b32 s99, s3, 10
    s_add_u32 s99, s99, 106496
    s_mov_b32 m0, s99
    s_nop 0
    buffer_load_dwordx4 v3, s[80:83], s97 offen nt lds
    s_add_u32 s97, s97, 5120
    s_add_u32 s99, s99, 5120
    s_mov_b32 m0, s99
    s_nop 0
    buffer_load_dwordx4 v3, s[80:83], s97 offen nt lds
    s_add_u32 s97, s97, 5120
    s_add_u32 s99, s99, 5120
    s_mov_b32 m0, s99
    s_nop 0
    buffer_load_dwordx4 v3, s[80:83], s97 offen nt lds
    s_add_u32 s97, s97, 5120
    s_add_u32 s99, s99, 5120
    s_mov_b32 m0, s99
    s_nop 0
    buffer_load_dwordx4 v3, s[80:83], s97 offen nt lds
    s_add_u32 s97, s97, 5120
    s_add_u32 s99, s99, 5120
    s_mov_b32 m0, s99
    s_nop 0
    buffer_load_dwordx4 v3, s[80:83], s97 offen nt lds
    s_add_u32 s97, s97, 5120
    s_add_u32 s99, s99, 5120
    s_mov_b32 m0, s99
    s_nop 0
    buffer_load_dwordx4 v3, s[80:83], s97 offen nt lds
    s_add_u32 s97, s97, 5120
    s_add_u32 s99, s99, 5120
    s_mov_b32 m0, s99
    s_nop 0
    buffer_load_dwordx4 v3, s[80:83], s97 offen nt lds
    s_add_u32 s97, s97, 5120
    s_add_u32 s99, s99, 5120
    s_mov_b32 m0, s99
    s_nop 0
    buffer_load_dwordx4 v3, s[80:83], s97 offen nt lds
    s_add_u32 s97, s97, 5120
    s_add_u32 s99, s99, 5120
L_sk_40:
L_dend_37:
L_dma_35:
    s_cmp_eq_u32 s3, 0
    s_cbranch_scc1 L_win_41
    s_waitcnt vmcnt(6)
    buffer_load_dwordx4 v[124:127], v2, s[48:51], s60 offen offset:0 nt
    buffer_load_dwordx4 v[128:131], v2, s[48:51], s60 offen offset:128 nt
    buffer_load_dwordx4 v[132:135], v2, s[48:51], s60 offen offset:256 nt
    s_add_u32 s60, s60, 24576
    s_waitcnt vmcnt(6)
    buffer_load_dwordx4 v[136:139], v2, s[48:51], s60 offen offset:0 nt
    buffer_load_dwordx4 v[140:143], v2, s[48:51], s60 offen offset:128 nt
    buffer_load_dwordx4 v[144:147], v2, s[48:51], s60 offen offset:256 nt
    s_add_u32 s60, s60, 24576
    s_waitcnt vmcnt(6)
    buffer_load_dwordx4 v[148:151], v2, s[48:51], s60 offen offset:0 nt
    buffer_load_dwordx4 v[152:155], v2, s[48:51], s60 offen offset:128 nt
    buffer_load_dwordx4 v[156:159], v2, s[48:51], s60 offen offset:256 nt
    s_add_u32 s60, s60, 24576
    s_waitcnt vmcnt(6)
    buffer_load_dwordx4 v[160:163], v2, s[48:51], s60 offen offset:0 nt
    buffer_load_dwordx4 v[164:167], v2, s[48:51], s60 offen offset:128 nt
    buffer_load_dwordx4 v[168:171], v2, s[48:51], s60 offen offset:256 nt
    s_add_u32 s60, s60, 24576
    s_waitcnt vmcnt(6)
    buffer_load_dwordx4 v[172:175], v2, s[48:51], s60 offen offset:0 nt
    buffer_load_dwordx4 v[176:179], v2, s[48:51], s60 offen offset:128 nt
    buffer_load_dwordx4 v[180:183], v2, s[48:51], s60 offen offset:256 nt
    s_add_u32 s60, s60, 24576
    s_waitcnt vmcnt(6)
    buffer_load_dwordx4 v[184:187], v2, s[48:51], s60 offen offset:0 nt
    buffer_load_dwordx4 v[188:191], v2, s[48:51], s60 offen offset:128 nt
    buffer_load_dwordx4 v[192:195], v2, s[48:51], s60 offen offset:256 nt
    s_add_u32 s60, s60, 24576
    s_waitcnt vmcnt(6)
    buffer_load_dwordx4 v[196:199], v2, s[48:51], s60 offen offset:0 nt
    buffer_load_dwordx4 v[200:203], v2, s[48:51], s60 offen offset:128 nt
    buffer_load_dwordx4 v[204:207], v2, s[48:51], s60 offen offset:256 nt
    s_add_u32 s60, s60, 24576
    s_waitcnt vmcnt(6)
    buffer_load_dwordx4 v[208:211], v2, s[48:51], s60 offen offset:0 nt
    buffer_load_dwordx4 v[212:215], v2, s[48:51], s60 offen offset:128 nt
    buffer_load_dwordx4 v[216:219], v2, s[48:51], s60 offen offset:256 nt
    s_add_u32 s60, s60, 24576
    s_waitcnt vmcnt(6)
    buffer_load_dwordx4 v[220:223], v2, s[48:51], s60 offen offset:0 nt
    buffer_load_dwordx4 v[224:227], v2, s[48:51], s60 offen offset:128 nt
    buffer_load_dwordx4 v[228:231], v2, s[48:51], s60 offen offset:256 nt
    s_add_u32 s60, s60, 24576
    s_waitcnt vmcnt(6)
    buffer_load_dwordx4 v[232:235], v2, s[48:51], s60 offen offset:0 nt
    buffer_load_dwordx4 v[236:239], v2, s[48:51], s60 offen offset:128 nt
    buffer_load_dwordx4 v[240:243], v2, s[48:51], s60 offen offset:256 nt
    s_add_u32 s60, s60, 24576
    s_waitcnt vmcnt(6)
    buffer_load_dwordx4 v[244:247], v2, s[48:51], s60 offen offset:0 nt
    buffer_load_dwordx4 v[248:251], v2, s[48:51], s60 offen offset:128 nt
    buffer_load_dwordx4 v[252:255], v2, s[48:51], s60 offen offset:256 nt
    s_add_u32 s60, s60, 24576
L_win_41:
    s_cmp_lg_u32 s3, 0
    s_cbranch_scc1 L_nw0_42
    v_lshlrev_b32 v3, 4, v1
    v_min_u32 v3, 0x2f0, v3
    ds_read_b128 v[112:115], v3 offset:8192
    ds_read_b128 v[116:119], v3 offset:8960
    ds_read_b128 v[120:123], v3 offset:9728
    ds_read_b128 v[124:127], v3 offset:10496
    ds_read_b128 v[128:131], v3 offset:11264
    ds_read_b128 v[132:135], v3 offset:12032
    ds_read_b128 v[136:139], v3 offset:12800
    ds_read_b128 v[140:143], v3 offset:13568
    s_waitcnt lgkmcnt(0)
    v_add_f32 v112, v112, v128
    v_add_f32 v113, v113, v129
    v_add_f32 v114, v114, v130
    v_add_f32 v115, v115, v131
    v_add_f32 v116, v116, v132
    v_add_f32 v117, v117, v133
    v_add_f32 v118, v118, v134
    v_add_f32 v119, v119, v135
    v_add_f32 v120, v120, v136
    v_add_f32 v121, v121, v137
    v_add_f32 v122, v122, v138
    v_add_f32 v123, v123, v139
    v_add_f32 v124, v124, v140
    v_add_f32 v125, v125, v141
    v_add_f32 v126, v126, v142
    v_add_f32 v127, v127, v143
    v_add_f32 v112, v112, v120
    v_add_f32 v113, v113, v121
    v_add_f32 v114, v114, v122
    v_add_f32 v115, v115, v123
    v_add_f32 v116, v116, v124
    v_add_f32 v117, v117, v125
    v_add_f32 v118, v118, v126
    v_add_f32 v119, v119, v127
    v_add_f32 v112, v112, v116
    v_add_f32 v113, v113, v117
    v_add_f32 v114, v114, v118
    v_add_f32 v115, v115, v119
    s_mul_i32 s97, s96, 768
    s_add_u32 s97, s97, 475136
    v_add_u32 v4, s97, v3
    v_cmp_gt_u32 vcc, 48, v1
    s_and_saveexec_b64 s[4:5], vcc
    s_cbranch_execz L_m_43
    global_store_dwordx4 v4, v[112:115], s[42:43] sc1
L_m_43:
    s_mov_b64 exec, s[4:5]
    s_mul_i32 s97, s46, 6144
    s_add_u32 s97, s97, 475136
    v_add_u32 v4, s97, v3
    v_add_u32 v5, 3072, v4
    s_mov_b32 s63, 0
L_spin_44:
    global_load_dwordx4 v[112:115], v4, s[42:43] offset:0 sc1
    global_load_dwordx4 v[116:119], v4, s[42:43] offset:768 sc1
    global_load_dwordx4 v[120:123], v4, s[42:43] offset:1536 sc1
    global_load_dwordx4 v[124:127], v4, s[42:43] offset:2304 sc1
    global_load_dwordx4 v[128:131], v5, s[42:43] offset:0 sc1
    global_load_dwordx4 v[132:135], v5, s[42:43] offset:768 sc1
    global_load_dwordx4 v[136:139], v5, s[42:43] offset:1536 sc1
    global_load_dwordx4 v[140:143], v5, s[42:43] offset:2304 sc1
    s_waitcnt vmcnt(0)
    v_max_u32 v6, v112, v113
    v_max3_u32 v6, v6, v114, v115
    v_max3_u32 v6, v6, v116, v117
    v_max3_u32 v6, v6, v118, v119
    v_max3_u32 v6, v6, v120, v121
    v_max3_u32 v6, v6, v122, v123
    v_max3_u32 v6, v6, v124, v125
    v_max3_u32 v6, v6, v126, v127
    v_max3_u32 v6, v6, v128, v129
    v_max3_u32 v6, v6, v130, v131
    v_max3_u32 v6, v6, v132, v133
    v_max3_u32 v6, v6, v134, v135
    v_max3_u32 v6, v6, v136, v137
    v_max3_u32 v6, v6, v138, v139
    v_max3_u32 v6, v6, v140, v141
    v_max3_u32 v6, v6, v142, v143
    v_cmp_eq_u32 vcc, -1, v6
    s_nop 1
    s_cbranch_vccz L_spun_45
    s_add_u32 s63, s63, 1
    s_cmp_ge_u32 s63, 65536
    s_cbranch_scc1 L_spun_45
    s_branch L_spin_44
L_spun_45:
    v_add_f32 v112, v112, v128
    v_add_f32 v113, v113, v129
    v_add_f32 v114, v114, v130
    v_add_f32 v115, v115, v131
    v_add_f32 v116, v116, v132
    v_add_f32 v117, v117, v133
    v_add_f32 v118, v118, v134
    v_add_f32 v119, v119, v135
    v_add_f32 v120, v120, v136
    v_add_f32 v121, v121, v137
    v_add_f32 v122, v122, v138
    v_add_f32 v123, v123, v139
    v_add_f32 v124, v124, v140
    v_add_f32 v125, v125, v141
    v_add_f32 v126, v126, v142
    v_add_f32 v127, v127, v143
    v_add_f32 v112, v112, v120
    v_add_f32 v113, v113, v121
    v_add_f32 v114, v114, v122
    v_add_f32 v115, v115, v123
    v_add_f32 v116, v116, v124
    v_add_f32 v117, v117, v125
    v_add_f32 v118, v118, v126
    v_add_f32 v119, v119, v127
    v_add_f32 v112, v112, v116
    v_add_f32 v113, v113, v117
    v_add_f32 v114, v114, v118
    v_add_f32 v115, v115, v119
    v_cvt_pk_bf16_f32 v116, v112, v113
    v_cvt_pk_bf16_f32 v117, v114, v115
    v_lshlrev_b32 v3, 3, v1
    v_cmp_gt_u32 vcc, 48, v1
    s_and_saveexec_b64 s[4:5], vcc
    s_cbranch_execz L_m_46
    ds_write_b64 v3, v[116:117] offset:6400
L_m_46:
    s_mov_b64 exec, s[4:5]
    s_waitcnt lgkmcnt(0)
    s_cmp_eq_u32 s92, 0
    s_cbranch_scc1 L_dffn_47
    s_cmp_lg_u32 s92, 1
    s_cbranch_scc1 L_dend_48
    s_mov_b32 s80, s24
    s_mov_b32 s81, s25
    s_mov_b32 s82, 7864320
    s_mov_b32 s83, 0x20000
    v_lshrrev_b32 v3, 3, v0
    v_mul_u32_u24 v3, 1280, v3
    v_and_b32 v4, 7, v0
    v_lshl_add_u32 v3, v4, 4, v3
    s_mul_i32 s97, s94, 491520
    s_lshl_b32 s98, s95, 7
    s_add_u32 s97, s97, s98
    s_lshl_b32 s99, s3, 10
    s_add_u32 s99, s99, 24576
    s_mov_b32 m0, s99
    s_nop 0
    buffer_load_dwordx4 v3, s[80:83], s97 offen nt lds
    s_add_u32 s97, s97, 81920
    s_add_u32 s99, s99, 8192
    s_mov_b32 m0, s99
    s_nop 0
    buffer_load_dwordx4 v3, s[80:83], s97 offen nt lds
    s_add_u32 s97, s97, 81920
    s_add_u32 s99, s99, 8192
    s_mov_b32 m0, s99
    s_nop 0
    buffer_load_dwordx4 v3, s[80:83], s97 offen nt lds
    s_add_u32 s97, s97, 81920
    s_add_u32 s99, s99, 8192
    s_mov_b32 m0, s99
    s_nop 0
    buffer_load_dwordx4 v3, s[80:83], s97 offen nt lds
    s_add_u32 s97, s97, 81920
    s_add_u32 s99, s99, 8192
    s_mov_b32 m0, s99
    s_nop 0
    buffer_load_dwordx4 v3, s[80:83], s97 offen nt lds
    s_add_u32 s97, s97, 81920
    s_add_u32 s99, s99, 8192
    s_mov_b32 m0, s99
    s_nop 0
    buffer_load_dwordx4 v3, s[80:83], s97 offen nt lds
    s_add_u32 s97, s97, 81920
    s_add_u32 s99, s99, 8192
    s_branch L_dend_48
L_dffn_47:
    s_mov_b32 s80, s28
    s_mov_b32 s81, s29
    s_mov_b32 s82, 1966080
    s_mov_b32 s83, 0x20000
    s_cmp_ge_u32 s3, 4
    s_cbranch_scc1 L_sk_49
    s_branch L_j_50
L_sk_49:
    s_mov_b32 s80, s30
    s_mov_b32 s81, s31
L_j_50:
    v_lshrrev_b32 v3, 2, v0
    v_and_b32 v3, 63, v3
    v_mul_u32_u24 v3, 3072, v3
    v_and_b32 v4, 3, v0
    v_lshl_add_u32 v3, v4, 4, v3
    s_lshl_b32 s97, s93, 6
    s_lshl_b32 s99, s3, 10
    s_add_u32 s99, s99, 24576
    s_mov_b32 m0, s99
    s_nop 0
    buffer_load_dwordx4 v3, s[80:83], s97 offen nt lds
    s_add_u32 s97, s97, 196608
    s_add_u32 s99, s99, 8192
    s_mov_b32 m0, s99
    s_nop 0
    buffer_load_dwordx4 v3, s[80:83], s97 offen nt lds
    s_add_u32 s97, s97, 196608
    s_add_u32 s99, s99, 8192
    s_mov_b32 m0, s99
    s_nop 0
    buffer_load_dwordx4 v3, s[80:83], s97 offen nt lds
    s_add_u32 s97, s97, 196608
    s_add_u32 s99, s99, 8192
    s_mov_b32 m0, s99
    s_nop 0
    buffer_load_dwordx4 v3, s[80:83], s97 offen nt lds
    s_add_u32 s97, s97, 196608
    s_add_u32 s99, s99, 8192
    s_mov_b32 m0, s99
    s_nop 0
    buffer_load_dwordx4 v3, s[80:83], s97 offen nt lds
    s_add_u32 s97, s97, 196608
    s_add_u32 s99, s99, 8192
    s_mov_b32 m0, s99
    s_nop 0
    buffer_load_dwordx4 v3, s[80:83], s97 offen nt lds
    s_add_u32 s97, s97, 196608
    s_add_u32 s99, s99, 8192
    s_mov_b32 m0, s99
    s_nop 0
    buffer_load_dwordx4 v3, s[80:83], s97 offen nt lds
    s_add_u32 s97, s97, 196608
    s_add_u32 s99, s99, 8192
    s_mov_b32 m0, s99
    s_nop 0
    buffer_load_dwordx4 v3, s[80:83], s97 offen nt lds
    s_add_u32 s97, s97, 196608
    s_add_u32 s99, s99, 8192
    s_mov_b32 m0, s99
    s_nop 0
    buffer_load_dwordx4 v3, s[80:83], s97 offen nt lds
    s_add_u32 s97, s97, 196608
    s_add_u32 s99, s99, 8192
    s_mov_b32 m0, s99
    s_nop 0
    buffer_load_dwordx4 v3, s[80:83], s97 offen nt lds
    s_add_u32 s97, s97, 196608
    s_add_u32 s99, s99, 8192
    s_cmp_ge_u32 s3, 5
    s_cbranch_scc1 L_sk_51
    s_mov_b32 s80, s32
    s_mov_b32 s81, s33
    s_mov_b32 s82, 1966080
    s_mov_b32 s83, 0x20000
    v_mul_u32_u24 v3, 205, v0
    v_lshrrev_b32 v3, 14, v3
    v_mul_u32_u24 v4, 80, v3
    v_sub_u32 v4, v0, v4
    v_mul_u32_u24 v3, 1280, v3
    v_lshl_add_u32 v3, v4, 4, v3
    s_mul_i32 s97, s93, 40960
    s_lshl_b32 s99, s3, 10
    s_add_u32 s99, s99, 106496
    s_mov_b32 m0, s99
    s_nop 0
    buffer_load_dwordx4 v3, s[80:83], s97 offen nt lds
    s_add_u32 s97, s97, 5120
    s_add_u32 s99, s99, 5120
    s_mov_b32 m0, s99
    s_nop 0
    buffer_load_dwordx4 v3, s[80:83], s97 offen nt lds
    s_add_u32 s97, s97, 5120
    s_add_u32 s99, s99, 5120
    s_mov_b32 m0, s99
    s_nop 0
    buffer_load_dwordx4 v3, s[80:83], s97 offen nt lds
    s_add_u32 s97, s97, 5120
    s_add_u32 s99, s99, 5120
    s_mov_b32 m0, s99
    s_nop 0
    buffer_load_dwordx4 v3, s[80:83], s97 offen nt lds
    s_add_u32 s97, s97, 5120
    s_add_u32 s99, s99, 5120
    s_mov_b32 m0, s99
    s_nop 0
    buffer_load_dwordx4 v3, s[80:83], s97 offen nt lds
    s_add_u32 s97, s97, 5120
    s_add_u32 s99, s99, 5120
    s_mov_b32 m0, s99
    s_nop 0
    buffer_load_dwordx4 v3, s[80:83], s97 offen nt lds
    s_add_u32 s97, s97, 5120
    s_add_u32 s99, s99, 5120
    s_mov_b32 m0, s99
    s_nop 0
    buffer_load_dwordx4 v3, s[80:83], s97 offen nt lds
    s_add_u32 s97, s97, 5120
    s_add_u32 s99, s99, 5120
    s_mov_b32 m0, s99
    s_nop 0
    buffer_load_dwordx4 v3, s[80:83], s97 offen nt lds
    s_add_u32 s97, s97, 5120
    s_add_u32 s99, s99, 5120
L_sk_51:
L_dend_48:
    buffer_load_dwordx4 v[64:67], v2, s[48:51], s60 offen offset:0 nt
    buffer_load_dwordx4 v[68:71], v2, s[48:51], s60 offen offset:128 nt
    buffer_load_dwordx4 v[72:75], v2, s[48:51], s60 offen offset:256 nt
    s_add_u32 s60, s60, 24576
    buffer_load_dwordx4 v[76:79], v2, s[48:51], s60 offen offset:0 nt
    buffer_load_dwordx4 v[80:83], v2, s[48:51], s60 offen offset:128 nt
    buffer_load_dwordx4 v[84:87], v2, s[48:51], s60 offen offset:256 nt
    s_add_u32 s60, s60, 24576
    buffer_load_dwordx4 v[88:91], v2, s[48:51], s60 offen offset:0 nt
    buffer_load_dwordx4 v[92:95], v2, s[48:51], s60 offen offset:128 nt
    buffer_load_dwordx4 v[96:99], v2, s[48:51], s60 offen offset:256 nt
    s_add_u32 s60, s60, 24576
    buffer_load_dwordx4 v[100:103], v2, s[48:51], s60 offen offset:0 nt
    buffer_load_dwordx4 v[104:107], v2, s[48:51], s60 offen offset:128 nt
    buffer_load_dwordx4 v[108:111], v2, s[48:51], s60 offen offset:256 nt
    s_add_u32 s60, s60, 24576
    buffer_load_dwordx4 v[112:115], v2, s[48:51], s60 offen offset:0 nt
    buffer_load_dwordx4 v[116:119], v2, s[48:51], s60 offen offset:128 nt
    buffer_load_dwordx4 v[120:123], v2, s[48:51], s60 offen offset:256 nt
    s_add_u32 s60, s60, 24576
    buffer_load_dwordx4 v[124:127], v2, s[48:51], s60 offen offset:0 nt
    buffer_load_dwordx4 v[128:131], v2, s[48:51], s60 offen offset:128 nt
    buffer_load_dwordx4 v[132:135], v2, s[48:51], s60 offen offset:256 nt
    s_add_u32 s60, s60, 24576
    buffer_load_dwordx4 v[136:139], v2, s[48:51], s60 offen offset:0 nt
    buffer_load_dwordx4 v[140:143], v2, s[48:51], s60 offen offset:128 nt
    buffer_load_dwordx4 v[144:147], v2, s[48:51], s60 offen offset:256 nt
    s_add_u32 s60, s60, 24576
    buffer_load_dwordx4 v[148:151], v2, s[48:51], s60 offen offset:0 nt
    buffer_load_dwordx4 v[152:155], v2, s[48:51], s60 offen offset:128 nt
    buffer_load_dwordx4 v[156:159], v2, s[48:51], s60 offen offset:256 nt
    s_add_u32 s60, s60, 24576
    buffer_load_dwordx4 v[160:163], v2, s[48:51], s60 offen offset:0 nt
    buffer_load_dwordx4 v[164:167], v2, s[48:51], s60 offen offset:128 nt
    buffer_load_dwordx4 v[168:171], v2, s[48:51], s60 offen offset:256 nt
    s_add_u32 s60, s60, 24576
    buffer_load_dwordx4 v[172:175], v2, s[48:51], s60 offen offset:0 nt
    buffer_load_dwordx4 v[176:179], v2, s[48:51], s60 offen offset:128 nt
    buffer_load_dwordx4 v[180:183], v2, s[48:51], s60 offen offset:256 nt
    s_add_u32 s60, s60, 24576
    buffer_load_dwordx4 v[184:187], v2, s[48:51], s60 offen offset:0 nt
    buffer_load_dwordx4 v[188:191], v2, s[48:51], s60 offen offset:128 nt
    buffer_load_dwordx4 v[192:195], v2, s[48:51], s60 offen offset:256 nt
    s_add_u32 s60, s60, 24576
    buffer_load_dwordx4 v[196:199], v2, s[48:51], s60 offen offset:0 nt
    buffer_load_dwordx4 v[200:203], v2, s[48:51], s60 offen offset:128 nt
    buffer_load_dwordx4 v[204:207], v2, s[48:51], s60 offen offset:256 nt
    s_add_u32 s60, s60, 24576
    buffer_load_dwordx4 v[208:211], v2, s[48:51], s60 offen offset:0 nt
    buffer_load_dwordx4 v[212:215], v2, s[48:51], s60 offen offset:128 nt
    buffer_load_dwordx4 v[216:219], v2, s[48:51], s60 offen offset:256 nt
    s_add_u32 s60, s60, 24576
    buffer_load_dwordx4 v[220:223], v2, s[48:51], s60 offen offset:0 nt
    buffer_load_dwordx4 v[224:227], v2, s[48:51], s60 offen offset:128 nt
    buffer_load_dwordx4 v[228:231], v2, s[48:51], s60 offen offset:256 nt
    s_add_u32 s60, s60, 24576
    buffer_load_dwordx4 v[232:235], v2, s[48:51], s60 offen offset:0 nt
    buffer_load_dwordx4 v[236:239], v2, s[48:51], s60 offen offset:128 nt
    buffer_load_dwordx4 v[240:243], v2, s[48:51], s60 offen offset:256 nt
    s_add_u32 s60, s60, 24576
    buffer_load_dwordx4 v[244:247], v2, s[48:51], s60 offen offset:0 nt
    buffer_load_dwordx4 v[248:251], v2, s[48:51], s60 offen offset:128 nt
    buffer_load_dwordx4 v[252:255], v2, s[48:51], s60 offen offset:256 nt
    s_add_u32 s60, s60, 24576
L_nw0_42:
    s_barrier
    v_and_b32 v3, 7, v1
    v_lshlrev_b32 v3, 4, v3
    ds_read_b128 v[16:19], v3 offset:6400
    ds_read_b128 v[20:23], v3 offset:6528
    ds_read_b128 v[24:27], v3 offset:6656
    s_waitcnt lgkmcnt(0)
    s_waitcnt vmcnt(36)
    v_dot2_f32_bf16 v37, v64, v16, 0
    v_dot2_f32_bf16 v38, v68, v20, 0
    v_dot2_f32_bf16 v39, v72, v24, 0
    v_dot2_f32_bf16 v40, v76, v16, 0
    v_dot2_f32_bf16 v41, v80, v20, 0
    v_dot2_f32_bf16 v42, v84, v24, 0
    v_dot2_f32_bf16 v43, v88, v16, 0
    v_dot2_f32_bf16 v44, v92, v20, 0
    v_dot2_f32_bf16 v45, v96, v24, 0
    v_dot2_f32_bf16 v46, v100, v16, 0
    v_dot2_f32_bf16 v47, v104, v20, 0
    v_dot2_f32_bf16 v48, v108, v24, 0
    v_dot2c_f32_bf16 v37, v65, v17
    v_dot2c_f32_bf16 v38, v69, v21
    v_dot2c_f32_bf16 v39, v73, v25
    v_dot2c_f32_bf16 v40, v77, v17
    v_dot2c_f32_bf16 v41, v81, v21
    v_dot2c_f32_bf16 v42, v85, v25
    v_dot2c_f32_bf16 v43, v89, v17
    v_dot2c_f32_bf16 v44, v93, v21
    v_dot2c_f32_bf16 v45, v97, v25
    v_dot2c_f32_bf16 v46, v101, v17
    v_dot2c_f32_bf16 v47, v105, v21
    v_dot2c_f32_bf16 v48, v109, v25
    v_dot2c_f32_bf16 v37, v66, v18
    v_dot2c_f32_bf16 v38, v70, v22
    v_dot2c_f32_bf16 v39, v74, v26
    v_dot2c_f32_bf16 v40, v78, v18
    v_dot2c_f32_bf16 v41, v82, v22
    v_dot2c_f32_bf16 v42, v86, v26
    v_dot2c_f32_bf16 v43, v90, v18
    v_dot2c_f32_bf16 v44, v94, v22
    v_dot2c_f32_bf16 v45, v98, v26
    v_dot2c_f32_bf16 v46, v102, v18
    v_dot2c_f32_bf16 v47, v106, v22
    v_dot2c_f32_bf16 v48, v110, v26
    v_dot2c_f32_bf16 v37, v67, v19
    v_dot2c_f32_bf16 v38, v71, v23
    v_dot2c_f32_bf16 v39, v75, v27
    v_dot2c_f32_bf16 v40, v79, v19
    v_dot2c_f32_bf16 v41, v83, v23
    v_dot2c_f32_bf16 v42, v87, v27
    v_dot2c_f32_bf16 v43, v91, v19
    v_dot2c_f32_bf16 v44, v95, v23
    v_dot2c_f32_bf16 v45, v99, v27
    v_dot2c_f32_bf16 v46, v103, v19
    v_dot2c_f32_bf16 v47, v107, v23
    v_dot2c_f32_bf16 v48, v111, v27
    buffer_load_dwordx4 v[64:67], v2, s[48:51], s60 offen offset:0 nt
    buffer_load_dwordx4 v[68:71], v2, s[48:51], s60 offen offset:128 nt
    buffer_load_dwordx4 v[72:75], v2, s[48:51], s60 offen offset:256 nt
    s_add_u32 s60, s60, 24576
    buffer_load_dwordx4 v[76:79], v2, s[48:51], s60 offen offset:0 nt
    buffer_load_dwordx4 v[80:83], v2, s[48:51], s60 offen offset:128 nt
    buffer_load_dwordx4 v[84:87], v2, s[48:51], s60 offen offset:256 nt
    s_add_u32 s60, s60, 24576
    buffer_load_dwordx4 v[88:91], v2, s[48:51], s60 offen offset:0 nt
    buffer_load_dwordx4 v[92:95], v2, s[48:51], s60 offen offset:128 nt
    buffer_load_dwordx4 v[96:99], v2, s[48:51], s60 offen offset:256 nt
    s_add_u32 s60, s60, 24576
    buffer_load_dwordx4 v[100:103], v2, s[48:51], s60 offen offset:0 nt
    buffer_load_dwordx4 v[104:107], v2, s[48:51], s60 offen offset:128 nt
    buffer_load_dwordx4 v[108:111], v2, s[48:51], s60 offen offset:256 nt
    s_add_u32 s60, s60, 24576
    v_add_f32 v37, v37, v38
    v_add_f32 v40, v40, v41
    v_add_f32 v43, v43, v44
    v_add_f32 v46, v46, v47
    v_add_f32 v37, v37, v39
    v_add_f32 v40, v40, v42
    v_add_f32 v43, v43, v45
    v_add_f32 v46, v46, v48
    v_add_f32_dpp v37, v37, v37 quad_perm:[1,0,3,2] row_mask:0xf bank_mask:0xf
    v_add_f32_dpp v40, v40, v40 quad_perm:[1,0,3,2] row_mask:0xf bank_mask:0xf
    v_add_f32_dpp v43, v43, v43 quad_perm:[1,0,3,2] row_mask:0xf bank_mask:0xf
    v_add_f32_dpp v46, v46, v46 quad_perm:[1,0,3,2] row_mask:0xf bank_mask:0xf
    v_add_f32_dpp v37, v37, v37 quad_perm:[2,3,0,1] row_mask:0xf bank_mask:0xf
    v_add_f32_dpp v40, v40, v40 quad_perm:[2,3,0,1] row_mask:0xf bank_mask:0xf
    v_add_f32_dpp v43, v43, v43 quad_perm:[2,3,0,1] row_mask:0xf bank_mask:0xf
    v_add_f32_dpp v46, v46, v46 quad_perm:[2,3,0,1] row_mask:0xf bank_mask:0xf
    v_add_f32_dpp v37, v37, v37 row_half_mirror row_mask:0xf bank_mask:0xf
    v_add_f32_dpp v40, v40, v40 row_half_mirror row_mask:0xf bank_mask:0xf
    v_add_f32_dpp v43, v43, v43 row_half_mirror row_mask:0xf bank_mask:0xf
    v_add_f32_dpp v46, v46, v46 row_half_mirror row_mask:0xf bank_mask:0xf
    v_cndmask_b32 v49, v49, v37, s[64:65]
    v_cndmask_b32 v49, v49, v40, s[66:67]
    v_cndmask_b32 v49, v49, v43, s[68:69]
    v_cndmask_b32 v49, v49, v46, s[70:71]
    s_waitcnt vmcnt(36)
    v_dot2_f32_bf16 v37, v112, v16, 0
    v_dot2_f32_bf16 v38, v116, v20, 0
    v_dot2_f32_bf16 v39, v120, v24, 0
    v_dot2_f32_bf16 v40, v124, v16, 0
    v_dot2_f32_bf16 v41, v128, v20, 0
    v_dot2_f32_bf16 v42, v132, v24, 0
    v_dot2_f32_bf16 v43, v136, v16, 0
    v_dot2_f32_bf16 v44, v140, v20, 0
    v_dot2_f32_bf16 v45, v144, v24, 0
    v_dot2_f32_bf16 v46, v148, v16, 0
    v_dot2_f32_bf16 v47, v152, v20, 0
    v_dot2_f32_bf16 v48, v156, v24, 0
    v_dot2c_f32_bf16 v37, v113, v17
    v_dot2c_f32_bf16 v38, v117, v21
    v_dot2c_f32_bf16 v39, v121, v25
    v_dot2c_f32_bf16 v40, v125, v17
    v_dot2c_f32_bf16 v41, v129, v21
    v_dot2c_f32_bf16 v42, v133, v25
    v_dot2c_f32_bf16 v43, v137, v17
    v_dot2c_f32_bf16 v44, v141, v21
    v_dot2c_f32_bf16 v45, v145, v25
    v_dot2c_f32_bf16 v46, v149, v17
    v_dot2c_f32_bf16 v47, v153, v21
    v_dot2c_f32_bf16 v48, v157, v25
    v_dot2c_f32_bf16 v37, v114, v18
    v_dot2c_f32_bf16 v38, v118, v22
    v_dot2c_f32_bf16 v39, v122, v26
    v_dot2c_f32_bf16 v40, v126, v18
    v_dot2c_f32_bf16 v41, v130, v22
    v_dot2c_f32_bf16 v42, v134, v26
    v_dot2c_f32_bf16 v43, v138, v18
    v_dot2c_f32_bf16 v44, v142, v22
    v_dot2c_f32_bf16 v45, v146, v26
    v_dot2c_f32_bf16 v46, v150, v18
    v_dot2c_f32_bf16 v47, v154, v22
    v_dot2c_f32_bf16 v48, v158, v26
    v_dot2c_f32_bf16 v37, v115, v19
    v_dot2c_f32_bf16 v38, v119, v23
    v_dot2c_f32_bf16 v39, v123, v27
    v_dot2c_f32_bf16 v40, v127, v19
    v_dot2c_f32_bf16 v41, v131, v23
    v_dot2c_f32_bf16 v42, v135, v27
    v_dot2c_f32_bf16 v43, v139, v19
    v_dot2c_f32_bf16 v44, v143, v23
    v_dot2c_f32_bf16 v45, v147, v27
    v_dot2c_f32_bf16 v46, v151, v19
    v_dot2c_f32_bf16 v47, v155, v23
    v_dot2c_f32_bf16 v48, v159, v27
    buffer_load_dwordx4 v[112:115], v2, s[48:51], s60 offen offset:0 nt
    buffer_load_dwordx4 v[116:119], v2, s[48:51], s60 offen offset:128 nt
    buffer_load_dwordx4 v[120:123], v2, s[48:51], s60 offen offset:256 nt
    s_add_u32 s60, s60, 24576
    buffer_load_dwordx4 v[124:127], v2, s[48:51], s60 offen offset:0 nt
    buffer_load_dwordx4 v[128:131], v2, s[48:51], s60 offen offset:128 nt
    buffer_load_dwordx4 v[132:135], v2, s[48:51], s60 offen offset:256 nt
    s_add_u32 s60, s60, 24576
    buffer_load_dwordx4 v[136:139], v2, s[48:51], s60 offen offset:0 nt
    buffer_load_dwordx4 v[140:143], v2, s[48:51], s60 offen offset:128 nt
    buffer_load_dwordx4 v[144:147], v2, s[48:51], s60 offen offset:256 nt
    s_add_u32 s60, s60, 24576
    buffer_load_dwordx4 v[148:151], v2, s[48:51], s60 offen offset:0 nt
    buffer_load_dwordx4 v[152:155], v2, s[48:51], s60 offen offset:128 nt
    buffer_load_dwordx4 v[156:159], v2, s[48:51], s60 offen offset:256 nt
    s_add_u32 s60, s60, 24576
    v_add_f32 v37, v37, v38
    v_add_f32 v40, v40, v41
    v_add_f32 v43, v43, v44
    v_add_f32 v46, v46, v47
    v_add_f32 v37, v37, v39
    v_add_f32 v40, v40, v42
    v_add_f32 v43, v43, v45
    v_add_f32 v46, v46, v48
    v_add_f32_dpp v37, v37, v37 quad_perm:[1,0,3,2] row_mask:0xf bank_mask:0xf
    v_add_f32_dpp v40, v40, v40 quad_perm:[1,0,3,2] row_mask:0xf bank_mask:0xf
    v_add_f32_dpp v43, v43, v43 quad_perm:[1,0,3,2] row_mask:0xf bank_mask:0xf
    v_add_f32_dpp v46, v46, v46 quad_perm:[1,0,3,2] row_mask:0xf bank_mask:0xf
    v_add_f32_dpp v37, v37, v37 quad_perm:[2,3,0,1] row_mask:0xf bank_mask:0xf
    v_add_f32_dpp v40, v40, v40 quad_perm:[2,3,0,1] row_mask:0xf bank_mask:0xf
    v_add_f32_dpp v43, v43, v43 quad_perm:[2,3,0,1] row_mask:0xf bank_mask:0xf
    v_add_f32_dpp v46, v46, v46 quad_perm:[2,3,0,1] row_mask:0xf bank_mask:0xf
    v_add_f32_dpp v37, v37, v37 row_half_mirror row_mask:0xf bank_mask:0xf
    v_add_f32_dpp v40, v40, v40 row_half_mirror row_mask:0xf bank_mask:0xf
    v_add_f32_dpp v43, v43, v43 row_half_mirror row_mask:0xf bank_mask:0xf
    v_add_f32_dpp v46, v46, v46 row_half_mirror row_mask:0xf bank_mask:0xf
    v_cndmask_b32 v49, v49, v37, s[72:73]
    v_cndmask_b32 v49, v49, v40, s[74:75]
    v_cndmask_b32 v49, v49, v43, s[76:77]
    v_cndmask_b32 v49, v49, v46, s[78:79]
    v_cvt_pk_bf16_f32 v50, v49, v49
    v_and_b32 v50, 0xffff0000, v50
    v_mul_f32 v50, 0x3d93cd3a, v50
    v_cvt_pk_bf16_f32 v28, v50, v50
    v_and_b32 v28, 0xffff0000, v28
    s_waitcnt vmcnt(36)
    v_dot2_f32_bf16 v37, v160, v16, 0
    v_dot2_f32_bf16 v38, v164, v20, 0
    v_dot2_f32_bf16 v39, v168, v24, 0
    v_dot2_f32_bf16 v40, v172, v16, 0
    v_dot2_f32_bf16 v41, v176, v20, 0
    v_dot2_f32_bf16 v42, v180, v24, 0
    v_dot2_f32_bf16 v43, v184, v16, 0
    v_dot2_f32_bf16 v44, v188, v20, 0
    v_dot2_f32_bf16 v45, v192, v24, 0
    v_dot2_f32_bf16 v46, v196, v16, 0
    v_dot2_f32_bf16 v47, v200, v20, 0
    v_dot2_f32_bf16 v48, v204, v24, 0
    v_dot2c_f32_bf16 v37, v161, v17
    v_dot2c_f32_bf16 v38, v165, v21
    v_dot2c_f32_bf16 v39, v169, v25
    v_dot2c_f32_bf16 v40, v173, v17
    v_dot2c_f32_bf16 v41, v177, v21
    v_dot2c_f32_bf16 v42, v181, v25
    v_dot2c_f32_bf16 v43, v185, v17
    v_dot2c_f32_bf16 v44, v189, v21
    v_dot2c_f32_bf16 v45, v193, v25
    v_dot2c_f32_bf16 v46, v197, v17
    v_dot2c_f32_bf16 v47, v201, v21
    v_dot2c_f32_bf16 v48, v205, v25
    v_dot2c_f32_bf16 v37, v162, v18
    v_dot2c_f32_bf16 v38, v166, v22
    v_dot2c_f32_bf16 v39, v170, v26
    v_dot2c_f32_bf16 v40, v174, v18
    v_dot2c_f32_bf16 v41, v178, v22
    v_dot2c_f32_bf16 v42, v182, v26
    v_dot2c_f32_bf16 v43, v186, v18
    v_dot2c_f32_bf16 v44, v190, v22
    v_dot2c_f32_bf16 v45, v194, v26
    v_dot2c_f32_bf16 v46, v198, v18
    v_dot2c_f32_bf16 v47, v202, v22
    v_dot2c_f32_bf16 v48, v206, v26
    v_dot2c_f32_bf16 v37, v163, v19
    v_dot2c_f32_bf16 v38, v167, v23
    v_dot2c_f32_bf16 v39, v171, v27
    v_dot2c_f32_bf16 v40, v175, v19
    v_dot2c_f32_bf16 v41, v179, v23
    v_dot2c_f32_bf16 v42, v183, v27
    v_dot2c_f32_bf16 v43, v187, v19
    v_dot2c_f32_bf16 v44, v191, v23
    v_dot2c_f32_bf16 v45, v195, v27
    v_dot2c_f32_bf16 v46, v199, v19
    v_dot2c_f32_bf16 v47, v203, v23
    v_dot2c_f32_bf16 v48, v207, v27
    buffer_load_dwordx4 v[160:163], v2, s[48:51], s60 offen offset:0 nt
    buffer_load_dwordx4 v[164:167], v2, s[48:51], s60 offen offset:128 nt
    buffer_load_dwordx4 v[168:171], v2, s[48:51], s60 offen offset:256 nt
    s_add_u32 s60, s60, 24576
    buffer_load_dwordx4 v[172:175], v2, s[48:51], s60 offen offset:0 nt
    buffer_load_dwordx4 v[176:179], v2, s[48:51], s60 offen offset:128 nt
    buffer_load_dwordx4 v[180:183], v2, s[48:51], s60 offen offset:256 nt
    s_add_u32 s60, s60, 24576
    buffer_load_dwordx4 v[184:187], v2, s[48:51], s60 offen offset:0 nt
    buffer_load_dwordx4 v[188:191], v2, s[48:51], s60 offen offset:128 nt
    buffer_load_dwordx4 v[192:195], v2, s[48:51], s60 offen offset:256 nt
    s_add_u32 s60, s60, 24576
    buffer_load_dwordx4 v[196:199], v2, s[48:51], s60 offen offset:0 nt
    buffer_load_dwordx4 v[200:203], v2, s[48:51], s60 offen offset:128 nt
    buffer_load_dwordx4 v[204:207], v2, s[48:51], s60 offen offset:256 nt
    s_add_u32 s60, s60, 24576
    v_add_f32 v37, v37, v38
    v_add_f32 v40, v40, v41
    v_add_f32 v43, v43, v44
    v_add_f32 v46, v46, v47
    v_add_f32 v37, v37, v39
    v_add_f32 v40, v40, v42
    v_add_f32 v43, v43, v45
    v_add_f32 v46, v46, v48
    v_add_f32_dpp v37, v37, v37 quad_perm:[1,0,3,2] row_mask:0xf bank_mask:0xf
    v_add_f32_dpp v40, v40, v40 quad_perm:[1,0,3,2] row_mask:0xf bank_mask:0xf
    v_add_f32_dpp v43, v43, v43 quad_perm:[1,0,3,2] row_mask:0xf bank_mask:0xf
    v_add_f32_dpp v46, v46, v46 quad_perm:[1,0,3,2] row_mask:0xf bank_mask:0xf
    v_add_f32_dpp v37, v37, v37 quad_perm:[2,3,0,1] row_mask:0xf bank_mask:0xf
    v_add_f32_dpp v40, v40, v40 quad_perm:[2,3,0,1] row_mask:0xf bank_mask:0xf
    v_add_f32_dpp v43, v43, v43 quad_perm:[2,3,0,1] row_mask:0xf bank_mask:0xf
    v_add_f32_dpp v46, v46, v46 quad_perm:[2,3,0,1] row_mask:0xf bank_mask:0xf
    v_add_f32_dpp v37, v37, v37 row_half_mirror row_mask:0xf bank_mask:0xf
    v_add_f32_dpp v40, v40, v40 row_half_mirror row_mask:0xf bank_mask:0xf
    v_add_f32_dpp v43, v43, v43 row_half_mirror row_mask:0xf bank_mask:0xf
    v_add_f32_dpp v46, v46, v46 row_half_mirror row_mask:0xf bank_mask:0xf
    v_cndmask_b32 v49, v49, v37, s[64:65]
    v_cndmask_b32 v49, v49, v40, s[66:67]
    v_cndmask_b32 v49, v49, v43, s[68:69]
    v_cndmask_b32 v49, v49, v46, s[70:71]
    s_waitcnt vmcnt(36)
    v_dot2_f32_bf16 v37, v208, v16, 0
    v_dot2_f32_bf16 v38, v212, v20, 0
    v_dot2_f32_bf16 v39, v216, v24, 0
    v_dot2_f32_bf16 v40, v220, v16, 0
    v_dot2_f32_bf16 v41, v224, v20, 0
    v_dot2_f32_bf16 v42, v228, v24, 0
    v_dot2_f32_bf16 v43, v232, v16, 0
    v_dot2_f32_bf16 v44, v236, v20, 0
    v_dot2_f32_bf16 v45, v240, v24, 0
    v_dot2_f32_bf16 v46, v244, v16, 0
    v_dot2_f32_bf16 v47, v248, v20, 0
    v_dot2_f32_bf16 v48, v252, v24, 0
    v_dot2c_f32_bf16 v37, v209, v17
    v_dot2c_f32_bf16 v38, v213, v21
    v_dot2c_f32_bf16 v39, v217, v25
    v_dot2c_f32_bf16 v40, v221, v17
    v_dot2c_f32_bf16 v41, v225, v21
    v_dot2c_f32_bf16 v42, v229, v25
    v_dot2c_f32_bf16 v43, v233, v17
    v_dot2c_f32_bf16 v44, v237, v21
    v_dot2c_f32_bf16 v45, v241, v25
    v_dot2c_f32_bf16 v46, v245, v17
    v_dot2c_f32_bf16 v47, v249, v21
    v_dot2c_f32_bf16 v48, v253, v25
    v_dot2c_f32_bf16 v37, v210, v18
    v_dot2c_f32_bf16 v38, v214, v22
    v_dot2c_f32_bf16 v39, v218, v26
    v_dot2c_f32_bf16 v40, v222, v18
    v_dot2c_f32_bf16 v41, v226, v22
    v_dot2c_f32_bf16 v42, v230, v26
    v_dot2c_f32_bf16 v43, v234, v18
    v_dot2c_f32_bf16 v44, v238, v22
    v_dot2c_f32_bf16 v45, v242, v26
    v_dot2c_f32_bf16 v46, v246, v18
    v_dot2c_f32_bf16 v47, v250, v22
    v_dot2c_f32_bf16 v48, v254, v26
    v_dot2c_f32_bf16 v37, v211, v19
    v_dot2c_f32_bf16 v38, v215, v23
    v_dot2c_f32_bf16 v39, v219, v27
    v_dot2c_f32_bf16 v40, v223, v19
    v_dot2c_f32_bf16 v41, v227, v23
    v_dot2c_f32_bf16 v42, v231, v27
    v_dot2c_f32_bf16 v43, v235, v19
    v_dot2c_f32_bf16 v44, v239, v23
    v_dot2c_f32_bf16 v45, v243, v27
    v_dot2c_f32_bf16 v46, v247, v19
    v_dot2c_f32_bf16 v47, v251, v23
    v_dot2c_f32_bf16 v48, v255, v27
    buffer_load_dwordx4 v[208:211], v2, s[48:51], s60 offen offset:0 nt
    buffer_load_dwordx4 v[212:215], v2, s[48:51], s60 offen offset:128 nt
    buffer_load_dwordx4 v[216:219], v2, s[48:51], s60 offen offset:256 nt
    s_add_u32 s60, s60, 24576
    buffer_load_dwordx4 v[220:223], v2, s[48:51], s60 offen offset:0 nt
    buffer_load_dwordx4 v[224:227], v2, s[48:51], s60 offen offset:128 nt
    buffer_load_dwordx4 v[228:231], v2, s[48:51], s60 offen offset:256 nt
    s_add_u32 s60, s60, 24576
    buffer_load_dwordx4 v[232:235], v2, s[48:51], s60 offen offset:0 nt
    buffer_load_dwordx4 v[236:239], v2, s[48:51], s60 offen offset:128 nt
    buffer_load_dwordx4 v[240:243], v2, s[48:51], s60 offen offset:256 nt
    s_add_u32 s60, s60, 24576
    buffer_load_dwordx4 v[244:247], v2, s[48:51], s60 offen offset:0 nt
    buffer_load_dwordx4 v[248:251], v2, s[48:51], s60 offen offset:128 nt
    buffer_load_dwordx4 v[252:255], v2, s[48:51], s60 offen offset:256 nt
    s_add_u32 s60, s60, 24576
    v_add_f32 v37, v37, v38
    v_add_f32 v40, v40, v41
    v_add_f32 v43, v43, v44
    v_add_f32 v46, v46, v47
    v_add_f32 v37, v37, v39
    v_add_f32 v40, v40, v42
    v_add_f32 v43, v43, v45
    v_add_f32 v46, v46, v48
    v_add_f32_dpp v37, v37, v37 quad_perm:[1,0,3,2] row_mask:0xf bank_mask:0xf
    v_add_f32_dpp v40, v40, v40 quad_perm:[1,0,3,2] row_mask:0xf bank_mask:0xf
    v_add_f32_dpp v43, v43, v43 quad_perm:[1,0,3,2] row_mask:0xf bank_mask:0xf
    v_add_f32_dpp v46, v46, v46 quad_perm:[1,0,3,2] row_mask:0xf bank_mask:0xf
    v_add_f32_dpp v37, v37, v37 quad_perm:[2,3,0,1] row_mask:0xf bank_mask:0xf
    v_add_f32_dpp v40, v40, v40 quad_perm:[2,3,0,1] row_mask:0xf bank_mask:0xf
    v_add_f32_dpp v43, v43, v43 quad_perm:[2,3,0,1] row_mask:0xf bank_mask:0xf
    v_add_f32_dpp v46, v46, v46 quad_perm:[2,3,0,1] row_mask:0xf bank_mask:0xf
    v_add_f32_dpp v37, v37, v37 row_half_mirror row_mask:0xf bank_mask:0xf
    v_add_f32_dpp v40, v40, v40 row_half_mirror row_mask:0xf bank_mask:0xf
    v_add_f32_dpp v43, v43, v43 row_half_mirror row_mask:0xf bank_mask:0xf
    v_add_f32_dpp v46, v46, v46 row_half_mirror row_mask:0xf bank_mask:0xf
    v_cndmask_b32 v49, v49, v37, s[72:73]
    v_cndmask_b32 v49, v49, v40, s[74:75]
    v_cndmask_b32 v49, v49, v43, s[76:77]
    v_cndmask_b32 v49, v49, v46, s[78:79]
    v_cvt_pk_bf16_f32 v50, v49, v49
    v_and_b32 v50, 0xffff0000, v50
    v_mul_f32 v50, 0x3d93cd3a, v50
    v_cvt_pk_bf16_f32 v29, v50, v50
    v_and_b32 v29, 0xffff0000, v29
    s_waitcnt vmcnt(36)
    v_dot2_f32_bf16 v37, v64, v16, 0
    v_dot2_f32_bf16 v38, v68, v20, 0
    v_dot2_f32_bf16 v39, v72, v24, 0
    v_dot2_f32_bf16 v40, v76, v16, 0
    v_dot2_f32_bf16 v41, v80, v20, 0
    v_dot2_f32_bf16 v42, v84, v24, 0
    v_dot2_f32_bf16 v43, v88, v16, 0
    v_dot2_f32_bf16 v44, v92, v20, 0
    v_dot2_f32_bf16 v45, v96, v24, 0
    v_dot2_f32_bf16 v46, v100, v16, 0
    v_dot2_f32_bf16 v47, v104, v20, 0
    v_dot2_f32_bf16 v48, v108, v24, 0
    v_dot2c_f32_bf16 v37, v65, v17
    v_dot2c_f32_bf16 v38, v69, v21
    v_dot2c_f32_bf16 v39, v73, v25
    v_dot2c_f32_bf16 v40, v77, v17
    v_dot2c_f32_bf16 v41, v81, v21
    v_dot2c_f32_bf16 v42, v85, v25
    v_dot2c_f32_bf16 v43, v89, v17
    v_dot2c_f32_bf16 v44, v93, v21
    v_dot2c_f32_bf16 v45, v97, v25
    v_dot2c_f32_bf16 v46, v101, v17
    v_dot2c_f32_bf16 v47, v105, v21
    v_dot2c_f32_bf16 v48, v109, v25
    v_dot2c_f32_bf16 v37, v66, v18
    v_dot2c_f32_bf16 v38, v70, v22
    v_dot2c_f32_bf16 v39, v74, v26
    v_dot2c_f32_bf16 v40, v78, v18
    v_dot2c_f32_bf16 v41, v82, v22
    v_dot2c_f32_bf16 v42, v86, v26
    v_dot2c_f32_bf16 v43, v90, v18
    v_dot2c_f32_bf16 v44, v94, v22
    v_dot2c_f32_bf16 v45, v98, v26
    v_dot2c_f32_bf16 v46, v102, v18
    v_dot2c_f32_bf16 v47, v106, v22
    v_dot2c_f32_bf16 v48, v110, v26
    v_dot2c_f32_bf16 v37, v67, v19
    v_dot2c_f32_bf16 v38, v71, v23
    v_dot2c_f32_bf16 v39, v75, v27
    v_dot2c_f32_bf16 v40, v79, v19
    v_dot2c_f32_bf16 v41, v83, v23
    v_dot2c_f32_bf16 v42, v87, v27
    v_dot2c_f32_bf16 v43, v91, v19
    v_dot2c_f32_bf16 v44, v95, v23
    v_dot2c_f32_bf16 v45, v99, v27
    v_dot2c_f32_bf16 v46, v103, v19
    v_dot2c_f32_bf16 v47, v107, v23
    v_dot2c_f32_bf16 v48, v111, v27
    buffer_load_dwordx4 v[64:67], v2, s[48:51], s60 offen offset:0 nt
    buffer_load_dwordx4 v[68:71], v2, s[48:51], s60 offen offset:128 nt
    buffer_load_dwordx4 v[72:75], v2, s[48:51], s60 offen offset:256 nt
    s_add_u32 s60, s60, 24576
    buffer_load_dwordx4 v[76:79], v2, s[48:51], s60 offen offset:0 nt
    buffer_load_dwordx4 v[80:83], v2, s[48:51], s60 offen offset:128 nt
    buffer_load_dwordx4 v[84:87], v2, s[48:51], s60 offen offset:256 nt
    s_add_u32 s60, s60, 24576
    buffer_load_dwordx4 v[88:91], v2, s[48:51], s60 offen offset:0 nt
    buffer_load_dwordx4 v[92:95], v2, s[48:51], s60 offen offset:128 nt
    buffer_load_dwordx4 v[96:99], v2, s[48:51], s60 offen offset:256 nt
    s_add_u32 s60, s60, 24576
    buffer_load_dwordx4 v[100:103], v2, s[48:51], s60 offen offset:0 nt
    buffer_load_dwordx4 v[104:107], v2, s[48:51], s60 offen offset:128 nt
    buffer_load_dwordx4 v[108:111], v2, s[48:51], s60 offen offset:256 nt
    s_add_u32 s60, s60, 24576
    v_add_f32 v37, v37, v38
    v_add_f32 v40, v40, v41
    v_add_f32 v43, v43, v44
    v_add_f32 v46, v46, v47
    v_add_f32 v37, v37, v39
    v_add_f32 v40, v40, v42
    v_add_f32 v43, v43, v45
    v_add_f32 v46, v46, v48
    v_add_f32_dpp v37, v37, v37 quad_perm:[1,0,3,2] row_mask:0xf bank_mask:0xf
    v_add_f32_dpp v40, v40, v40 quad_perm:[1,0,3,2] row_mask:0xf bank_mask:0xf
    v_add_f32_dpp v43, v43, v43 quad_perm:[1,0,3,2] row_mask:0xf bank_mask:0xf
    v_add_f32_dpp v46, v46, v46 quad_perm:[1,0,3,2] row_mask:0xf bank_mask:0xf
    v_add_f32_dpp v37, v37, v37 quad_perm:[2,3,0,1] row_mask:0xf bank_mask:0xf
    v_add_f32_dpp v40, v40, v40 quad_perm:[2,3,0,1] row_mask:0xf bank_mask:0xf
    v_add_f32_dpp v43, v43, v43 quad_perm:[2,3,0,1] row_mask:0xf bank_mask:0xf
    v_add_f32_dpp v46, v46, v46 quad_perm:[2,3,0,1] row_mask:0xf bank_mask:0xf
    v_add_f32_dpp v37, v37, v37 row_half_mirror row_mask:0xf bank_mask:0xf
    v_add_f32_dpp v40, v40, v40 row_half_mirror row_mask:0xf bank_mask:0xf
    v_add_f32_dpp v43, v43, v43 row_half_mirror row_mask:0xf bank_mask:0xf
    v_add_f32_dpp v46, v46, v46 row_half_mirror row_mask:0xf bank_mask:0xf
    v_cndmask_b32 v49, v49, v37, s[64:65]
    v_cndmask_b32 v49, v49, v40, s[66:67]
    v_cndmask_b32 v49, v49, v43, s[68:69]
    v_cndmask_b32 v49, v49, v46, s[70:71]
    s_waitcnt vmcnt(36)
    v_dot2_f32_bf16 v37, v112, v16, 0
    v_dot2_f32_bf16 v38, v116, v20, 0
    v_dot2_f32_bf16 v39, v120, v24, 0
    v_dot2_f32_bf16 v40, v124, v16, 0
    v_dot2_f32_bf16 v41, v128, v20, 0
    v_dot2_f32_bf16 v42, v132, v24, 0
    v_dot2_f32_bf16 v43, v136, v16, 0
    v_dot2_f32_bf16 v44, v140, v20, 0
    v_dot2_f32_bf16 v45, v144, v24, 0
    v_dot2_f32_bf16 v46, v148, v16, 0
    v_dot2_f32_bf16 v47, v152, v20, 0
    v_dot2_f32_bf16 v48, v156, v24, 0
    v_dot2c_f32_bf16 v37, v113, v17
    v_dot2c_f32_bf16 v38, v117, v21
    v_dot2c_f32_bf16 v39, v121, v25
    v_dot2c_f32_bf16 v40, v125, v17
    v_dot2c_f32_bf16 v41, v129, v21
    v_dot2c_f32_bf16 v42, v133, v25
    v_dot2c_f32_bf16 v43, v137, v17
    v_dot2c_f32_bf16 v44, v141, v21
    v_dot2c_f32_bf16 v45, v145, v25
    v_dot2c_f32_bf16 v46, v149, v17
    v_dot2c_f32_bf16 v47, v153, v21
    v_dot2c_f32_bf16 v48, v157, v25
    v_dot2c_f32_bf16 v37, v114, v18
    v_dot2c_f32_bf16 v38, v118, v22
    v_dot2c_f32_bf16 v39, v122, v26
    v_dot2c_f32_bf16 v40, v126, v18
    v_dot2c_f32_bf16 v41, v130, v22
    v_dot2c_f32_bf16 v42, v134, v26
    v_dot2c_f32_bf16 v43, v138, v18
    v_dot2c_f32_bf16 v44, v142, v22
    v_dot2c_f32_bf16 v45, v146, v26
    v_dot2c_f32_bf16 v46, v150, v18
    v_dot2c_f32_bf16 v47, v154, v22
    v_dot2c_f32_bf16 v48, v158, v26
    v_dot2c_f32_bf16 v37, v115, v19
    v_dot2c_f32_bf16 v38, v119, v23
    v_dot2c_f32_bf16 v39, v123, v27
    v_dot2c_f32_bf16 v40, v127, v19
    v_dot2c_f32_bf16 v41, v131, v23
    v_dot2c_f32_bf16 v42, v135, v27
    v_dot2c_f32_bf16 v43, v139, v19
    v_dot2c_f32_bf16 v44, v143, v23
    v_dot2c_f32_bf16 v45, v147, v27
    v_dot2c_f32_bf16 v46, v151, v19
    v_dot2c_f32_bf16 v47, v155, v23
    v_dot2c_f32_bf16 v48, v159, v27
    buffer_load_dwordx4 v[112:115], v2, s[48:51], s60 offen offset:0 nt
    buffer_load_dwordx4 v[116:119], v2, s[48:51], s60 offen offset:128 nt
    buffer_load_dwordx4 v[120:123], v2, s[48:51], s60 offen offset:256 nt
    s_add_u32 s60, s60, 24576
    buffer_load_dwordx4 v[124:127], v2, s[48:51], s60 offen offset:0 nt
    buffer_load_dwordx4 v[128:131], v2, s[48:51], s60 offen offset:128 nt
    buffer_load_dwordx4 v[132:135], v2, s[48:51], s60 offen offset:256 nt
    s_add_u32 s60, s60, 24576
    buffer_load_dwordx4 v[136:139], v2, s[48:51], s60 offen offset:0 nt
    buffer_load_dwordx4 v[140:143], v2, s[48:51], s60 offen offset:128 nt
    buffer_load_dwordx4 v[144:147], v2, s[48:51], s60 offen offset:256 nt
    s_add_u32 s60, s60, 24576
    buffer_load_dwordx4 v[148:151], v2, s[48:51], s60 offen offset:0 nt
    buffer_load_dwordx4 v[152:155], v2, s[48:51], s60 offen offset:128 nt
    buffer_load_dwordx4 v[156:159], v2, s[48:51], s60 offen offset:256 nt
    s_add_u32 s60, s60, 24576
    v_add_f32 v37, v37, v38
    v_add_f32 v40, v40, v41
    v_add_f32 v43, v43, v44
    v_add_f32 v46, v46, v47
    v_add_f32 v37, v37, v39
    v_add_f32 v40, v40, v42
    v_add_f32 v43, v43, v45
    v_add_f32 v46, v46, v48
    v_add_f32_dpp v37, v37, v37 quad_perm:[1,0,3,2] row_mask:0xf bank_mask:0xf
    v_add_f32_dpp v40, v40, v40 quad_perm:[1,0,3,2] row_mask:0xf bank_mask:0xf
    v_add_f32_dpp v43, v43, v43 quad_perm:[1,0,3,2] row_mask:0xf bank_mask:0xf
    v_add_f32_dpp v46, v46, v46 quad_perm:[1,0,3,2] row_mask:0xf bank_mask:0xf
    v_add_f32_dpp v37, v37, v37 quad_perm:[2,3,0,1] row_mask:0xf bank_mask:0xf
    v_add_f32_dpp v40, v40, v40 quad_perm:[2,3,0,1] row_mask:0xf bank_mask:0xf
    v_add_f32_dpp v43, v43, v43 quad_perm:[2,3,0,1] row_mask:0xf bank_mask:0xf
    v_add_f32_dpp v46, v46, v46 quad_perm:[2,3,0,1] row_mask:0xf bank_mask:0xf
    v_add_f32_dpp v37, v37, v37 row_half_mirror row_mask:0xf bank_mask:0xf
    v_add_f32_dpp v40, v40, v40 row_half_mirror row_mask:0xf bank_mask:0xf
    v_add_f32_dpp v43, v43, v43 row_half_mirror row_mask:0xf bank_mask:0xf
    v_add_f32_dpp v46, v46, v46 row_half_mirror row_mask:0xf bank_mask:0xf
    v_cndmask_b32 v49, v49, v37, s[72:73]
    v_cndmask_b32 v49, v49, v40, s[74:75]
    v_cndmask_b32 v49, v49, v43, s[76:77]
    v_cndmask_b32 v49, v49, v46, s[78:79]
    v_cvt_pk_bf16_f32 v50, v49, v49
    v_and_b32 v50, 0xffff0000, v50
    v_mul_f32 v50, 0x3d93cd3a, v50
    v_cvt_pk_bf16_f32 v30, v50, v50
    v_and_b32 v30, 0xffff0000, v30
    s_waitcnt vmcnt(36)
    v_dot2_f32_bf16 v37, v160, v16, 0
    v_dot2_f32_bf16 v38, v164, v20, 0
    v_dot2_f32_bf16 v39, v168, v24, 0
    v_dot2_f32_bf16 v40, v172, v16, 0
    v_dot2_f32_bf16 v41, v176, v20, 0
    v_dot2_f32_bf16 v42, v180, v24, 0
    v_dot2_f32_bf16 v43, v184, v16, 0
    v_dot2_f32_bf16 v44, v188, v20, 0
    v_dot2_f32_bf16 v45, v192, v24, 0
    v_dot2_f32_bf16 v46, v196, v16, 0
    v_dot2_f32_bf16 v47, v200, v20, 0
    v_dot2_f32_bf16 v48, v204, v24, 0
    v_dot2c_f32_bf16 v37, v161, v17
    v_dot2c_f32_bf16 v38, v165, v21
    v_dot2c_f32_bf16 v39, v169, v25
    v_dot2c_f32_bf16 v40, v173, v17
    v_dot2c_f32_bf16 v41, v177, v21
    v_dot2c_f32_bf16 v42, v181, v25
    v_dot2c_f32_bf16 v43, v185, v17
    v_dot2c_f32_bf16 v44, v189, v21
    v_dot2c_f32_bf16 v45, v193, v25
    v_dot2c_f32_bf16 v46, v197, v17
    v_dot2c_f32_bf16 v47, v201, v21
    v_dot2c_f32_bf16 v48, v205, v25
    v_dot2c_f32_bf16 v37, v162, v18
    v_dot2c_f32_bf16 v38, v166, v22
    v_dot2c_f32_bf16 v39, v170, v26
    v_dot2c_f32_bf16 v40, v174, v18
    v_dot2c_f32_bf16 v41, v178, v22
    v_dot2c_f32_bf16 v42, v182, v26
    v_dot2c_f32_bf16 v43, v186, v18
    v_dot2c_f32_bf16 v44, v190, v22
    v_dot2c_f32_bf16 v45, v194, v26
    v_dot2c_f32_bf16 v46, v198, v18
    v_dot2c_f32_bf16 v47, v202, v22
    v_dot2c_f32_bf16 v48, v206, v26
    v_dot2c_f32_bf16 v37, v163, v19
    v_dot2c_f32_bf16 v38, v167, v23
    v_dot2c_f32_bf16 v39, v171, v27
    v_dot2c_f32_bf16 v40, v175, v19
    v_dot2c_f32_bf16 v41, v179, v23
    v_dot2c_f32_bf16 v42, v183, v27
    v_dot2c_f32_bf16 v43, v187, v19
    v_dot2c_f32_bf16 v44, v191, v23
    v_dot2c_f32_bf16 v45, v195, v27
    v_dot2c_f32_bf16 v46, v199, v19
    v_dot2c_f32_bf16 v47, v203, v23
    v_dot2c_f32_bf16 v48, v207, v27
    buffer_load_dwordx4 v[160:163], v2, s[48:51], s60 offen offset:0 nt
    buffer_load_dwordx4 v[164:167], v2, s[48:51], s60 offen offset:128 nt
    buffer_load_dwordx4 v[168:171], v2, s[48:51], s60 offen offset:256 nt
    s_add_u32 s60, s60, 24576
    buffer_load_dwordx4 v[172:175], v2, s[48:51], s60 offen offset:0 nt
    buffer_load_dwordx4 v[176:179], v2, s[48:51], s60 offen offset:128 nt
    buffer_load_dwordx4 v[180:183], v2, s[48:51], s60 offen offset:256 nt
    s_add_u32 s60, s60, 24576
    buffer_load_dwordx4 v[184:187], v2, s[48:51], s60 offen offset:0 nt
    buffer_load_dwordx4 v[188:191], v2, s[48:51], s60 offen offset:128 nt
    buffer_load_dwordx4 v[192:195], v2, s[48:51], s60 offen offset:256 nt
    s_add_u32 s60, s60, 24576
    buffer_load_dwordx4 v[196:199], v2, s[48:51], s60 offen offset:0 nt
    buffer_load_dwordx4 v[200:203], v2, s[48:51], s60 offen offset:128 nt
    buffer_load_dwordx4 v[204:207], v2, s[48:51], s60 offen offset:256 nt
    s_add_u32 s60, s60, 24576
    v_add_f32 v37, v37, v38
    v_add_f32 v40, v40, v41
    v_add_f32 v43, v43, v44
    v_add_f32 v46, v46, v47
    v_add_f32 v37, v37, v39
    v_add_f32 v40, v40, v42
    v_add_f32 v43, v43, v45
    v_add_f32 v46, v46, v48
    v_add_f32_dpp v37, v37, v37 quad_perm:[1,0,3,2] row_mask:0xf bank_mask:0xf
    v_add_f32_dpp v40, v40, v40 quad_perm:[1,0,3,2] row_mask:0xf bank_mask:0xf
    v_add_f32_dpp v43, v43, v43 quad_perm:[1,0,3,2] row_mask:0xf bank_mask:0xf
    v_add_f32_dpp v46, v46, v46 quad_perm:[1,0,3,2] row_mask:0xf bank_mask:0xf
    v_add_f32_dpp v37, v37, v37 quad_perm:[2,3,0,1] row_mask:0xf bank_mask:0xf
    v_add_f32_dpp v40, v40, v40 quad_perm:[2,3,0,1] row_mask:0xf bank_mask:0xf
    v_add_f32_dpp v43, v43, v43 quad_perm:[2,3,0,1] row_mask:0xf bank_mask:0xf
    v_add_f32_dpp v46, v46, v46 quad_perm:[2,3,0,1] row_mask:0xf bank_mask:0xf
    v_add_f32_dpp v37, v37, v37 row_half_mirror row_mask:0xf bank_mask:0xf
    v_add_f32_dpp v40, v40, v40 row_half_mirror row_mask:0xf bank_mask:0xf
    v_add_f32_dpp v43, v43, v43 row_half_mirror row_mask:0xf bank_mask:0xf
    v_add_f32_dpp v46, v46, v46 row_half_mirror row_mask:0xf bank_mask:0xf
    v_cndmask_b32 v49, v49, v37, s[64:65]
    v_cndmask_b32 v49, v49, v40, s[66:67]
    v_cndmask_b32 v49, v49, v43, s[68:69]
    v_cndmask_b32 v49, v49, v46, s[70:71]
    s_waitcnt vmcnt(36)
    v_dot2_f32_bf16 v37, v208, v16, 0
    v_dot2_f32_bf16 v38, v212, v20, 0
    v_dot2_f32_bf16 v39, v216, v24, 0
    v_dot2_f32_bf16 v40, v220, v16, 0
    v_dot2_f32_bf16 v41, v224, v20, 0
    v_dot2_f32_bf16 v42, v228, v24, 0
    v_dot2_f32_bf16 v43, v232, v16, 0
    v_dot2_f32_bf16 v44, v236, v20, 0
    v_dot2_f32_bf16 v45, v240, v24, 0
    v_dot2_f32_bf16 v46, v244, v16, 0
    v_dot2_f32_bf16 v47, v248, v20, 0
    v_dot2_f32_bf16 v48, v252, v24, 0
    v_dot2c_f32_bf16 v37, v209, v17
    v_dot2c_f32_bf16 v38, v213, v21
    v_dot2c_f32_bf16 v39, v217, v25
    v_dot2c_f32_bf16 v40, v221, v17
    v_dot2c_f32_bf16 v41, v225, v21
    v_dot2c_f32_bf16 v42, v229, v25
    v_dot2c_f32_bf16 v43, v233, v17
    v_dot2c_f32_bf16 v44, v237, v21
    v_dot2c_f32_bf16 v45, v241, v25
    v_dot2c_f32_bf16 v46, v245, v17
    v_dot2c_f32_bf16 v47, v249, v21
    v_dot2c_f32_bf16 v48, v253, v25
    v_dot2c_f32_bf16 v37, v210, v18
    v_dot2c_f32_bf16 v38, v214, v22
    v_dot2c_f32_bf16 v39, v218, v26
    v_dot2c_f32_bf16 v40, v222, v18
    v_dot2c_f32_bf16 v41, v226, v22
    v_dot2c_f32_bf16 v42, v230, v26
    v_dot2c_f32_bf16 v43, v234, v18
    v_dot2c_f32_bf16 v44, v238, v22
    v_dot2c_f32_bf16 v45, v242, v26
    v_dot2c_f32_bf16 v46, v246, v18
    v_dot2c_f32_bf16 v47, v250, v22
    v_dot2c_f32_bf16 v48, v254, v26
    v_dot2c_f32_bf16 v37, v211, v19
    v_dot2c_f32_bf16 v38, v215, v23
    v_dot2c_f32_bf16 v39, v219, v27
    v_dot2c_f32_bf16 v40, v223, v19
    v_dot2c_f32_bf16 v41, v227, v23
    v_dot2c_f32_bf16 v42, v231, v27
    v_dot2c_f32_bf16 v43, v235, v19
    v_dot2c_f32_bf16 v44, v239, v23
    v_dot2c_f32_bf16 v45, v243, v27
    v_dot2c_f32_bf16 v46, v247, v19
    v_dot2c_f32_bf16 v47, v251, v23
    v_dot2c_f32_bf16 v48, v255, v27
    buffer_load_dwordx4 v[208:211], v2, s[48:51], s60 offen offset:0 nt
    buffer_load_dwordx4 v[212:215], v2, s[48:51], s60 offen offset:128 nt
    buffer_load_dwordx4 v[216:219], v2, s[48:51], s60 offen offset:256 nt
    s_add_u32 s60, s60, 24576
    buffer_load_dwordx4 v[220:223], v2, s[48:51], s60 offen offset:0 nt
    buffer_load_dwordx4 v[224:227], v2, s[48:51], s60 offen offset:128 nt
    buffer_load_dwordx4 v[228:231], v2, s[48:51], s60 offen offset:256 nt
    s_add_u32 s60, s60, 24576
    buffer_load_dwordx4 v[232:235], v2, s[48:51], s60 offen offset:0 nt
    buffer_load_dwordx4 v[236:239], v2, s[48:51], s60 offen offset:128 nt
    buffer_load_dwordx4 v[240:243], v2, s[48:51], s60 offen offset:256 nt
    s_add_u32 s60, s60, 24576
    buffer_load_dwordx4 v[244:247], v2, s[48:51], s60 offen offset:0 nt
    buffer_load_dwordx4 v[248:251], v2, s[48:51], s60 offen offset:128 nt
    buffer_load_dwordx4 v[252:255], v2, s[48:51], s60 offen offset:256 nt
    s_add_u32 s60, s60, 24576
    v_add_f32 v37, v37, v38
    v_add_f32 v40, v40, v41
    v_add_f32 v43, v43, v44
    v_add_f32 v46, v46, v47
    v_add_f32 v37, v37, v39
    v_add_f32 v40, v40, v42
    v_add_f32 v43, v43, v45
    v_add_f32 v46, v46, v48
    v_add_f32_dpp v37, v37, v37 quad_perm:[1,0,3,2] row_mask:0xf bank_mask:0xf
    v_add_f32_dpp v40, v40, v40 quad_perm:[1,0,3,2] row_mask:0xf bank_mask:0xf
    v_add_f32_dpp v43, v43, v43 quad_perm:[1,0,3,2] row_mask:0xf bank_mask:0xf
    v_add_f32_dpp v46, v46, v46 quad_perm:[1,0,3,2] row_mask:0xf bank_mask:0xf
    v_add_f32_dpp v37, v37, v37 quad_perm:[2,3,0,1] row_mask:0xf bank_mask:0xf
    v_add_f32_dpp v40, v40, v40 quad_perm:[2,3,0,1] row_mask:0xf bank_mask:0xf
    v_add_f32_dpp v43, v43, v43 quad_perm:[2,3,0,1] row_mask:0xf bank_mask:0xf
    v_add_f32_dpp v46, v46, v46 quad_perm:[2,3,0,1] row_mask:0xf bank_mask:0xf
    v_add_f32_dpp v37, v37, v37 row_half_mirror row_mask:0xf bank_mask:0xf
    v_add_f32_dpp v40, v40, v40 row_half_mirror row_mask:0xf bank_mask:0xf
    v_add_f32_dpp v43, v43, v43 row_half_mirror row_mask:0xf bank_mask:0xf
    v_add_f32_dpp v46, v46, v46 row_half_mirror row_mask:0xf bank_mask:0xf
    v_cndmask_b32 v49, v49, v37, s[72:73]
    v_cndmask_b32 v49, v49, v40, s[74:75]
    v_cndmask_b32 v49, v49, v43, s[76:77]
    v_cndmask_b32 v49, v49, v46, s[78:79]
    v_cvt_pk_bf16_f32 v50, v49, v49
    v_and_b32 v50, 0xffff0000, v50
    v_mul_f32 v50, 0x3d93cd3a, v50
    v_cvt_pk_bf16_f32 v31, v50, v50
    v_and_b32 v31, 0xffff0000, v31
    s_waitcnt vmcnt(36)
    v_dot2_f32_bf16 v37, v64, v16, 0
    v_dot2_f32_bf16 v38, v68, v20, 0
    v_dot2_f32_bf16 v39, v72, v24, 0
    v_dot2_f32_bf16 v40, v76, v16, 0
    v_dot2_f32_bf16 v41, v80, v20, 0
    v_dot2_f32_bf16 v42, v84, v24, 0
    v_dot2_f32_bf16 v43, v88, v16, 0
    v_dot2_f32_bf16 v44, v92, v20, 0
    v_dot2_f32_bf16 v45, v96, v24, 0
    v_dot2_f32_bf16 v46, v100, v16, 0
    v_dot2_f32_bf16 v47, v104, v20, 0
    v_dot2_f32_bf16 v48, v108, v24, 0
    v_dot2c_f32_bf16 v37, v65, v17
    v_dot2c_f32_bf16 v38, v69, v21
    v_dot2c_f32_bf16 v39, v73, v25
    v_dot2c_f32_bf16 v40, v77, v17
    v_dot2c_f32_bf16 v41, v81, v21
    v_dot2c_f32_bf16 v42, v85, v25
    v_dot2c_f32_bf16 v43, v89, v17
    v_dot2c_f32_bf16 v44, v93, v21
    v_dot2c_f32_bf16 v45, v97, v25
    v_dot2c_f32_bf16 v46, v101, v17
    v_dot2c_f32_bf16 v47, v105, v21
    v_dot2c_f32_bf16 v48, v109, v25
    v_dot2c_f32_bf16 v37, v66, v18
    v_dot2c_f32_bf16 v38, v70, v22
    v_dot2c_f32_bf16 v39, v74, v26
    v_dot2c_f32_bf16 v40, v78, v18
    v_dot2c_f32_bf16 v41, v82, v22
    v_dot2c_f32_bf16 v42, v86, v26
    v_dot2c_f32_bf16 v43, v90, v18
    v_dot2c_f32_bf16 v44, v94, v22
    v_dot2c_f32_bf16 v45, v98, v26
    v_dot2c_f32_bf16 v46, v102, v18
    v_dot2c_f32_bf16 v47, v106, v22
    v_dot2c_f32_bf16 v48, v110, v26
    v_dot2c_f32_bf16 v37, v67, v19
    v_dot2c_f32_bf16 v38, v71, v23
    v_dot2c_f32_bf16 v39, v75, v27
    v_dot2c_f32_bf16 v40, v79, v19
    v_dot2c_f32_bf16 v41, v83, v23
    v_dot2c_f32_bf16 v42, v87, v27
    v_dot2c_f32_bf16 v43, v91, v19
    v_dot2c_f32_bf16 v44, v95, v23
    v_dot2c_f32_bf16 v45, v99, v27
    v_dot2c_f32_bf16 v46, v103, v19
    v_dot2c_f32_bf16 v47, v107, v23
    v_dot2c_f32_bf16 v48, v111, v27
    buffer_load_dwordx4 v[64:67], v2, s[48:51], s60 offen offset:0 nt
    buffer_load_dwordx4 v[68:71], v2, s[48:51], s60 offen offset:128 nt
    buffer_load_dwordx4 v[72:75], v2, s[48:51], s60 offen offset:256 nt
    s_add_u32 s60, s60, 24576
    buffer_load_dwordx4 v[76:79], v2, s[48:51], s60 offen offset:0 nt
    buffer_load_dwordx4 v[80:83], v2, s[48:51], s60 offen offset:128 nt
    buffer_load_dwordx4 v[84:87], v2, s[48:51], s60 offen offset:256 nt
    s_add_u32 s60, s60, 24576
    buffer_load_dwordx4 v[88:91], v2, s[48:51], s60 offen offset:0 nt
    buffer_load_dwordx4 v[92:95], v2, s[48:51], s60 offen offset:128 nt
    buffer_load_dwordx4 v[96:99], v2, s[48:51], s60 offen offset:256 nt
    s_add_u32 s60, s60, 24576
    buffer_load_dwordx4 v[100:103], v2, s[48:51], s60 offen offset:0 nt
    buffer_load_dwordx4 v[104:107], v2, s[48:51], s60 offen offset:128 nt
    buffer_load_dwordx4 v[108:111], v2, s[48:51], s60 offen offset:256 nt
    s_add_u32 s60, s60, 24576
    v_add_f32 v37, v37, v38
    v_add_f32 v40, v40, v41
    v_add_f32 v43, v43, v44
    v_add_f32 v46, v46, v47
    v_add_f32 v37, v37, v39
    v_add_f32 v40, v40, v42
    v_add_f32 v43, v43, v45
    v_add_f32 v46, v46, v48
    v_add_f32_dpp v37, v37, v37 quad_perm:[1,0,3,2] row_mask:0xf bank_mask:0xf
    v_add_f32_dpp v40, v40, v40 quad_perm:[1,0,3,2] row_mask:0xf bank_mask:0xf
    v_add_f32_dpp v43, v43, v43 quad_perm:[1,0,3,2] row_mask:0xf bank_mask:0xf
    v_add_f32_dpp v46, v46, v46 quad_perm:[1,0,3,2] row_mask:0xf bank_mask:0xf
    v_add_f32_dpp v37, v37, v37 quad_perm:[2,3,0,1] row_mask:0xf bank_mask:0xf
    v_add_f32_dpp v40, v40, v40 quad_perm:[2,3,0,1] row_mask:0xf bank_mask:0xf
    v_add_f32_dpp v43, v43, v43 quad_perm:[2,3,0,1] row_mask:0xf bank_mask:0xf
    v_add_f32_dpp v46, v46, v46 quad_perm:[2,3,0,1] row_mask:0xf bank_mask:0xf
    v_add_f32_dpp v37, v37, v37 row_half_mirror row_mask:0xf bank_mask:0xf
    v_add_f32_dpp v40, v40, v40 row_half_mirror row_mask:0xf bank_mask:0xf
    v_add_f32_dpp v43, v43, v43 row_half_mirror row_mask:0xf bank_mask:0xf
    v_add_f32_dpp v46, v46, v46 row_half_mirror row_mask:0xf bank_mask:0xf
    v_cndmask_b32 v49, v49, v37, s[64:65]
    v_cndmask_b32 v49, v49, v40, s[66:67]
    v_cndmask_b32 v49, v49, v43, s[68:69]
    v_cndmask_b32 v49, v49, v46, s[70:71]
    s_waitcnt vmcnt(36)
    v_dot2_f32_bf16 v37, v112, v16, 0
    v_dot2_f32_bf16 v38, v116, v20, 0
    v_dot2_f32_bf16 v39, v120, v24, 0
    v_dot2_f32_bf16 v40, v124, v16, 0
    v_dot2_f32_bf16 v41, v128, v20, 0
    v_dot2_f32_bf16 v42, v132, v24, 0
    v_dot2_f32_bf16 v43, v136, v16, 0
    v_dot2_f32_bf16 v44, v140, v20, 0
    v_dot2_f32_bf16 v45, v144, v24, 0
    v_dot2_f32_bf16 v46, v148, v16, 0
    v_dot2_f32_bf16 v47, v152, v20, 0
    v_dot2_f32_bf16 v48, v156, v24, 0
    v_dot2c_f32_bf16 v37, v113, v17
    v_dot2c_f32_bf16 v38, v117, v21
    v_dot2c_f32_bf16 v39, v121, v25
    v_dot2c_f32_bf16 v40, v125, v17
    v_dot2c_f32_bf16 v41, v129, v21
    v_dot2c_f32_bf16 v42, v133, v25
    v_dot2c_f32_bf16 v43, v137, v17
    v_dot2c_f32_bf16 v44, v141, v21
    v_dot2c_f32_bf16 v45, v145, v25
    v_dot2c_f32_bf16 v46, v149, v17
    v_dot2c_f32_bf16 v47, v153, v21
    v_dot2c_f32_bf16 v48, v157, v25
    v_dot2c_f32_bf16 v37, v114, v18
    v_dot2c_f32_bf16 v38, v118, v22
    v_dot2c_f32_bf16 v39, v122, v26
    v_dot2c_f32_bf16 v40, v126, v18
    v_dot2c_f32_bf16 v41, v130, v22
    v_dot2c_f32_bf16 v42, v134, v26
    v_dot2c_f32_bf16 v43, v138, v18
    v_dot2c_f32_bf16 v44, v142, v22
    v_dot2c_f32_bf16 v45, v146, v26
    v_dot2c_f32_bf16 v46, v150, v18
    v_dot2c_f32_bf16 v47, v154, v22
    v_dot2c_f32_bf16 v48, v158, v26
    v_dot2c_f32_bf16 v37, v115, v19
    v_dot2c_f32_bf16 v38, v119, v23
    v_dot2c_f32_bf16 v39, v123, v27
    v_dot2c_f32_bf16 v40, v127, v19
    v_dot2c_f32_bf16 v41, v131, v23
    v_dot2c_f32_bf16 v42, v135, v27
    v_dot2c_f32_bf16 v43, v139, v19
    v_dot2c_f32_bf16 v44, v143, v23
    v_dot2c_f32_bf16 v45, v147, v27
    v_dot2c_f32_bf16 v46, v151, v19
    v_dot2c_f32_bf16 v47, v155, v23
    v_dot2c_f32_bf16 v48, v159, v27
    buffer_load_dwordx4 v[112:115], v2, s[48:51], s60 offen offset:0 nt
    buffer_load_dwordx4 v[116:119], v2, s[48:51], s60 offen offset:128 nt
    buffer_load_dwordx4 v[120:123], v2, s[48:51], s60 offen offset:256 nt
    s_add_u32 s60, s60, 24576
    buffer_load_dwordx4 v[124:127], v2, s[48:51], s60 offen offset:0 nt
    buffer_load_dwordx4 v[128:131], v2, s[48:51], s60 offen offset:128 nt
    buffer_load_dwordx4 v[132:135], v2, s[48:51], s60 offen offset:256 nt
    s_add_u32 s60, s60, 24576
    buffer_load_dwordx4 v[136:139], v2, s[48:51], s60 offen offset:0 nt
    buffer_load_dwordx4 v[140:143], v2, s[48:51], s60 offen offset:128 nt
    buffer_load_dwordx4 v[144:147], v2, s[48:51], s60 offen offset:256 nt
    s_add_u32 s60, s60, 24576
    buffer_load_dwordx4 v[148:151], v2, s[48:51], s60 offen offset:0 nt
    buffer_load_dwordx4 v[152:155], v2, s[48:51], s60 offen offset:128 nt
    buffer_load_dwordx4 v[156:159], v2, s[48:51], s60 offen offset:256 nt
    s_add_u32 s60, s60, 24576
    v_add_f32 v37, v37, v38
    v_add_f32 v40, v40, v41
    v_add_f32 v43, v43, v44
    v_add_f32 v46, v46, v47
    v_add_f32 v37, v37, v39
    v_add_f32 v40, v40, v42
    v_add_f32 v43, v43, v45
    v_add_f32 v46, v46, v48
    v_add_f32_dpp v37, v37, v37 quad_perm:[1,0,3,2] row_mask:0xf bank_mask:0xf
    v_add_f32_dpp v40, v40, v40 quad_perm:[1,0,3,2] row_mask:0xf bank_mask:0xf
    v_add_f32_dpp v43, v43, v43 quad_perm:[1,0,3,2] row_mask:0xf bank_mask:0xf
    v_add_f32_dpp v46, v46, v46 quad_perm:[1,0,3,2] row_mask:0xf bank_mask:0xf
    v_add_f32_dpp v37, v37, v37 quad_perm:[2,3,0,1] row_mask:0xf bank_mask:0xf
    v_add_f32_dpp v40, v40, v40 quad_perm:[2,3,0,1] row_mask:0xf bank_mask:0xf
    v_add_f32_dpp v43, v43, v43 quad_perm:[2,3,0,1] row_mask:0xf bank_mask:0xf
    v_add_f32_dpp v46, v46, v46 quad_perm:[2,3,0,1] row_mask:0xf bank_mask:0xf
    v_add_f32_dpp v37, v37, v37 row_half_mirror row_mask:0xf bank_mask:0xf
    v_add_f32_dpp v40, v40, v40 row_half_mirror row_mask:0xf bank_mask:0xf
    v_add_f32_dpp v43, v43, v43 row_half_mirror row_mask:0xf bank_mask:0xf
    v_add_f32_dpp v46, v46, v46 row_half_mirror row_mask:0xf bank_mask:0xf
    v_cndmask_b32 v49, v49, v37, s[72:73]
    v_cndmask_b32 v49, v49, v40, s[74:75]
    v_cndmask_b32 v49, v49, v43, s[76:77]
    v_cndmask_b32 v49, v49, v46, s[78:79]
    v_cvt_pk_bf16_f32 v50, v49, v49
    v_and_b32 v50, 0xffff0000, v50
    v_mul_f32 v50, 0x3d93cd3a, v50
    v_cvt_pk_bf16_f32 v32, v50, v50
    v_and_b32 v32, 0xffff0000, v32
    s_waitcnt vmcnt(36)
    v_dot2_f32_bf16 v37, v160, v16, 0
    v_dot2_f32_bf16 v38, v164, v20, 0
    v_dot2_f32_bf16 v39, v168, v24, 0
    v_dot2_f32_bf16 v40, v172, v16, 0
    v_dot2_f32_bf16 v41, v176, v20, 0
    v_dot2_f32_bf16 v42, v180, v24, 0
    v_dot2_f32_bf16 v43, v184, v16, 0
    v_dot2_f32_bf16 v44, v188, v20, 0
    v_dot2_f32_bf16 v45, v192, v24, 0
    v_dot2_f32_bf16 v46, v196, v16, 0
    v_dot2_f32_bf16 v47, v200, v20, 0
    v_dot2_f32_bf16 v48, v204, v24, 0
    v_dot2c_f32_bf16 v37, v161, v17
    v_dot2c_f32_bf16 v38, v165, v21
    v_dot2c_f32_bf16 v39, v169, v25
    v_dot2c_f32_bf16 v40, v173, v17
    v_dot2c_f32_bf16 v41, v177, v21
    v_dot2c_f32_bf16 v42, v181, v25
    v_dot2c_f32_bf16 v43, v185, v17
    v_dot2c_f32_bf16 v44, v189, v21
    v_dot2c_f32_bf16 v45, v193, v25
    v_dot2c_f32_bf16 v46, v197, v17
    v_dot2c_f32_bf16 v47, v201, v21
    v_dot2c_f32_bf16 v48, v205, v25
    v_dot2c_f32_bf16 v37, v162, v18
    v_dot2c_f32_bf16 v38, v166, v22
    v_dot2c_f32_bf16 v39, v170, v26
    v_dot2c_f32_bf16 v40, v174, v18
    v_dot2c_f32_bf16 v41, v178, v22
    v_dot2c_f32_bf16 v42, v182, v26
    v_dot2c_f32_bf16 v43, v186, v18
    v_dot2c_f32_bf16 v44, v190, v22
    v_dot2c_f32_bf16 v45, v194, v26
    v_dot2c_f32_bf16 v46, v198, v18
    v_dot2c_f32_bf16 v47, v202, v22
    v_dot2c_f32_bf16 v48, v206, v26
    v_dot2c_f32_bf16 v37, v163, v19
    v_dot2c_f32_bf16 v38, v167, v23
    v_dot2c_f32_bf16 v39, v171, v27
    v_dot2c_f32_bf16 v40, v175, v19
    v_dot2c_f32_bf16 v41, v179, v23
    v_dot2c_f32_bf16 v42, v183, v27
    v_dot2c_f32_bf16 v43, v187, v19
    v_dot2c_f32_bf16 v44, v191, v23
    v_dot2c_f32_bf16 v45, v195, v27
    v_dot2c_f32_bf16 v46, v199, v19
    v_dot2c_f32_bf16 v47, v203, v23
    v_dot2c_f32_bf16 v48, v207, v27
    buffer_load_dwordx4 v[160:163], v2, s[48:51], s60 offen offset:0 nt
    buffer_load_dwordx4 v[164:167], v2, s[48:51], s60 offen offset:128 nt
    buffer_load_dwordx4 v[168:171], v2, s[48:51], s60 offen offset:256 nt
    s_add_u32 s60, s60, 24576
    buffer_load_dwordx4 v[172:175], v2, s[48:51], s60 offen offset:0 nt
    buffer_load_dwordx4 v[176:179], v2, s[48:51], s60 offen offset:128 nt
    buffer_load_dwordx4 v[180:183], v2, s[48:51], s60 offen offset:256 nt
    s_add_u32 s60, s60, 24576
    buffer_load_dwordx4 v[184:187], v2, s[48:51], s60 offen offset:0 nt
    buffer_load_dwordx4 v[188:191], v2, s[48:51], s60 offen offset:128 nt
    buffer_load_dwordx4 v[192:195], v2, s[48:51], s60 offen offset:256 nt
    s_add_u32 s60, s60, 24576
    buffer_load_dwordx4 v[196:199], v2, s[48:51], s60 offen offset:0 nt
    buffer_load_dwordx4 v[200:203], v2, s[48:51], s60 offen offset:128 nt
    buffer_load_dwordx4 v[204:207], v2, s[48:51], s60 offen offset:256 nt
    s_add_u32 s60, s60, 24576
    v_add_f32 v37, v37, v38
    v_add_f32 v40, v40, v41
    v_add_f32 v43, v43, v44
    v_add_f32 v46, v46, v47
    v_add_f32 v37, v37, v39
    v_add_f32 v40, v40, v42
    v_add_f32 v43, v43, v45
    v_add_f32 v46, v46, v48
    v_add_f32_dpp v37, v37, v37 quad_perm:[1,0,3,2] row_mask:0xf bank_mask:0xf
    v_add_f32_dpp v40, v40, v40 quad_perm:[1,0,3,2] row_mask:0xf bank_mask:0xf
    v_add_f32_dpp v43, v43, v43 quad_perm:[1,0,3,2] row_mask:0xf bank_mask:0xf
    v_add_f32_dpp v46, v46, v46 quad_perm:[1,0,3,2] row_mask:0xf bank_mask:0xf
    v_add_f32_dpp v37, v37, v37 quad_perm:[2,3,0,1] row_mask:0xf bank_mask:0xf
    v_add_f32_dpp v40, v40, v40 quad_perm:[2,3,0,1] row_mask:0xf bank_mask:0xf
    v_add_f32_dpp v43, v43, v43 quad_perm:[2,3,0,1] row_mask:0xf bank_mask:0xf
    v_add_f32_dpp v46, v46, v46 quad_perm:[2,3,0,1] row_mask:0xf bank_mask:0xf
    v_add_f32_dpp v37, v37, v37 row_half_mirror row_mask:0xf bank_mask:0xf
    v_add_f32_dpp v40, v40, v40 row_half_mirror row_mask:0xf bank_mask:0xf
    v_add_f32_dpp v43, v43, v43 row_half_mirror row_mask:0xf bank_mask:0xf
    v_add_f32_dpp v46, v46, v46 row_half_mirror row_mask:0xf bank_mask:0xf
    v_cndmask_b32 v49, v49, v37, s[64:65]
    v_cndmask_b32 v49, v49, v40, s[66:67]
    v_cndmask_b32 v49, v49, v43, s[68:69]
    v_cndmask_b32 v49, v49, v46, s[70:71]
    s_waitcnt vmcnt(36)
    v_dot2_f32_bf16 v37, v208, v16, 0
    v_dot2_f32_bf16 v38, v212, v20, 0
    v_dot2_f32_bf16 v39, v216, v24, 0
    v_dot2_f32_bf16 v40, v220, v16, 0
    v_dot2_f32_bf16 v41, v224, v20, 0
    v_dot2_f32_bf16 v42, v228, v24, 0
    v_dot2_f32_bf16 v43, v232, v16, 0
    v_dot2_f32_bf16 v44, v236, v20, 0
    v_dot2_f32_bf16 v45, v240, v24, 0
    v_dot2_f32_bf16 v46, v244, v16, 0
    v_dot2_f32_bf16 v47, v248, v20, 0
    v_dot2_f32_bf16 v48, v252, v24, 0
    v_dot2c_f32_bf16 v37, v209, v17
    v_dot2c_f32_bf16 v38, v213, v21
    v_dot2c_f32_bf16 v39, v217, v25
    v_dot2c_f32_bf16 v40, v221, v17
    v_dot2c_f32_bf16 v41, v225, v21
    v_dot2c_f32_bf16 v42, v229, v25
    v_dot2c_f32_bf16 v43, v233, v17
    v_dot2c_f32_bf16 v44, v237, v21
    v_dot2c_f32_bf16 v45, v241, v25
    v_dot2c_f32_bf16 v46, v245, v17
    v_dot2c_f32_bf16 v47, v249, v21
    v_dot2c_f32_bf16 v48, v253, v25
    v_dot2c_f32_bf16 v37, v210, v18
    v_dot2c_f32_bf16 v38, v214, v22
    v_dot2c_f32_bf16 v39, v218, v26
    v_dot2c_f32_bf16 v40, v222, v18
    v_dot2c_f32_bf16 v41, v226, v22
    v_dot2c_f32_bf16 v42, v230, v26
    v_dot2c_f32_bf16 v43, v234, v18
    v_dot2c_f32_bf16 v44, v238, v22
    v_dot2c_f32_bf16 v45, v242, v26
    v_dot2c_f32_bf16 v46, v246, v18
    v_dot2c_f32_bf16 v47, v250, v22
    v_dot2c_f32_bf16 v48, v254, v26
    v_dot2c_f32_bf16 v37, v211, v19
    v_dot2c_f32_bf16 v38, v215, v23
    v_dot2c_f32_bf16 v39, v219, v27
    v_dot2c_f32_bf16 v40, v223, v19
    v_dot2c_f32_bf16 v41, v227, v23
    v_dot2c_f32_bf16 v42, v231, v27
    v_dot2c_f32_bf16 v43, v235, v19
    v_dot2c_f32_bf16 v44, v239, v23
    v_dot2c_f32_bf16 v45, v243, v27
    v_dot2c_f32_bf16 v46, v247, v19
    v_dot2c_f32_bf16 v47, v251, v23
    v_dot2c_f32_bf16 v48, v255, v27
    buffer_load_dwordx4 v[208:211], v2, s[48:51], s60 offen offset:0 nt
    buffer_load_dwordx4 v[212:215], v2, s[48:51], s60 offen offset:128 nt
    buffer_load_dwordx4 v[216:219], v2, s[48:51], s60 offen offset:256 nt
    s_add_u32 s60, s60, 24576
    buffer_load_dwordx4 v[220:223], v2, s[48:51], s60 offen offset:0 nt
    buffer_load_dwordx4 v[224:227], v2, s[48:51], s60 offen offset:128 nt
    buffer_load_dwordx4 v[228:231], v2, s[48:51], s60 offen offset:256 nt
    s_add_u32 s60, s60, 24576
    buffer_load_dwordx4 v[232:235], v2, s[48:51], s60 offen offset:0 nt
    buffer_load_dwordx4 v[236:239], v2, s[48:51], s60 offen offset:128 nt
    buffer_load_dwordx4 v[240:243], v2, s[48:51], s60 offen offset:256 nt
    s_add_u32 s60, s60, 24576
    buffer_load_dwordx4 v[244:247], v2, s[48:51], s60 offen offset:0 nt
    buffer_load_dwordx4 v[248:251], v2, s[48:51], s60 offen offset:128 nt
    buffer_load_dwordx4 v[252:255], v2, s[48:51], s60 offen offset:256 nt
    s_add_u32 s60, s60, 24576
    v_add_f32 v37, v37, v38
    v_add_f32 v40, v40, v41
    v_add_f32 v43, v43, v44
    v_add_f32 v46, v46, v47
    v_add_f32 v37, v37, v39
    v_add_f32 v40, v40, v42
    v_add_f32 v43, v43, v45
    v_add_f32 v46, v46, v48
    v_add_f32_dpp v37, v37, v37 quad_perm:[1,0,3,2] row_mask:0xf bank_mask:0xf
    v_add_f32_dpp v40, v40, v40 quad_perm:[1,0,3,2] row_mask:0xf bank_mask:0xf
    v_add_f32_dpp v43, v43, v43 quad_perm:[1,0,3,2] row_mask:0xf bank_mask:0xf
    v_add_f32_dpp v46, v46, v46 quad_perm:[1,0,3,2] row_mask:0xf bank_mask:0xf
    v_add_f32_dpp v37, v37, v37 quad_perm:[2,3,0,1] row_mask:0xf bank_mask:0xf
    v_add_f32_dpp v40, v40, v40 quad_perm:[2,3,0,1] row_mask:0xf bank_mask:0xf
    v_add_f32_dpp v43, v43, v43 quad_perm:[2,3,0,1] row_mask:0xf bank_mask:0xf
    v_add_f32_dpp v46, v46, v46 quad_perm:[2,3,0,1] row_mask:0xf bank_mask:0xf
    v_add_f32_dpp v37, v37, v37 row_half_mirror row_mask:0xf bank_mask:0xf
    v_add_f32_dpp v40, v40, v40 row_half_mirror row_mask:0xf bank_mask:0xf
    v_add_f32_dpp v43, v43, v43 row_half_mirror row_mask:0xf bank_mask:0xf
    v_add_f32_dpp v46, v46, v46 row_half_mirror row_mask:0xf bank_mask:0xf
    v_cndmask_b32 v49, v49, v37, s[72:73]
    v_cndmask_b32 v49, v49, v40, s[74:75]
    v_cndmask_b32 v49, v49, v43, s[76:77]
    v_cndmask_b32 v49, v49, v46, s[78:79]
    v_cvt_pk_bf16_f32 v50, v49, v49
    v_and_b32 v50, 0xffff0000, v50
    v_mul_f32 v50, 0x3d93cd3a, v50
    v_cvt_pk_bf16_f32 v33, v50, v50
    v_and_b32 v33, 0xffff0000, v33
    s_waitcnt vmcnt(36)
    v_dot2_f32_bf16 v37, v64, v16, 0
    v_dot2_f32_bf16 v38, v68, v20, 0
    v_dot2_f32_bf16 v39, v72, v24, 0
    v_dot2_f32_bf16 v40, v76, v16, 0
    v_dot2_f32_bf16 v41, v80, v20, 0
    v_dot2_f32_bf16 v42, v84, v24, 0
    v_dot2_f32_bf16 v43, v88, v16, 0
    v_dot2_f32_bf16 v44, v92, v20, 0
    v_dot2_f32_bf16 v45, v96, v24, 0
    v_dot2_f32_bf16 v46, v100, v16, 0
    v_dot2_f32_bf16 v47, v104, v20, 0
    v_dot2_f32_bf16 v48, v108, v24, 0
    v_dot2c_f32_bf16 v37, v65, v17
    v_dot2c_f32_bf16 v38, v69, v21
    v_dot2c_f32_bf16 v39, v73, v25
    v_dot2c_f32_bf16 v40, v77, v17
    v_dot2c_f32_bf16 v41, v81, v21
    v_dot2c_f32_bf16 v42, v85, v25
    v_dot2c_f32_bf16 v43, v89, v17
    v_dot2c_f32_bf16 v44, v93, v21
    v_dot2c_f32_bf16 v45, v97, v25
    v_dot2c_f32_bf16 v46, v101, v17
    v_dot2c_f32_bf16 v47, v105, v21
    v_dot2c_f32_bf16 v48, v109, v25
    v_dot2c_f32_bf16 v37, v66, v18
    v_dot2c_f32_bf16 v38, v70, v22
    v_dot2c_f32_bf16 v39, v74, v26
    v_dot2c_f32_bf16 v40, v78, v18
    v_dot2c_f32_bf16 v41, v82, v22
    v_dot2c_f32_bf16 v42, v86, v26
    v_dot2c_f32_bf16 v43, v90, v18
    v_dot2c_f32_bf16 v44, v94, v22
    v_dot2c_f32_bf16 v45, v98, v26
    v_dot2c_f32_bf16 v46, v102, v18
    v_dot2c_f32_bf16 v47, v106, v22
    v_dot2c_f32_bf16 v48, v110, v26
    v_dot2c_f32_bf16 v37, v67, v19
    v_dot2c_f32_bf16 v38, v71, v23
    v_dot2c_f32_bf16 v39, v75, v27
    v_dot2c_f32_bf16 v40, v79, v19
    v_dot2c_f32_bf16 v41, v83, v23
    v_dot2c_f32_bf16 v42, v87, v27
    v_dot2c_f32_bf16 v43, v91, v19
    v_dot2c_f32_bf16 v44, v95, v23
    v_dot2c_f32_bf16 v45, v99, v27
    v_dot2c_f32_bf16 v46, v103, v19
    v_dot2c_f32_bf16 v47, v107, v23
    v_dot2c_f32_bf16 v48, v111, v27
    buffer_load_dwordx4 v[64:67], v2, s[48:51], s60 offen offset:0 nt
    buffer_load_dwordx4 v[68:71], v2, s[48:51], s60 offen offset:128 nt
    buffer_load_dwordx4 v[72:75], v2, s[48:51], s60 offen offset:256 nt
    s_add_u32 s60, s60, 24576
    buffer_load_dwordx4 v[76:79], v2, s[48:51], s60 offen offset:0 nt
    buffer_load_dwordx4 v[80:83], v2, s[48:51], s60 offen offset:128 nt
    buffer_load_dwordx4 v[84:87], v2, s[48:51], s60 offen offset:256 nt
    s_add_u32 s60, s60, 24576
    buffer_load_dwordx4 v[88:91], v2, s[48:51], s60 offen offset:0 nt
    buffer_load_dwordx4 v[92:95], v2, s[48:51], s60 offen offset:128 nt
    buffer_load_dwordx4 v[96:99], v2, s[48:51], s60 offen offset:256 nt
    s_add_u32 s60, s60, 24576
    buffer_load_dwordx4 v[100:103], v2, s[48:51], s60 offen offset:0 nt
    buffer_load_dwordx4 v[104:107], v2, s[48:51], s60 offen offset:128 nt
    buffer_load_dwordx4 v[108:111], v2, s[48:51], s60 offen offset:256 nt
    s_add_u32 s60, s60, 24576
    v_add_f32 v37, v37, v38
    v_add_f32 v40, v40, v41
    v_add_f32 v43, v43, v44
    v_add_f32 v46, v46, v47
    v_add_f32 v37, v37, v39
    v_add_f32 v40, v40, v42
    v_add_f32 v43, v43, v45
    v_add_f32 v46, v46, v48
    v_add_f32_dpp v37, v37, v37 quad_perm:[1,0,3,2] row_mask:0xf bank_mask:0xf
    v_add_f32_dpp v40, v40, v40 quad_perm:[1,0,3,2] row_mask:0xf bank_mask:0xf
    v_add_f32_dpp v43, v43, v43 quad_perm:[1,0,3,2] row_mask:0xf bank_mask:0xf
    v_add_f32_dpp v46, v46, v46 quad_perm:[1,0,3,2] row_mask:0xf bank_mask:0xf
    v_add_f32_dpp v37, v37, v37 quad_perm:[2,3,0,1] row_mask:0xf bank_mask:0xf
    v_add_f32_dpp v40, v40, v40 quad_perm:[2,3,0,1] row_mask:0xf bank_mask:0xf
    v_add_f32_dpp v43, v43, v43 quad_perm:[2,3,0,1] row_mask:0xf bank_mask:0xf
    v_add_f32_dpp v46, v46, v46 quad_perm:[2,3,0,1] row_mask:0xf bank_mask:0xf
    v_add_f32_dpp v37, v37, v37 row_half_mirror row_mask:0xf bank_mask:0xf
    v_add_f32_dpp v40, v40, v40 row_half_mirror row_mask:0xf bank_mask:0xf
    v_add_f32_dpp v43, v43, v43 row_half_mirror row_mask:0xf bank_mask:0xf
    v_add_f32_dpp v46, v46, v46 row_half_mirror row_mask:0xf bank_mask:0xf
    v_cndmask_b32 v49, v49, v37, s[64:65]
    v_cndmask_b32 v49, v49, v40, s[66:67]
    v_cndmask_b32 v49, v49, v43, s[68:69]
    v_cndmask_b32 v49, v49, v46, s[70:71]
    s_waitcnt vmcnt(36)
    v_dot2_f32_bf16 v37, v112, v16, 0
    v_dot2_f32_bf16 v38, v116, v20, 0
    v_dot2_f32_bf16 v39, v120, v24, 0
    v_dot2_f32_bf16 v40, v124, v16, 0
    v_dot2_f32_bf16 v41, v128, v20, 0
    v_dot2_f32_bf16 v42, v132, v24, 0
    v_dot2_f32_bf16 v43, v136, v16, 0
    v_dot2_f32_bf16 v44, v140, v20, 0
    v_dot2_f32_bf16 v45, v144, v24, 0
    v_dot2_f32_bf16 v46, v148, v16, 0
    v_dot2_f32_bf16 v47, v152, v20, 0
    v_dot2_f32_bf16 v48, v156, v24, 0
    v_dot2c_f32_bf16 v37, v113, v17
    v_dot2c_f32_bf16 v38, v117, v21
    v_dot2c_f32_bf16 v39, v121, v25
    v_dot2c_f32_bf16 v40, v125, v17
    v_dot2c_f32_bf16 v41, v129, v21
    v_dot2c_f32_bf16 v42, v133, v25
    v_dot2c_f32_bf16 v43, v137, v17
    v_dot2c_f32_bf16 v44, v141, v21
    v_dot2c_f32_bf16 v45, v145, v25
    v_dot2c_f32_bf16 v46, v149, v17
    v_dot2c_f32_bf16 v47, v153, v21
    v_dot2c_f32_bf16 v48, v157, v25
    v_dot2c_f32_bf16 v37, v114, v18
    v_dot2c_f32_bf16 v38, v118, v22
    v_dot2c_f32_bf16 v39, v122, v26
    v_dot2c_f32_bf16 v40, v126, v18
    v_dot2c_f32_bf16 v41, v130, v22
    v_dot2c_f32_bf16 v42, v134, v26
    v_dot2c_f32_bf16 v43, v138, v18
    v_dot2c_f32_bf16 v44, v142, v22
    v_dot2c_f32_bf16 v45, v146, v26
    v_dot2c_f32_bf16 v46, v150, v18
    v_dot2c_f32_bf16 v47, v154, v22
    v_dot2c_f32_bf16 v48, v158, v26
    v_dot2c_f32_bf16 v37, v115, v19
    v_dot2c_f32_bf16 v38, v119, v23
    v_dot2c_f32_bf16 v39, v123, v27
    v_dot2c_f32_bf16 v40, v127, v19
    v_dot2c_f32_bf16 v41, v131, v23
    v_dot2c_f32_bf16 v42, v135, v27
    v_dot2c_f32_bf16 v43, v139, v19
    v_dot2c_f32_bf16 v44, v143, v23
    v_dot2c_f32_bf16 v45, v147, v27
    v_dot2c_f32_bf16 v46, v151, v19
    v_dot2c_f32_bf16 v47, v155, v23
    v_dot2c_f32_bf16 v48, v159, v27
    s_mov_b32 s60, s61
    buffer_load_dwordx4 v[112:115], v2, s[56:59], s60 offen offset:0 nt
    buffer_load_dwordx4 v[116:119], v2, s[56:59], s60 offen offset:128 nt
    buffer_load_dwordx4 v[120:123], v2, s[56:59], s60 offen offset:256 nt
    s_add_u32 s60, s60, 24576
    buffer_load_dwordx4 v[124:127], v2, s[56:59], s60 offen offset:0 nt
    buffer_load_dwordx4 v[128:131], v2, s[56:59], s60 offen offset:128 nt
    buffer_load_dwordx4 v[132:135], v2, s[56:59], s60 offen offset:256 nt
    s_add_u32 s60, s60, 24576
    buffer_load_dwordx4 v[136:139], v2, s[56:59], s60 offen offset:0 nt
    buffer_load_dwordx4 v[140:143], v2, s[56:59], s60 offen offset:128 nt
    buffer_load_dwordx4 v[144:147], v2, s[56:59], s60 offen offset:256 nt
    s_add_u32 s60, s60, 24576
    buffer_load_dwordx4 v[148:151], v2, s[56:59], s60 offen offset:0 nt
    buffer_load_dwordx4 v[152:155], v2, s[56:59], s60 offen offset:128 nt
    buffer_load_dwordx4 v[156:159], v2, s[56:59], s60 offen offset:256 nt
    s_add_u32 s60, s60, 24576
    v_add_f32 v37, v37, v38
    v_add_f32 v40, v40, v41
    v_add_f32 v43, v43, v44
    v_add_f32 v46, v46, v47
    v_add_f32 v37, v37, v39
    v_add_f32 v40, v40, v42
    v_add_f32 v43, v43, v45
    v_add_f32 v46, v46, v48
    v_add_f32_dpp v37, v37, v37 quad_perm:[1,0,3,2] row_mask:0xf bank_mask:0xf
    v_add_f32_dpp v40, v40, v40 quad_perm:[1,0,3,2] row_mask:0xf bank_mask:0xf
    v_add_f32_dpp v43, v43, v43 quad_perm:[1,0,3,2] row_mask:0xf bank_mask:0xf
    v_add_f32_dpp v46, v46, v46 quad_perm:[1,0,3,2] row_mask:0xf bank_mask:0xf
    v_add_f32_dpp v37, v37, v37 quad_perm:[2,3,0,1] row_mask:0xf bank_mask:0xf
    v_add_f32_dpp v40, v40, v40 quad_perm:[2,3,0,1] row_mask:0xf bank_mask:0xf
    v_add_f32_dpp v43, v43, v43 quad_perm:[2,3,0,1] row_mask:0xf bank_mask:0xf
    v_add_f32_dpp v46, v46, v46 quad_perm:[2,3,0,1] row_mask:0xf bank_mask:0xf
    v_add_f32_dpp v37, v37, v37 row_half_mirror row_mask:0xf bank_mask:0xf
    v_add_f32_dpp v40, v40, v40 row_half_mirror row_mask:0xf bank_mask:0xf
    v_add_f32_dpp v43, v43, v43 row_half_mirror row_mask:0xf bank_mask:0xf
    v_add_f32_dpp v46, v46, v46 row_half_mirror row_mask:0xf bank_mask:0xf
    v_cndmask_b32 v49, v49, v37, s[72:73]
    v_cndmask_b32 v49, v49, v40, s[74:75]
    v_cndmask_b32 v49, v49, v43, s[76:77]
    v_cndmask_b32 v49, v49, v46, s[78:79]
    v_cvt_pk_bf16_f32 v50, v49, v49
    v_and_b32 v50, 0xffff0000, v50
    v_mul_f32 v50, 0x3d93cd3a, v50
    v_cvt_pk_bf16_f32 v34, v50, v50
    v_and_b32 v34, 0xffff0000, v34
    s_waitcnt vmcnt(36)
    v_dot2_f32_bf16 v37, v160, v16, 0
    v_dot2_f32_bf16 v38, v164, v20, 0
    v_dot2_f32_bf16 v39, v168, v24, 0
    v_dot2_f32_bf16 v40, v172, v16, 0
    v_dot2_f32_bf16 v41, v176, v20, 0
    v_dot2_f32_bf16 v42, v180, v24, 0
    v_dot2_f32_bf16 v43, v184, v16, 0
    v_dot2_f32_bf16 v44, v188, v20, 0
    v_dot2_f32_bf16 v45, v192, v24, 0
    v_dot2_f32_bf16 v46, v196, v16, 0
    v_dot2_f32_bf16 v47, v200, v20, 0
    v_dot2_f32_bf16 v48, v204, v24, 0
    v_dot2c_f32_bf16 v37, v161, v17
    v_dot2c_f32_bf16 v38, v165, v21
    v_dot2c_f32_bf16 v39, v169, v25
    v_dot2c_f32_bf16 v40, v173, v17
    v_dot2c_f32_bf16 v41, v177, v21
    v_dot2c_f32_bf16 v42, v181, v25
    v_dot2c_f32_bf16 v43, v185, v17
    v_dot2c_f32_bf16 v44, v189, v21
    v_dot2c_f32_bf16 v45, v193, v25
    v_dot2c_f32_bf16 v46, v197, v17
    v_dot2c_f32_bf16 v47, v201, v21
    v_dot2c_f32_bf16 v48, v205, v25
    v_dot2c_f32_bf16 v37, v162, v18
    v_dot2c_f32_bf16 v38, v166, v22
    v_dot2c_f32_bf16 v39, v170, v26
    v_dot2c_f32_bf16 v40, v174, v18
    v_dot2c_f32_bf16 v41, v178, v22
    v_dot2c_f32_bf16 v42, v182, v26
    v_dot2c_f32_bf16 v43, v186, v18
    v_dot2c_f32_bf16 v44, v190, v22
    v_dot2c_f32_bf16 v45, v194, v26
    v_dot2c_f32_bf16 v46, v198, v18
    v_dot2c_f32_bf16 v47, v202, v22
    v_dot2c_f32_bf16 v48, v206, v26
    v_dot2c_f32_bf16 v37, v163, v19
    v_dot2c_f32_bf16 v38, v167, v23
    v_dot2c_f32_bf16 v39, v171, v27
    v_dot2c_f32_bf16 v40, v175, v19
    v_dot2c_f32_bf16 v41, v179, v23
    v_dot2c_f32_bf16 v42, v183, v27
    v_dot2c_f32_bf16 v43, v187, v19
    v_dot2c_f32_bf16 v44, v191, v23
    v_dot2c_f32_bf16 v45, v195, v27
    v_dot2c_f32_bf16 v46, v199, v19
    v_dot2c_f32_bf16 v47, v203, v23
    v_dot2c_f32_bf16 v48, v207, v27
    buffer_load_dwordx4 v[160:163], v2, s[56:59], s60 offen offset:0 nt
    buffer_load_dwordx4 v[164:167], v2, s[56:59], s60 offen offset:128 nt
    buffer_load_dwordx4 v[168:171], v2, s[56:59], s60 offen offset:256 nt
    s_add_u32 s60, s60, 24576
    buffer_load_dwordx4 v[172:175], v2, s[56:59], s60 offen offset:0 nt
    buffer_load_dwordx4 v[176:179], v2, s[56:59], s60 offen offset:128 nt
    buffer_load_dwordx4 v[180:183], v2, s[56:59], s60 offen offset:256 nt
    s_add_u32 s60, s60, 24576
    buffer_load_dwordx4 v[184:187], v2, s[56:59], s60 offen offset:0 nt
    buffer_load_dwordx4 v[188:191], v2, s[56:59], s60 offen offset:128 nt
    buffer_load_dwordx4 v[192:195], v2, s[56:59], s60 offen offset:256 nt
    s_add_u32 s60, s60, 24576
    buffer_load_dwordx4 v[196:199], v2, s[56:59], s60 offen offset:0 nt
    buffer_load_dwordx4 v[200:203], v2, s[56:59], s60 offen offset:128 nt
    buffer_load_dwordx4 v[204:207], v2, s[56:59], s60 offen offset:256 nt
    s_add_u32 s60, s60, 24576
    v_add_f32 v37, v37, v38
    v_add_f32 v40, v40, v41
    v_add_f32 v43, v43, v44
    v_add_f32 v46, v46, v47
    v_add_f32 v37, v37, v39
    v_add_f32 v40, v40, v42
    v_add_f32 v43, v43, v45
    v_add_f32 v46, v46, v48
    v_add_f32_dpp v37, v37, v37 quad_perm:[1,0,3,2] row_mask:0xf bank_mask:0xf
    v_add_f32_dpp v40, v40, v40 quad_perm:[1,0,3,2] row_mask:0xf bank_mask:0xf
    v_add_f32_dpp v43, v43, v43 quad_perm:[1,0,3,2] row_mask:0xf bank_mask:0xf
    v_add_f32_dpp v46, v46, v46 quad_perm:[1,0,3,2] row_mask:0xf bank_mask:0xf
    v_add_f32_dpp v37, v37, v37 quad_perm:[2,3,0,1] row_mask:0xf bank_mask:0xf
    v_add_f32_dpp v40, v40, v40 quad_perm:[2,3,0,1] row_mask:0xf bank_mask:0xf
    v_add_f32_dpp v43, v43, v43 quad_perm:[2,3,0,1] row_mask:0xf bank_mask:0xf
    v_add_f32_dpp v46, v46, v46 quad_perm:[2,3,0,1] row_mask:0xf bank_mask:0xf
    v_add_f32_dpp v37, v37, v37 row_half_mirror row_mask:0xf bank_mask:0xf
    v_add_f32_dpp v40, v40, v40 row_half_mirror row_mask:0xf bank_mask:0xf
    v_add_f32_dpp v43, v43, v43 row_half_mirror row_mask:0xf bank_mask:0xf
    v_add_f32_dpp v46, v46, v46 row_half_mirror row_mask:0xf bank_mask:0xf
    v_cndmask_b32 v49, v49, v37, s[64:65]
    v_cndmask_b32 v49, v49, v40, s[66:67]
    v_cndmask_b32 v49, v49, v43, s[68:69]
    v_cndmask_b32 v49, v49, v46, s[70:71]
    s_waitcnt vmcnt(36)
    v_dot2_f32_bf16 v37, v208, v16, 0
    v_dot2_f32_bf16 v38, v212, v20, 0
    v_dot2_f32_bf16 v39, v216, v24, 0
    v_dot2_f32_bf16 v40, v220, v16, 0
    v_dot2_f32_bf16 v41, v224, v20, 0
    v_dot2_f32_bf16 v42, v228, v24, 0
    v_dot2_f32_bf16 v43, v232, v16, 0
    v_dot2_f32_bf16 v44, v236, v20, 0
    v_dot2_f32_bf16 v45, v240, v24, 0
    v_dot2_f32_bf16 v46, v244, v16, 0
    v_dot2_f32_bf16 v47, v248, v20, 0
    v_dot2_f32_bf16 v48, v252, v24, 0
    v_dot2c_f32_bf16 v37, v209, v17
    v_dot2c_f32_bf16 v38, v213, v21
    v_dot2c_f32_bf16 v39, v217, v25
    v_dot2c_f32_bf16 v40, v221, v17
    v_dot2c_f32_bf16 v41, v225, v21
    v_dot2c_f32_bf16 v42, v229, v25
    v_dot2c_f32_bf16 v43, v233, v17
    v_dot2c_f32_bf16 v44, v237, v21
    v_dot2c_f32_bf16 v45, v241, v25
    v_dot2c_f32_bf16 v46, v245, v17
    v_dot2c_f32_bf16 v47, v249, v21
    v_dot2c_f32_bf16 v48, v253, v25
    v_dot2c_f32_bf16 v37, v210, v18
    v_dot2c_f32_bf16 v38, v214, v22
    v_dot2c_f32_bf16 v39, v218, v26
    v_dot2c_f32_bf16 v40, v222, v18
    v_dot2c_f32_bf16 v41, v226, v22
    v_dot2c_f32_bf16 v42, v230, v26
    v_dot2c_f32_bf16 v43, v234, v18
    v_dot2c_f32_bf16 v44, v238, v22
    v_dot2c_f32_bf16 v45, v242, v26
    v_dot2c_f32_bf16 v46, v246, v18
    v_dot2c_f32_bf16 v47, v250, v22
    v_dot2c_f32_bf16 v48, v254, v26
    v_dot2c_f32_bf16 v37, v211, v19
    v_dot2c_f32_bf16 v38, v215, v23
    v_dot2c_f32_bf16 v39, v219, v27
    v_dot2c_f32_bf16 v40, v223, v19
    v_dot2c_f32_bf16 v41, v227, v23
    v_dot2c_f32_bf16 v42, v231, v27
    v_dot2c_f32_bf16 v43, v235, v19
    v_dot2c_f32_bf16 v44, v239, v23
    v_dot2c_f32_bf16 v45, v243, v27
    v_dot2c_f32_bf16 v46, v247, v19
    v_dot2c_f32_bf16 v47, v251, v23
    v_dot2c_f32_bf16 v48, v255, v27
    buffer_load_dwordx4 v[208:211], v2, s[56:59], s60 offen offset:0 nt
    buffer_load_dwordx4 v[212:215], v2, s[56:59], s60 offen offset:128 nt
    buffer_load_dwordx4 v[216:219], v2, s[56:59], s60 offen offset:256 nt
    s_add_u32 s60, s60, 24576
    buffer_load_dwordx4 v[220:223], v2, s[56:59], s60 offen offset:0 nt
    buffer_load_dwordx4 v[224:227], v2, s[56:59], s60 offen offset:128 nt
    buffer_load_dwordx4 v[228:231], v2, s[56:59], s60 offen offset:256 nt
    s_add_u32 s60, s60, 24576
    buffer_load_dwordx4 v[232:235], v2, s[56:59], s60 offen offset:0 nt
    buffer_load_dwordx4 v[236:239], v2, s[56:59], s60 offen offset:128 nt
    buffer_load_dwordx4 v[240:243], v2, s[56:59], s60 offen offset:256 nt
    s_add_u32 s60, s60, 24576
    buffer_load_dwordx4 v[244:247], v2, s[56:59], s60 offen offset:0 nt
    buffer_load_dwordx4 v[248:251], v2, s[56:59], s60 offen offset:128 nt
    buffer_load_dwordx4 v[252:255], v2, s[56:59], s60 offen offset:256 nt
    s_add_u32 s60, s60, 24576
    v_add_f32 v37, v37, v38
    v_add_f32 v40, v40, v41
    v_add_f32 v43, v43, v44
    v_add_f32 v46, v46, v47
    v_add_f32 v37, v37, v39
    v_add_f32 v40, v40, v42
    v_add_f32 v43, v43, v45
    v_add_f32 v46, v46, v48
    v_add_f32_dpp v37, v37, v37 quad_perm:[1,0,3,2] row_mask:0xf bank_mask:0xf
    v_add_f32_dpp v40, v40, v40 quad_perm:[1,0,3,2] row_mask:0xf bank_mask:0xf
    v_add_f32_dpp v43, v43, v43 quad_perm:[1,0,3,2] row_mask:0xf bank_mask:0xf
    v_add_f32_dpp v46, v46, v46 quad_perm:[1,0,3,2] row_mask:0xf bank_mask:0xf
    v_add_f32_dpp v37, v37, v37 quad_perm:[2,3,0,1] row_mask:0xf bank_mask:0xf
    v_add_f32_dpp v40, v40, v40 quad_perm:[2,3,0,1] row_mask:0xf bank_mask:0xf
    v_add_f32_dpp v43, v43, v43 quad_perm:[2,3,0,1] row_mask:0xf bank_mask:0xf
    v_add_f32_dpp v46, v46, v46 quad_perm:[2,3,0,1] row_mask:0xf bank_mask:0xf
    v_add_f32_dpp v37, v37, v37 row_half_mirror row_mask:0xf bank_mask:0xf
    v_add_f32_dpp v40, v40, v40 row_half_mirror row_mask:0xf bank_mask:0xf
    v_add_f32_dpp v43, v43, v43 row_half_mirror row_mask:0xf bank_mask:0xf
    v_add_f32_dpp v46, v46, v46 row_half_mirror row_mask:0xf bank_mask:0xf
    v_cndmask_b32 v49, v49, v37, s[72:73]
    v_cndmask_b32 v49, v49, v40, s[74:75]
    v_cndmask_b32 v49, v49, v43, s[76:77]
    v_cndmask_b32 v49, v49, v46, s[78:79]
    v_cvt_pk_bf16_f32 v50, v49, v49
    v_and_b32 v50, 0xffff0000, v50
    v_mul_f32 v50, 0x3d93cd3a, v50
    v_cvt_pk_bf16_f32 v35, v50, v50
    v_and_b32 v35, 0xffff0000, v35
    s_sub_i32 s97, s62, 56
    s_max_i32 s97, s97, 0
    v_and_b32 v3, 7, v1
    v_mov_b32 v4, 0xff800000
    v_cmp_gt_u32 vcc, s97, v3
    s_nop 1
    v_cndmask_b32 v35, v4, v35, vcc
    s_waitcnt vmcnt(36)
    v_dot2_f32_bf16 v37, v64, v16, 0
    v_dot2_f32_bf16 v38, v68, v20, 0
    v_dot2_f32_bf16 v39, v72, v24, 0
    v_dot2_f32_bf16 v40, v76, v16, 0
    v_dot2_f32_bf16 v41, v80, v20, 0
    v_dot2_f32_bf16 v42, v84, v24, 0
    v_dot2_f32_bf16 v43, v88, v16, 0
    v_dot2_f32_bf16 v44, v92, v20, 0
    v_dot2_f32_bf16 v45, v96, v24, 0
    v_dot2_f32_bf16 v46, v100, v16, 0
    v_dot2_f32_bf16 v47, v104, v20, 0
    v_dot2_f32_bf16 v48, v108, v24, 0
    v_dot2c_f32_bf16 v37, v65, v17
    v_dot2c_f32_bf16 v38, v69, v21
    v_dot2c_f32_bf16 v39, v73, v25
    v_dot2c_f32_bf16 v40, v77, v17
    v_dot2c_f32_bf16 v41, v81, v21
    v_dot2c_f32_bf16 v42, v85, v25
    v_dot2c_f32_bf16 v43, v89, v17
    v_dot2c_f32_bf16 v44, v93, v21
    v_dot2c_f32_bf16 v45, v97, v25
    v_dot2c_f32_bf16 v46, v101, v17
    v_dot2c_f32_bf16 v47, v105, v21
    v_dot2c_f32_bf16 v48, v109, v25
    v_dot2c_f32_bf16 v37, v66, v18
    v_dot2c_f32_bf16 v38, v70, v22
    v_dot2c_f32_bf16 v39, v74, v26
    v_dot2c_f32_bf16 v40, v78, v18
    v_dot2c_f32_bf16 v41, v82, v22
    v_dot2c_f32_bf16 v42, v86, v26
    v_dot2c_f32_bf16 v43, v90, v18
    v_dot2c_f32_bf16 v44, v94, v22
    v_dot2c_f32_bf16 v45, v98, v26
    v_dot2c_f32_bf16 v46, v102, v18
    v_dot2c_f32_bf16 v47, v106, v22
    v_dot2c_f32_bf16 v48, v110, v26
    v_dot2c_f32_bf16 v37, v67, v19
    v_dot2c_f32_bf16 v38, v71, v23
    v_dot2c_f32_bf16 v39, v75, v27
    v_dot2c_f32_bf16 v40, v79, v19
    v_dot2c_f32_bf16 v41, v83, v23
    v_dot2c_f32_bf16 v42, v87, v27
    v_dot2c_f32_bf16 v43, v91, v19
    v_dot2c_f32_bf16 v44, v95, v23
    v_dot2c_f32_bf16 v45, v99, v27
    v_dot2c_f32_bf16 v46, v103, v19
    v_dot2c_f32_bf16 v47, v107, v23
    v_dot2c_f32_bf16 v48, v111, v27
    buffer_load_dwordx4 v[64:67], v2, s[56:59], s60 offen offset:0 nt
    buffer_load_dwordx4 v[68:71], v2, s[56:59], s60 offen offset:128 nt
    buffer_load_dwordx4 v[72:75], v2, s[56:59], s60 offen offset:256 nt
    s_add_u32 s60, s60, 24576
    buffer_load_dwordx4 v[76:79], v2, s[56:59], s60 offen offset:0 nt
    buffer_load_dwordx4 v[80:83], v2, s[56:59], s60 offen offset:128 nt
    buffer_load_dwordx4 v[84:87], v2, s[56:59], s60 offen offset:256 nt
    s_add_u32 s60, s60, 24576
    buffer_load_dwordx4 v[88:91], v2, s[56:59], s60 offen offset:0 nt
    buffer_load_dwordx4 v[92:95], v2, s[56:59], s60 offen offset:128 nt
    buffer_load_dwordx4 v[96:99], v2, s[56:59], s60 offen offset:256 nt
    s_add_u32 s60, s60, 24576
    buffer_load_dwordx4 v[100:103], v2, s[56:59], s60 offen offset:0 nt
    buffer_load_dwordx4 v[104:107], v2, s[56:59], s60 offen offset:128 nt
    buffer_load_dwordx4 v[108:111], v2, s[56:59], s60 offen offset:256 nt
    s_add_u32 s60, s60, 24576
    v_add_f32 v37, v37, v38
    v_add_f32 v40, v40, v41
    v_add_f32 v43, v43, v44
    v_add_f32 v46, v46, v47
    v_add_f32 v37, v37, v39
    v_add_f32 v40, v40, v42
    v_add_f32 v43, v43, v45
    v_add_f32 v46, v46, v48
    v_add_f32_dpp v37, v37, v37 quad_perm:[1,0,3,2] row_mask:0xf bank_mask:0xf
    v_add_f32_dpp v40, v40, v40 quad_perm:[1,0,3,2] row_mask:0xf bank_mask:0xf
    v_add_f32_dpp v43, v43, v43 quad_perm:[1,0,3,2] row_mask:0xf bank_mask:0xf
    v_add_f32_dpp v46, v46, v46 quad_perm:[1,0,3,2] row_mask:0xf bank_mask:0xf
    v_add_f32_dpp v37, v37, v37 quad_perm:[2,3,0,1] row_mask:0xf bank_mask:0xf
    v_add_f32_dpp v40, v40, v40 quad_perm:[2,3,0,1] row_mask:0xf bank_mask:0xf
    v_add_f32_dpp v43, v43, v43 quad_perm:[2,3,0,1] row_mask:0xf bank_mask:0xf
    v_add_f32_dpp v46, v46, v46 quad_perm:[2,3,0,1] row_mask:0xf bank_mask:0xf
    v_add_f32_dpp v37, v37, v37 row_half_mirror row_mask:0xf bank_mask:0xf
    v_add_f32_dpp v40, v40, v40 row_half_mirror row_mask:0xf bank_mask:0xf
    v_add_f32_dpp v43, v43, v43 row_half_mirror row_mask:0xf bank_mask:0xf
    v_add_f32_dpp v46, v46, v46 row_half_mirror row_mask:0xf bank_mask:0xf
    v_cndmask_b32 v49, v49, v37, s[64:65]
    v_cndmask_b32 v49, v49, v40, s[66:67]
    v_cndmask_b32 v49, v49, v43, s[68:69]
    v_cndmask_b32 v49, v49, v46, s[70:71]
    v_cvt_pk_bf16_f32 v50, v49, v49
    v_and_b32 v50, 0xffff0000, v50
    v_mul_f32 v50, 0x3d93cd3a, v50
    v_cvt_pk_bf16_f32 v36, v50, v50
    v_and_b32 v36, 0xffff0000, v36
    s_sub_i32 s97, s62, 64
    s_max_i32 s97, s97, 0
    v_and_b32 v3, 7, v1
    v_mov_b32 v4, 0xff800000
    v_cmp_gt_u32 vcc, s97, v3
    s_nop 1
    v_cndmask_b32 v36, v4, v36, vcc
    v_max3_f32 v40, v28, v29, v30
    v_max3_f32 v40, v40, v31, v32
    v_max3_f32 v40, v40, v33, v34
    v_max3_f32 v40, v40, v35, v36
    s_nop 1
    v_max_f32_dpp v40, v40, v40 quad_perm:[1,0,3,2] row_mask:0xf bank_mask:0xf
    s_nop 1
    v_max_f32_dpp v40, v40, v40 quad_perm:[2,3,0,1] row_mask:0xf bank_mask:0xf
    s_nop 1
    v_max_f32_dpp v40, v40, v40 row_half_mirror row_mask:0xf bank_mask:0xf
    s_nop 1
    v_max_f32_dpp v40, v40, v40 row_mirror row_mask:0xf bank_mask:0xf
    v_mov_b32 v42, v40
    s_nop 1
    v_permlane16_swap_b32 v40, v42
    s_nop 1
    v_max_f32 v40, v40, v42
    v_mov_b32 v42, v40
    s_nop 1
    v_permlane32_swap_b32 v40, v42
    s_nop 1
    v_max_f32 v40, v40, v42
    v_mov_b32 v41, 0
    v_sub_f32 v42, v28, v40
    v_mul_f32 v42, 0x3fb8aa3b, v42
    v_exp_f32 v42, v42
    s_nop 0
    v_add_f32 v41, v41, v42
    v_sub_f32 v42, v29, v40
    v_mul_f32 v42, 0x3fb8aa3b, v42
    v_exp_f32 v42, v42
    s_nop 0
    v_add_f32 v41, v41, v42
    v_sub_f32 v42, v30, v40
    v_mul_f32 v42, 0x3fb8aa3b, v42
    v_exp_f32 v42, v42
    s_nop 0
    v_add_f32 v41, v41, v42
    v_sub_f32 v42, v31, v40
    v_mul_f32 v42, 0x3fb8aa3b, v42
    v_exp_f32 v42, v42
    s_nop 0
    v_add_f32 v41, v41, v42
    v_sub_f32 v42, v32, v40
    v_mul_f32 v42, 0x3fb8aa3b, v42
    v_exp_f32 v42, v42
    s_nop 0
    v_add_f32 v41, v41, v42
    v_sub_f32 v42, v33, v40
    v_mul_f32 v42, 0x3fb8aa3b, v42
    v_exp_f32 v42, v42
    s_nop 0
    v_add_f32 v41, v41, v42
    v_sub_f32 v42, v34, v40
    v_mul_f32 v42, 0x3fb8aa3b, v42
    v_exp_f32 v42, v42
    s_nop 0
    v_add_f32 v41, v41, v42
    v_sub_f32 v42, v35, v40
    v_mul_f32 v42, 0x3fb8aa3b, v42
    v_exp_f32 v42, v42
    s_nop 0
    v_add_f32 v41, v41, v42
    v_sub_f32 v42, v36, v40
    v_mul_f32 v42, 0x3fb8aa3b, v42
    v_exp_f32 v42, v42
    s_nop 0
    v_add_f32 v41, v41, v42
    s_nop 1
    v_add_f32_dpp v41, v41, v41 quad_perm:[1,0,3,2] row_mask:0xf bank_mask:0xf
    s_nop 1
    v_add_f32_dpp v41, v41, v41 quad_perm:[2,3,0,1] row_mask:0xf bank_mask:0xf
    s_nop 1
    v_add_f32_dpp v41, v41, v41 row_half_mirror row_mask:0xf bank_mask:0xf
    s_nop 1
    v_add_f32_dpp v41, v41, v41 row_mirror row_mask:0xf bank_mask:0xf
    v_mov_b32 v42, v41
    s_nop 1
    v_permlane16_swap_b32 v41, v42
    s_nop 1
    v_add_f32 v41, v41, v42
    v_mov_b32 v42, v41
    s_nop 1
    v_permlane32_swap_b32 v41, v42
    s_nop 1
    v_add_f32 v41, v41, v42
    s_lshl_b32 s97, s96, 3
    s_add_u32 s97, s97, s3
    s_lshl_b32 s97, s97, 3
    s_add_u32 s97, s97, 32768
    v_mov_b32 v3, s97
    v_cmp_eq_u32 vcc, 0, v1
    s_and_saveexec_b64 s[4:5], vcc
    s_cbranch_execz L_m_52
    global_store_dwordx2 v3, v[40:41], s[42:43] sc1
L_m_52:
    s_mov_b64 exec, s[4:5]
    s_cmp_lg_u32 s3, 0
    s_cbranch_scc1 L_nw0_53
    s_cmp_ge_u32 s2, 40
    s_cbranch_scc1 L_m2_54
    s_lshl_b32 s97, s2, 8
    s_add_u32 s97, s97, 5120
    v_lshl_add_u32 v3, v1, 2, s97
    s_add_u32 s10, s42, 409600
    s_addc_u32 s11, s43, 0
    global_load_dword v44, v3, s[10:11] sc1
    s_add_u32 s10, s42, 424960
    s_addc_u32 s11, s43, 0
    global_load_dword v45, v3, s[10:11] sc1
    s_add_u32 s10, s42, 440320
    s_addc_u32 s11, s43, 0
    global_load_dword v46, v3, s[10:11] sc1
    s_add_u32 s10, s42, 455680
    s_addc_u32 s11, s43, 0
    global_load_dword v47, v3, s[10:11] sc1
    s_waitcnt vmcnt(0)
    v_add_f32 v44, v44, v45
    v_add_f32 v46, v46, v47
    v_add_f32 v44, v44, v46
    v_cvt_pk_bf16_f32 v44, v44, v44
    v_and_b32 v44, 0xffff0000, v44
    global_store_dword v3, v44, s[42:43] offset:0 sc1
L_m2_54:
    s_lshl_b32 s97, s46, 9
    s_add_u32 s97, s97, 32768
    v_lshl_add_u32 v3, v1, 3, s97
    s_mov_b32 s63, 0
L_spin_55:
    global_load_dwordx2 v[42:43], v3, s[42:43] sc1
    s_waitcnt vmcnt(0)
    v_max_u32 v4, v42, v43
    v_cmp_eq_u32 vcc, -1, v4
    s_nop 1
    s_cbranch_vccz L_spun_56
    s_add_u32 s63, s63, 1
    s_cmp_ge_u32 s63, 65536
    s_cbranch_scc1 L_spun_56
    s_sleep 1
    s_branch L_spin_55
L_spun_56:
    s_mov_b32 s60, s61
    buffer_load_dwordx4 v[112:115], v2, s[52:55], s60 offen offset:0 nt
    buffer_load_dwordx4 v[116:119], v2, s[52:55], s60 offen offset:128 nt
    buffer_load_dwordx4 v[120:123], v2, s[52:55], s60 offen offset:256 nt
    s_add_u32 s60, s60, 24576
    buffer_load_dwordx4 v[124:127], v2, s[52:55], s60 offen offset:0 nt
    buffer_load_dwordx4 v[128:131], v2, s[52:55], s60 offen offset:128 nt
    buffer_load_dwordx4 v[132:135], v2, s[52:55], s60 offen offset:256 nt
    s_add_u32 s60, s60, 24576
    buffer_load_dwordx4 v[136:139], v2, s[52:55], s60 offen offset:0 nt
    buffer_load_dwordx4 v[140:143], v2, s[52:55], s60 offen offset:128 nt
    buffer_load_dwordx4 v[144:147], v2, s[52:55], s60 offen offset:256 nt
    s_add_u32 s60, s60, 24576
    buffer_load_dwordx4 v[148:151], v2, s[52:55], s60 offen offset:0 nt
    buffer_load_dwordx4 v[152:155], v2, s[52:55], s60 offen offset:128 nt
    buffer_load_dwordx4 v[156:159], v2, s[52:55], s60 offen offset:256 nt
    s_add_u32 s60, s60, 24576
    buffer_load_dwordx4 v[160:163], v2, s[52:55], s60 offen offset:0 nt
    buffer_load_dwordx4 v[164:167], v2, s[52:55], s60 offen offset:128 nt
    buffer_load_dwordx4 v[168:171], v2, s[52:55], s60 offen offset:256 nt
    s_add_u32 s60, s60, 24576
    buffer_load_dwordx4 v[172:175], v2, s[52:55], s60 offen offset:0 nt
    buffer_load_dwordx4 v[176:179], v2, s[52:55], s60 offen offset:128 nt
    buffer_load_dwordx4 v[180:183], v2, s[52:55], s60 offen offset:256 nt
    s_add_u32 s60, s60, 24576
    buffer_load_dwordx4 v[184:187], v2, s[52:55], s60 offen offset:0 nt
    buffer_load_dwordx4 v[188:191], v2, s[52:55], s60 offen offset:128 nt
    buffer_load_dwordx4 v[192:195], v2, s[52:55], s60 offen offset:256 nt
    s_add_u32 s60, s60, 24576
    buffer_load_dwordx4 v[196:199], v2, s[52:55], s60 offen offset:0 nt
    buffer_load_dwordx4 v[200:203], v2, s[52:55], s60 offen offset:128 nt
    buffer_load_dwordx4 v[204:207], v2, s[52:55], s60 offen offset:256 nt
    s_add_u32 s60, s60, 24576
    buffer_load_dwordx4 v[208:211], v2, s[52:55], s60 offen offset:0 nt
    buffer_load_dwordx4 v[212:215], v2, s[52:55], s60 offen offset:128 nt
    buffer_load_dwordx4 v[216:219], v2, s[52:55], s60 offen offset:256 nt
    s_add_u32 s60, s60, 24576
    buffer_load_dwordx4 v[220:223], v2, s[52:55], s60 offen offset:0 nt
    buffer_load_dwordx4 v[224:227], v2, s[52:55], s60 offen offset:128 nt
    buffer_load_dwordx4 v[228:231], v2, s[52:55], s60 offen offset:256 nt
    s_add_u32 s60, s60, 24576
    buffer_load_dwordx4 v[232:235], v2, s[52:55], s60 offen offset:0 nt
    buffer_load_dwordx4 v[236:239], v2, s[52:55], s60 offen offset:128 nt
    buffer_load_dwordx4 v[240:243], v2, s[52:55], s60 offen offset:256 nt
    s_add_u32 s60, s60, 24576
    buffer_load_dwordx4 v[244:247], v2, s[52:55], s60 offen offset:0 nt
    buffer_load_dwordx4 v[248:251], v2, s[52:55], s60 offen offset:128 nt
    buffer_load_dwordx4 v[252:255], v2, s[52:55], s60 offen offset:256 nt
    s_add_u32 s60, s60, 24576
    buffer_load_dwordx4 v[64:67], v2, s[52:55], s60 offen offset:0 nt
    buffer_load_dwordx4 v[68:71], v2, s[52:55], s60 offen offset:128 nt
    buffer_load_dwordx4 v[72:75], v2, s[52:55], s60 offen offset:256 nt
    s_add_u32 s60, s60, 24576
    buffer_load_dwordx4 v[76:79], v2, s[52:55], s60 offen offset:0 nt
    buffer_load_dwordx4 v[80:83], v2, s[52:55], s60 offen offset:128 nt
    buffer_load_dwordx4 v[84:87], v2, s[52:55], s60 offen offset:256 nt
    s_add_u32 s60, s60, 24576
    buffer_load_dwordx4 v[88:91], v2, s[52:55], s60 offen offset:0 nt
    buffer_load_dwordx4 v[92:95], v2, s[52:55], s60 offen offset:128 nt
    buffer_load_dwordx4 v[96:99], v2, s[52:55], s60 offen offset:256 nt
    s_add_u32 s60, s60, 24576
    buffer_load_dwordx4 v[100:103], v2, s[52:55], s60 offen offset:0 nt
    buffer_load_dwordx4 v[104:107], v2, s[52:55], s60 offen offset:128 nt
    buffer_load_dwordx4 v[108:111], v2, s[52:55], s60 offen offset:256 nt
    s_add_u32 s60, s60, 24576
    v_mov_b32 v44, v42
    s_nop 1
    v_max_f32_dpp v44, v44, v44 quad_perm:[1,0,3,2] row_mask:0xf bank_mask:0xf
    s_nop 1
    v_max_f32_dpp v44, v44, v44 quad_perm:[2,3,0,1] row_mask:0xf bank_mask:0xf
    s_nop 1
    v_max_f32_dpp v44, v44, v44 row_half_mirror row_mask:0xf bank_mask:0xf
    s_nop 1
    v_max_f32_dpp v44, v44, v44 row_mirror row_mask:0xf bank_mask:0xf
    v_mov_b32 v45, v44
    s_nop 1
    v_permlane16_swap_b32 v44, v45
    s_nop 1
    v_max_f32 v44, v44, v45
    v_mov_b32 v45, v44
    s_nop 1
    v_permlane32_swap_b32 v44, v45
    s_nop 1
    v_max_f32 v44, v44, v45
    v_sub_f32 v45, v42, v44
    v_mul_f32 v45, 0x3fb8aa3b, v45
    v_exp_f32 v45, v45
    s_nop 0
    v_mul_f32 v45, v45, v43
    s_nop 1
    v_add_f32_dpp v45, v45, v45 quad_perm:[1,0,3,2] row_mask:0xf bank_mask:0xf
    s_nop 1
    v_add_f32_dpp v45, v45, v45 quad_perm:[2,3,0,1] row_mask:0xf bank_mask:0xf
    s_nop 1
    v_add_f32_dpp v45, v45, v45 row_half_mirror row_mask:0xf bank_mask:0xf
    s_nop 1
    v_add_f32_dpp v45, v45, v45 row_mirror row_mask:0xf bank_mask:0xf
    v_mov_b32 v46, v45
    s_nop 1
    v_permlane16_swap_b32 v45, v46
    s_nop 1
    v_add_f32 v45, v45, v46
    v_mov_b32 v46, v45
    s_nop 1
    v_permlane32_swap_b32 v45, v46
    s_nop 1
    v_add_f32 v45, v45, v46
    v_mov_b32 v46, 1.0
    v_rcp_f32 v48, v45
    s_nop 0
    v_mul_f32 v49, v46, v48
    v_fma_f32 v47, -v49, v45, v46
    v_fma_f32 v47, v47, v48, v49
    v_mov_b32 v45, v47
    v_mov_b32 v3, 0
    v_cmp_eq_u32 vcc, 0, v1
    s_and_saveexec_b64 s[4:5], vcc
    s_cbranch_execz L_m_57
    ds_write_b64 v3, v[44:45] offset:6784
L_m_57:
    s_mov_b64 exec, s[4:5]
    s_waitcnt lgkmcnt(0)
L_nw0_53:
    s_barrier
    v_mov_b32 v3, 0
    ds_read_b64 v[44:45], v3 offset:6784
    s_waitcnt lgkmcnt(0)
    v_sub_f32 v42, v28, v44
    v_mul_f32 v42, 0x3fb8aa3b, v42
    v_exp_f32 v42, v42
    s_nop 0
    v_mul_f32 v42, v42, v45
    v_cvt_pk_bf16_f32 v42, v42, v42
    v_lshrrev_b32 v28, 16, v42
    v_sub_f32 v42, v29, v44
    v_mul_f32 v42, 0x3fb8aa3b, v42
    v_exp_f32 v42, v42
    s_nop 0
    v_mul_f32 v42, v42, v45
    v_cvt_pk_bf16_f32 v42, v42, v42
    v_lshrrev_b32 v29, 16, v42
    v_sub_f32 v42, v30, v44
    v_mul_f32 v42, 0x3fb8aa3b, v42
    v_exp_f32 v42, v42
    s_nop 0
    v_mul_f32 v42, v42, v45
    v_cvt_pk_bf16_f32 v42, v42, v42
    v_lshrrev_b32 v30, 16, v42
    v_sub_f32 v42, v31, v44
    v_mul_f32 v42, 0x3fb8aa3b, v42
    v_exp_f32 v42, v42
    s_nop 0
    v_mul_f32 v42, v42, v45
    v_cvt_pk_bf16_f32 v42, v42, v42
    v_lshrrev_b32 v31, 16, v42
    v_sub_f32 v42, v32, v44
    v_mul_f32 v42, 0x3fb8aa3b, v42
    v_exp_f32 v42, v42
    s_nop 0
    v_mul_f32 v42, v42, v45
    v_cvt_pk_bf16_f32 v42, v42, v42
    v_lshrrev_b32 v32, 16, v42
    v_sub_f32 v42, v33, v44
    v_mul_f32 v42, 0x3fb8aa3b, v42
    v_exp_f32 v42, v42
    s_nop 0
    v_mul_f32 v42, v42, v45
    v_cvt_pk_bf16_f32 v42, v42, v42
    v_lshrrev_b32 v33, 16, v42
    v_sub_f32 v42, v34, v44
    v_mul_f32 v42, 0x3fb8aa3b, v42
    v_exp_f32 v42, v42
    s_nop 0
    v_mul_f32 v42, v42, v45
    v_cvt_pk_bf16_f32 v42, v42, v42
    v_lshrrev_b32 v34, 16, v42
    v_sub_f32 v42, v35, v44
    v_mul_f32 v42, 0x3fb8aa3b, v42
    v_exp_f32 v42, v42
    s_nop 0
    v_mul_f32 v42, v42, v45
    v_cvt_pk_bf16_f32 v42, v42, v42
    v_lshrrev_b32 v35, 16, v42
    v_sub_f32 v42, v36, v44
    v_mul_f32 v42, 0x3fb8aa3b, v42
    v_exp_f32 v42, v42
    s_nop 0
    v_mul_f32 v42, v42, v45
    v_cvt_pk_bf16_f32 v42, v42, v42
    v_lshrrev_b32 v36, 16, v42
    v_mov_b32 v37, 0
    v_mov_b32 v38, 0
    v_mov_b32 v39, 0
    v_mov_b32 v40, 0
    v_mov_b32 v41, 0
    v_mov_b32 v42, 0
    v_mov_b32 v43, 0
    v_mov_b32 v44, 0
    v_mov_b32 v45, 0
    v_mov_b32 v46, 0
    v_mov_b32 v47, 0
    v_mov_b32 v48, 0
    v_mov_b32 v49, 0
    v_mov_b32 v50, 0
    v_mov_b32 v51, 0
    v_mov_b32 v52, 0
    v_mov_b32 v53, 0
    v_mov_b32 v54, 0
    v_mov_b32 v55, 0
    v_mov_b32 v56, 0
    v_mov_b32 v57, 0
    v_mov_b32 v58, 0
    v_mov_b32 v59, 0
    v_mov_b32 v60, 0
    s_waitcnt vmcnt(36)
    v_mov_b32_dpp v12, v28 row_newbcast:0 row_mask:0xf bank_mask:0x3
    v_mov_b32_dpp v12, v28 row_newbcast:8 row_mask:0xf bank_mask:0xc
    v_lshlrev_b32 v13, 16, v12
    v_dot2c_f32_bf16 v37, v112, v12
    v_dot2c_f32_bf16 v38, v112, v13
    v_dot2c_f32_bf16 v39, v113, v12
    v_dot2c_f32_bf16 v40, v113, v13
    v_dot2c_f32_bf16 v41, v114, v12
    v_dot2c_f32_bf16 v42, v114, v13
    v_dot2c_f32_bf16 v43, v115, v12
    v_dot2c_f32_bf16 v44, v115, v13
    v_dot2c_f32_bf16 v45, v116, v12
    v_dot2c_f32_bf16 v46, v116, v13
    v_dot2c_f32_bf16 v47, v117, v12
    v_dot2c_f32_bf16 v48, v117, v13
    v_dot2c_f32_bf16 v49, v118, v12
    v_dot2c_f32_bf16 v50, v118, v13
    v_dot2c_f32_bf16 v51, v119, v12
    v_dot2c_f32_bf16 v52, v119, v13
    v_dot2c_f32_bf16 v53, v120, v12
    v_dot2c_f32_bf16 v54, v120, v13
    v_dot2c_f32_bf16 v55, v121, v12
    v_dot2c_f32_bf16 v56, v121, v13
    v_dot2c_f32_bf16 v57, v122, v12
    v_dot2c_f32_bf16 v58, v122, v13
    v_dot2c_f32_bf16 v59, v123, v12
    v_dot2c_f32_bf16 v60, v123, v13
    v_mov_b32_dpp v61, v28 row_newbcast:1 row_mask:0xf bank_mask:0x3
    v_mov_b32_dpp v61, v28 row_newbcast:9 row_mask:0xf bank_mask:0xc
    v_lshlrev_b32 v62, 16, v61
    v_dot2c_f32_bf16 v37, v124, v61
    v_dot2c_f32_bf16 v38, v124, v62
    v_dot2c_f32_bf16 v39, v125, v61
    v_dot2c_f32_bf16 v40, v125, v62
    v_dot2c_f32_bf16 v41, v126, v61
    v_dot2c_f32_bf16 v42, v126, v62
    v_dot2c_f32_bf16 v43, v127, v61
    v_dot2c_f32_bf16 v44, v127, v62
    v_dot2c_f32_bf16 v45, v128, v61
    v_dot2c_f32_bf16 v46, v128, v62
    v_dot2c_f32_bf16 v47, v129, v61
    v_dot2c_f32_bf16 v48, v129, v62
    v_dot2c_f32_bf16 v49, v130, v61
    v_dot2c_f32_bf16 v50, v130, v62
    v_dot2c_f32_bf16 v51, v131, v61
    v_dot2c_f32_bf16 v52, v131, v62
    v_dot2c_f32_bf16 v53, v132, v61
    v_dot2c_f32_bf16 v54, v132, v62
    v_dot2c_f32_bf16 v55, v133, v61
    v_dot2c_f32_bf16 v56, v133, v62
    v_dot2c_f32_bf16 v57, v134, v61
    v_dot2c_f32_bf16 v58, v134, v62
    v_dot2c_f32_bf16 v59, v135, v61
    v_dot2c_f32_bf16 v60, v135, v62
    v_mov_b32_dpp v12, v28 row_newbcast:2 row_mask:0xf bank_mask:0x3
    v_mov_b32_dpp v12, v28 row_newbcast:10 row_mask:0xf bank_mask:0xc
    v_lshlrev_b32 v13, 16, v12
    v_dot2c_f32_bf16 v37, v136, v12
    v_dot2c_f32_bf16 v38, v136, v13
    v_dot2c_f32_bf16 v39, v137, v12
    v_dot2c_f32_bf16 v40, v137, v13
    v_dot2c_f32_bf16 v41, v138, v12
    v_dot2c_f32_bf16 v42, v138, v13
    v_dot2c_f32_bf16 v43, v139, v12
    v_dot2c_f32_bf16 v44, v139, v13
    v_dot2c_f32_bf16 v45, v140, v12
    v_dot2c_f32_bf16 v46, v140, v13
    v_dot2c_f32_bf16 v47, v141, v12
    v_dot2c_f32_bf16 v48, v141, v13
    v_dot2c_f32_bf16 v49, v142, v12
    v_dot2c_f32_bf16 v50, v142, v13
    v_dot2c_f32_bf16 v51, v143, v12
    v_dot2c_f32_bf16 v52, v143, v13
    v_dot2c_f32_bf16 v53, v144, v12
    v_dot2c_f32_bf16 v54, v144, v13
    v_dot2c_f32_bf16 v55, v145, v12
    v_dot2c_f32_bf16 v56, v145, v13
    v_dot2c_f32_bf16 v57, v146, v12
    v_dot2c_f32_bf16 v58, v146, v13
    v_dot2c_f32_bf16 v59, v147, v12
    v_dot2c_f32_bf16 v60, v147, v13
    v_mov_b32_dpp v61, v28 row_newbcast:3 row_mask:0xf bank_mask:0x3
    v_mov_b32_dpp v61, v28 row_newbcast:11 row_mask:0xf bank_mask:0xc
    v_lshlrev_b32 v62, 16, v61
    v_dot2c_f32_bf16 v37, v148, v61
    v_dot2c_f32_bf16 v38, v148, v62
    v_dot2c_f32_bf16 v39, v149, v61
    v_dot2c_f32_bf16 v40, v149, v62
    v_dot2c_f32_bf16 v41, v150, v61
    v_dot2c_f32_bf16 v42, v150, v62
    v_dot2c_f32_bf16 v43, v151, v61
    v_dot2c_f32_bf16 v44, v151, v62
    v_dot2c_f32_bf16 v45, v152, v61
    v_dot2c_f32_bf16 v46, v152, v62
    v_dot2c_f32_bf16 v47, v153, v61
    v_dot2c_f32_bf16 v48, v153, v62
    v_dot2c_f32_bf16 v49, v154, v61
    v_dot2c_f32_bf16 v50, v154, v62
    v_dot2c_f32_bf16 v51, v155, v61
    v_dot2c_f32_bf16 v52, v155, v62
    v_dot2c_f32_bf16 v53, v156, v61
    v_dot2c_f32_bf16 v54, v156, v62
    v_dot2c_f32_bf16 v55, v157, v61
    v_dot2c_f32_bf16 v56, v157, v62
    v_dot2c_f32_bf16 v57, v158, v61
    v_dot2c_f32_bf16 v58, v158, v62
    v_dot2c_f32_bf16 v59, v159, v61
    v_dot2c_f32_bf16 v60, v159, v62
    buffer_load_dwordx4 v[112:115], v2, s[52:55], s60 offen offset:0 nt
    buffer_load_dwordx4 v[116:119], v2, s[52:55], s60 offen offset:128 nt
    buffer_load_dwordx4 v[120:123], v2, s[52:55], s60 offen offset:256 nt
    s_add_u32 s60, s60, 24576
    buffer_load_dwordx4 v[124:127], v2, s[52:55], s60 offen offset:0 nt
    buffer_load_dwordx4 v[128:131], v2, s[52:55], s60 offen offset:128 nt
    buffer_load_dwordx4 v[132:135], v2, s[52:55], s60 offen offset:256 nt
    s_add_u32 s60, s60, 24576
    buffer_load_dwordx4 v[136:139], v2, s[52:55], s60 offen offset:0 nt
    buffer_load_dwordx4 v[140:143], v2, s[52:55], s60 offen offset:128 nt
    buffer_load_dwordx4 v[144:147], v2, s[52:55], s60 offen offset:256 nt
    s_add_u32 s60, s60, 24576
    buffer_load_dwordx4 v[148:151], v2, s[52:55], s60 offen offset:0 nt
    buffer_load_dwordx4 v[152:155], v2, s[52:55], s60 offen offset:128 nt
    buffer_load_dwordx4 v[156:159], v2, s[52:55], s60 offen offset:256 nt
    s_add_u32 s60, s60, 24576
    s_waitcnt vmcnt(36)
    v_mov_b32_dpp v12, v28 row_newbcast:4 row_mask:0xf bank_mask:0x3
    v_mov_b32_dpp v12, v28 row_newbcast:12 row_mask:0xf bank_mask:0xc
    v_lshlrev_b32 v13, 16, v12
    v_dot2c_f32_bf16 v37, v160, v12
    v_dot2c_f32_bf16 v38, v160, v13
    v_dot2c_f32_bf16 v39, v161, v12
    v_dot2c_f32_bf16 v40, v161, v13
    v_dot2c_f32_bf16 v41, v162, v12
    v_dot2c_f32_bf16 v42, v162, v13
    v_dot2c_f32_bf16 v43, v163, v12
    v_dot2c_f32_bf16 v44, v163, v13
    v_dot2c_f32_bf16 v45, v164, v12
    v_dot2c_f32_bf16 v46, v164, v13
    v_dot2c_f32_bf16 v47, v165, v12
    v_dot2c_f32_bf16 v48, v165, v13
    v_dot2c_f32_bf16 v49, v166, v12
    v_dot2c_f32_bf16 v50, v166, v13
    v_dot2c_f32_bf16 v51, v167, v12
    v_dot2c_f32_bf16 v52, v167, v13
    v_dot2c_f32_bf16 v53, v168, v12
    v_dot2c_f32_bf16 v54, v168, v13
    v_dot2c_f32_bf16 v55, v169, v12
    v_dot2c_f32_bf16 v56, v169, v13
    v_dot2c_f32_bf16 v57, v170, v12
    v_dot2c_f32_bf16 v58, v170, v13
    v_dot2c_f32_bf16 v59, v171, v12
    v_dot2c_f32_bf16 v60, v171, v13
    v_mov_b32_dpp v61, v28 row_newbcast:5 row_mask:0xf bank_mask:0x3
    v_mov_b32_dpp v61, v28 row_newbcast:13 row_mask:0xf bank_mask:0xc
    v_lshlrev_b32 v62, 16, v61
    v_dot2c_f32_bf16 v37, v172, v61
    v_dot2c_f32_bf16 v38, v172, v62
    v_dot2c_f32_bf16 v39, v173, v61
    v_dot2c_f32_bf16 v40, v173, v62
    v_dot2c_f32_bf16 v41, v174, v61
    v_dot2c_f32_bf16 v42, v174, v62
    v_dot2c_f32_bf16 v43, v175, v61
    v_dot2c_f32_bf16 v44, v175, v62
    v_dot2c_f32_bf16 v45, v176, v61
    v_dot2c_f32_bf16 v46, v176, v62
    v_dot2c_f32_bf16 v47, v177, v61
    v_dot2c_f32_bf16 v48, v177, v62
    v_dot2c_f32_bf16 v49, v178, v61
    v_dot2c_f32_bf16 v50, v178, v62
    v_dot2c_f32_bf16 v51, v179, v61
    v_dot2c_f32_bf16 v52, v179, v62
    v_dot2c_f32_bf16 v53, v180, v61
    v_dot2c_f32_bf16 v54, v180, v62
    v_dot2c_f32_bf16 v55, v181, v61
    v_dot2c_f32_bf16 v56, v181, v62
    v_dot2c_f32_bf16 v57, v182, v61
    v_dot2c_f32_bf16 v58, v182, v62
    v_dot2c_f32_bf16 v59, v183, v61
    v_dot2c_f32_bf16 v60, v183, v62
    v_mov_b32_dpp v12, v28 row_newbcast:6 row_mask:0xf bank_mask:0x3
    v_mov_b32_dpp v12, v28 row_newbcast:14 row_mask:0xf bank_mask:0xc
    v_lshlrev_b32 v13, 16, v12
    v_dot2c_f32_bf16 v37, v184, v12
    v_dot2c_f32_bf16 v38, v184, v13
    v_dot2c_f32_bf16 v39, v185, v12
    v_dot2c_f32_bf16 v40, v185, v13
    v_dot2c_f32_bf16 v41, v186, v12
    v_dot2c_f32_bf16 v42, v186, v13
    v_dot2c_f32_bf16 v43, v187, v12
    v_dot2c_f32_bf16 v44, v187, v13
    v_dot2c_f32_bf16 v45, v188, v12
    v_dot2c_f32_bf16 v46, v188, v13
    v_dot2c_f32_bf16 v47, v189, v12
    v_dot2c_f32_bf16 v48, v189, v13
    v_dot2c_f32_bf16 v49, v190, v12
    v_dot2c_f32_bf16 v50, v190, v13
    v_dot2c_f32_bf16 v51, v191, v12
    v_dot2c_f32_bf16 v52, v191, v13
    v_dot2c_f32_bf16 v53, v192, v12
    v_dot2c_f32_bf16 v54, v192, v13
    v_dot2c_f32_bf16 v55, v193, v12
    v_dot2c_f32_bf16 v56, v193, v13
    v_dot2c_f32_bf16 v57, v194, v12
    v_dot2c_f32_bf16 v58, v194, v13
    v_dot2c_f32_bf16 v59, v195, v12
    v_dot2c_f32_bf16 v60, v195, v13
    v_mov_b32_dpp v61, v28 row_newbcast:7 row_mask:0xf bank_mask:0x3
    v_mov_b32_dpp v61, v28 row_newbcast:15 row_mask:0xf bank_mask:0xc
    v_lshlrev_b32 v62, 16, v61
    v_dot2c_f32_bf16 v37, v196, v61
    v_dot2c_f32_bf16 v38, v196, v62
    v_dot2c_f32_bf16 v39, v197, v61
    v_dot2c_f32_bf16 v40, v197, v62
    v_dot2c_f32_bf16 v41, v198, v61
    v_dot2c_f32_bf16 v42, v198, v62
    v_dot2c_f32_bf16 v43, v199, v61
    v_dot2c_f32_bf16 v44, v199, v62
    v_dot2c_f32_bf16 v45, v200, v61
    v_dot2c_f32_bf16 v46, v200, v62
    v_dot2c_f32_bf16 v47, v201, v61
    v_dot2c_f32_bf16 v48, v201, v62
    v_dot2c_f32_bf16 v49, v202, v61
    v_dot2c_f32_bf16 v50, v202, v62
    v_dot2c_f32_bf16 v51, v203, v61
    v_dot2c_f32_bf16 v52, v203, v62
    v_dot2c_f32_bf16 v53, v204, v61
    v_dot2c_f32_bf16 v54, v204, v62
    v_dot2c_f32_bf16 v55, v205, v61
    v_dot2c_f32_bf16 v56, v205, v62
    v_dot2c_f32_bf16 v57, v206, v61
    v_dot2c_f32_bf16 v58, v206, v62
    v_dot2c_f32_bf16 v59, v207, v61
    v_dot2c_f32_bf16 v60, v207, v62
    buffer_load_dwordx4 v[160:163], v2, s[52:55], s60 offen offset:0 nt
    buffer_load_dwordx4 v[164:167], v2, s[52:55], s60 offen offset:128 nt
    buffer_load_dwordx4 v[168:171], v2, s[52:55], s60 offen offset:256 nt
    s_add_u32 s60, s60, 24576
    buffer_load_dwordx4 v[172:175], v2, s[52:55], s60 offen offset:0 nt
    buffer_load_dwordx4 v[176:179], v2, s[52:55], s60 offen offset:128 nt
    buffer_load_dwordx4 v[180:183], v2, s[52:55], s60 offen offset:256 nt
    s_add_u32 s60, s60, 24576
    buffer_load_dwordx4 v[184:187], v2, s[52:55], s60 offen offset:0 nt
    buffer_load_dwordx4 v[188:191], v2, s[52:55], s60 offen offset:128 nt
    buffer_load_dwordx4 v[192:195], v2, s[52:55], s60 offen offset:256 nt
    s_add_u32 s60, s60, 24576
    buffer_load_dwordx4 v[196:199], v2, s[52:55], s60 offen offset:0 nt
    buffer_load_dwordx4 v[200:203], v2, s[52:55], s60 offen offset:128 nt
    buffer_load_dwordx4 v[204:207], v2, s[52:55], s60 offen offset:256 nt
    s_add_u32 s60, s60, 24576
    s_waitcnt vmcnt(36)
    v_mov_b32_dpp v12, v29 row_newbcast:0 row_mask:0xf bank_mask:0x3
    v_mov_b32_dpp v12, v29 row_newbcast:8 row_mask:0xf bank_mask:0xc
    v_lshlrev_b32 v13, 16, v12
    v_dot2c_f32_bf16 v37, v208, v12
    v_dot2c_f32_bf16 v38, v208, v13
    v_dot2c_f32_bf16 v39, v209, v12
    v_dot2c_f32_bf16 v40, v209, v13
    v_dot2c_f32_bf16 v41, v210, v12
    v_dot2c_f32_bf16 v42, v210, v13
    v_dot2c_f32_bf16 v43, v211, v12
    v_dot2c_f32_bf16 v44, v211, v13
    v_dot2c_f32_bf16 v45, v212, v12
    v_dot2c_f32_bf16 v46, v212, v13
    v_dot2c_f32_bf16 v47, v213, v12
    v_dot2c_f32_bf16 v48, v213, v13
    v_dot2c_f32_bf16 v49, v214, v12
    v_dot2c_f32_bf16 v50, v214, v13
    v_dot2c_f32_bf16 v51, v215, v12
    v_dot2c_f32_bf16 v52, v215, v13
    v_dot2c_f32_bf16 v53, v216, v12
    v_dot2c_f32_bf16 v54, v216, v13
    v_dot2c_f32_bf16 v55, v217, v12
    v_dot2c_f32_bf16 v56, v217, v13
    v_dot2c_f32_bf16 v57, v218, v12
    v_dot2c_f32_bf16 v58, v218, v13
    v_dot2c_f32_bf16 v59, v219, v12
    v_dot2c_f32_bf16 v60, v219, v13
    v_mov_b32_dpp v61, v29 row_newbcast:1 row_mask:0xf bank_mask:0x3
    v_mov_b32_dpp v61, v29 row_newbcast:9 row_mask:0xf bank_mask:0xc
    v_lshlrev_b32 v62, 16, v61
    v_dot2c_f32_bf16 v37, v220, v61
    v_dot2c_f32_bf16 v38, v220, v62
    v_dot2c_f32_bf16 v39, v221, v61
    v_dot2c_f32_bf16 v40, v221, v62
    v_dot2c_f32_bf16 v41, v222, v61
    v_dot2c_f32_bf16 v42, v222, v62
    v_dot2c_f32_bf16 v43, v223, v61
    v_dot2c_f32_bf16 v44, v223, v62
    v_dot2c_f32_bf16 v45, v224, v61
    v_dot2c_f32_bf16 v46, v224, v62
    v_dot2c_f32_bf16 v47, v225, v61
    v_dot2c_f32_bf16 v48, v225, v62
    v_dot2c_f32_bf16 v49, v226, v61
    v_dot2c_f32_bf16 v50, v226, v62
    v_dot2c_f32_bf16 v51, v227, v61
    v_dot2c_f32_bf16 v52, v227, v62
    v_dot2c_f32_bf16 v53, v228, v61
    v_dot2c_f32_bf16 v54, v228, v62
    v_dot2c_f32_bf16 v55, v229, v61
    v_dot2c_f32_bf16 v56, v229, v62
    v_dot2c_f32_bf16 v57, v230, v61
    v_dot2c_f32_bf16 v58, v230, v62
    v_dot2c_f32_bf16 v59, v231, v61
    v_dot2c_f32_bf16 v60, v231, v62
    v_mov_b32_dpp v12, v29 row_newbcast:2 row_mask:0xf bank_mask:0x3
    v_mov_b32_dpp v12, v29 row_newbcast:10 row_mask:0xf bank_mask:0xc
    v_lshlrev_b32 v13, 16, v12
    v_dot2c_f32_bf16 v37, v232, v12
    v_dot2c_f32_bf16 v38, v232, v13
    v_dot2c_f32_bf16 v39, v233, v12
    v_dot2c_f32_bf16 v40, v233, v13
    v_dot2c_f32_bf16 v41, v234, v12
    v_dot2c_f32_bf16 v42, v234, v13
    v_dot2c_f32_bf16 v43, v235, v12
    v_dot2c_f32_bf16 v44, v235, v13
    v_dot2c_f32_bf16 v45, v236, v12
    v_dot2c_f32_bf16 v46, v236, v13
    v_dot2c_f32_bf16 v47, v237, v12
    v_dot2c_f32_bf16 v48, v237, v13
    v_dot2c_f32_bf16 v49, v238, v12
    v_dot2c_f32_bf16 v50, v238, v13
    v_dot2c_f32_bf16 v51, v239, v12
    v_dot2c_f32_bf16 v52, v239, v13
    v_dot2c_f32_bf16 v53, v240, v12
    v_dot2c_f32_bf16 v54, v240, v13
    v_dot2c_f32_bf16 v55, v241, v12
    v_dot2c_f32_bf16 v56, v241, v13
    v_dot2c_f32_bf16 v57, v242, v12
    v_dot2c_f32_bf16 v58, v242, v13
    v_dot2c_f32_bf16 v59, v243, v12
    v_dot2c_f32_bf16 v60, v243, v13
    v_mov_b32_dpp v61, v29 row_newbcast:3 row_mask:0xf bank_mask:0x3
    v_mov_b32_dpp v61, v29 row_newbcast:11 row_mask:0xf bank_mask:0xc
    v_lshlrev_b32 v62, 16, v61
    v_dot2c_f32_bf16 v37, v244, v61
    v_dot2c_f32_bf16 v38, v244, v62
    v_dot2c_f32_bf16 v39, v245, v61
    v_dot2c_f32_bf16 v40, v245, v62
    v_dot2c_f32_bf16 v41, v246, v61
    v_dot2c_f32_bf16 v42, v246, v62
    v_dot2c_f32_bf16 v43, v247, v61
    v_dot2c_f32_bf16 v44, v247, v62
    v_dot2c_f32_bf16 v45, v248, v61
    v_dot2c_f32_bf16 v46, v248, v62
    v_dot2c_f32_bf16 v47, v249, v61
    v_dot2c_f32_bf16 v48, v249, v62
    v_dot2c_f32_bf16 v49, v250, v61
    v_dot2c_f32_bf16 v50, v250, v62
    v_dot2c_f32_bf16 v51, v251, v61
    v_dot2c_f32_bf16 v52, v251, v62
    v_dot2c_f32_bf16 v53, v252, v61
    v_dot2c_f32_bf16 v54, v252, v62
    v_dot2c_f32_bf16 v55, v253, v61
    v_dot2c_f32_bf16 v56, v253, v62
    v_dot2c_f32_bf16 v57, v254, v61
    v_dot2c_f32_bf16 v58, v254, v62
    v_dot2c_f32_bf16 v59, v255, v61
    v_dot2c_f32_bf16 v60, v255, v62
    buffer_load_dwordx4 v[208:211], v2, s[52:55], s60 offen offset:0 nt
    buffer_load_dwordx4 v[212:215], v2, s[52:55], s60 offen offset:128 nt
    buffer_load_dwordx4 v[216:219], v2, s[52:55], s60 offen offset:256 nt
    s_add_u32 s60, s60, 24576
    buffer_load_dwordx4 v[220:223], v2, s[52:55], s60 offen offset:0 nt
    buffer_load_dwordx4 v[224:227], v2, s[52:55], s60 offen offset:128 nt
    buffer_load_dwordx4 v[228:231], v2, s[52:55], s60 offen offset:256 nt
    s_add_u32 s60, s60, 24576
    buffer_load_dwordx4 v[232:235], v2, s[52:55], s60 offen offset:0 nt
    buffer_load_dwordx4 v[236:239], v2, s[52:55], s60 offen offset:128 nt
    buffer_load_dwordx4 v[240:243], v2, s[52:55], s60 offen offset:256 nt
    s_add_u32 s60, s60, 24576
    buffer_load_dwordx4 v[244:247], v2, s[52:55], s60 offen offset:0 nt
    buffer_load_dwordx4 v[248:251], v2, s[52:55], s60 offen offset:128 nt
    buffer_load_dwordx4 v[252:255], v2, s[52:55], s60 offen offset:256 nt
    s_add_u32 s60, s60, 24576
    s_waitcnt vmcnt(36)
    v_mov_b32_dpp v12, v29 row_newbcast:4 row_mask:0xf bank_mask:0x3
    v_mov_b32_dpp v12, v29 row_newbcast:12 row_mask:0xf bank_mask:0xc
    v_lshlrev_b32 v13, 16, v12
    v_dot2c_f32_bf16 v37, v64, v12
    v_dot2c_f32_bf16 v38, v64, v13
    v_dot2c_f32_bf16 v39, v65, v12
    v_dot2c_f32_bf16 v40, v65, v13
    v_dot2c_f32_bf16 v41, v66, v12
    v_dot2c_f32_bf16 v42, v66, v13
    v_dot2c_f32_bf16 v43, v67, v12
    v_dot2c_f32_bf16 v44, v67, v13
    v_dot2c_f32_bf16 v45, v68, v12
    v_dot2c_f32_bf16 v46, v68, v13
    v_dot2c_f32_bf16 v47, v69, v12
    v_dot2c_f32_bf16 v48, v69, v13
    v_dot2c_f32_bf16 v49, v70, v12
    v_dot2c_f32_bf16 v50, v70, v13
    v_dot2c_f32_bf16 v51, v71, v12
    v_dot2c_f32_bf16 v52, v71, v13
    v_dot2c_f32_bf16 v53, v72, v12
    v_dot2c_f32_bf16 v54, v72, v13
    v_dot2c_f32_bf16 v55, v73, v12
    v_dot2c_f32_bf16 v56, v73, v13
    v_dot2c_f32_bf16 v57, v74, v12
    v_dot2c_f32_bf16 v58, v74, v13
    v_dot2c_f32_bf16 v59, v75, v12
    v_dot2c_f32_bf16 v60, v75, v13
    v_mov_b32_dpp v61, v29 row_newbcast:5 row_mask:0xf bank_mask:0x3
    v_mov_b32_dpp v61, v29 row_newbcast:13 row_mask:0xf bank_mask:0xc
    v_lshlrev_b32 v62, 16, v61
    v_dot2c_f32_bf16 v37, v76, v61
    v_dot2c_f32_bf16 v38, v76, v62
    v_dot2c_f32_bf16 v39, v77, v61
    v_dot2c_f32_bf16 v40, v77, v62
    v_dot2c_f32_bf16 v41, v78, v61
    v_dot2c_f32_bf16 v42, v78, v62
    v_dot2c_f32_bf16 v43, v79, v61
    v_dot2c_f32_bf16 v44, v79, v62
    v_dot2c_f32_bf16 v45, v80, v61
    v_dot2c_f32_bf16 v46, v80, v62
    v_dot2c_f32_bf16 v47, v81, v61
    v_dot2c_f32_bf16 v48, v81, v62
    v_dot2c_f32_bf16 v49, v82, v61
    v_dot2c_f32_bf16 v50, v82, v62
    v_dot2c_f32_bf16 v51, v83, v61
    v_dot2c_f32_bf16 v52, v83, v62
    v_dot2c_f32_bf16 v53, v84, v61
    v_dot2c_f32_bf16 v54, v84, v62
    v_dot2c_f32_bf16 v55, v85, v61
    v_dot2c_f32_bf16 v56, v85, v62
    v_dot2c_f32_bf16 v57, v86, v61
    v_dot2c_f32_bf16 v58, v86, v62
    v_dot2c_f32_bf16 v59, v87, v61
    v_dot2c_f32_bf16 v60, v87, v62
    v_mov_b32_dpp v12, v29 row_newbcast:6 row_mask:0xf bank_mask:0x3
    v_mov_b32_dpp v12, v29 row_newbcast:14 row_mask:0xf bank_mask:0xc
    v_lshlrev_b32 v13, 16, v12
    v_dot2c_f32_bf16 v37, v88, v12
    v_dot2c_f32_bf16 v38, v88, v13
    v_dot2c_f32_bf16 v39, v89, v12
    v_dot2c_f32_bf16 v40, v89, v13
    v_dot2c_f32_bf16 v41, v90, v12
    v_dot2c_f32_bf16 v42, v90, v13
    v_dot2c_f32_bf16 v43, v91, v12
    v_dot2c_f32_bf16 v44, v91, v13
    v_dot2c_f32_bf16 v45, v92, v12
    v_dot2c_f32_bf16 v46, v92, v13
    v_dot2c_f32_bf16 v47, v93, v12
    v_dot2c_f32_bf16 v48, v93, v13
    v_dot2c_f32_bf16 v49, v94, v12
    v_dot2c_f32_bf16 v50, v94, v13
    v_dot2c_f32_bf16 v51, v95, v12
    v_dot2c_f32_bf16 v52, v95, v13
    v_dot2c_f32_bf16 v53, v96, v12
    v_dot2c_f32_bf16 v54, v96, v13
    v_dot2c_f32_bf16 v55, v97, v12
    v_dot2c_f32_bf16 v56, v97, v13
    v_dot2c_f32_bf16 v57, v98, v12
    v_dot2c_f32_bf16 v58, v98, v13
    v_dot2c_f32_bf16 v59, v99, v12
    v_dot2c_f32_bf16 v60, v99, v13
    v_mov_b32_dpp v61, v29 row_newbcast:7 row_mask:0xf bank_mask:0x3
    v_mov_b32_dpp v61, v29 row_newbcast:15 row_mask:0xf bank_mask:0xc
    v_lshlrev_b32 v62, 16, v61
    v_dot2c_f32_bf16 v37, v100, v61
    v_dot2c_f32_bf16 v38, v100, v62
    v_dot2c_f32_bf16 v39, v101, v61
    v_dot2c_f32_bf16 v40, v101, v62
    v_dot2c_f32_bf16 v41, v102, v61
    v_dot2c_f32_bf16 v42, v102, v62
    v_dot2c_f32_bf16 v43, v103, v61
    v_dot2c_f32_bf16 v44, v103, v62
    v_dot2c_f32_bf16 v45, v104, v61
    v_dot2c_f32_bf16 v46, v104, v62
    v_dot2c_f32_bf16 v47, v105, v61
    v_dot2c_f32_bf16 v48, v105, v62
    v_dot2c_f32_bf16 v49, v106, v61
    v_dot2c_f32_bf16 v50, v106, v62
    v_dot2c_f32_bf16 v51, v107, v61
    v_dot2c_f32_bf16 v52, v107, v62
    v_dot2c_f32_bf16 v53, v108, v61
    v_dot2c_f32_bf16 v54, v108, v62
    v_dot2c_f32_bf16 v55, v109, v61
    v_dot2c_f32_bf16 v56, v109, v62
    v_dot2c_f32_bf16 v57, v110, v61
    v_dot2c_f32_bf16 v58, v110, v62
    v_dot2c_f32_bf16 v59, v111, v61
    v_dot2c_f32_bf16 v60, v111, v62
    buffer_load_dwordx4 v[64:67], v2, s[52:55], s60 offen offset:0 nt
    buffer_load_dwordx4 v[68:71], v2, s[52:55], s60 offen offset:128 nt
    buffer_load_dwordx4 v[72:75], v2, s[52:55], s60 offen offset:256 nt
    s_add_u32 s60, s60, 24576
    buffer_load_dwordx4 v[76:79], v2, s[52:55], s60 offen offset:0 nt
    buffer_load_dwordx4 v[80:83], v2, s[52:55], s60 offen offset:128 nt
    buffer_load_dwordx4 v[84:87], v2, s[52:55], s60 offen offset:256 nt
    s_add_u32 s60, s60, 24576
    buffer_load_dwordx4 v[88:91], v2, s[52:55], s60 offen offset:0 nt
    buffer_load_dwordx4 v[92:95], v2, s[52:55], s60 offen offset:128 nt
    buffer_load_dwordx4 v[96:99], v2, s[52:55], s60 offen offset:256 nt
    s_add_u32 s60, s60, 24576
    buffer_load_dwordx4 v[100:103], v2, s[52:55], s60 offen offset:0 nt
    buffer_load_dwordx4 v[104:107], v2, s[52:55], s60 offen offset:128 nt
    buffer_load_dwordx4 v[108:111], v2, s[52:55], s60 offen offset:256 nt
    s_add_u32 s60, s60, 24576
    s_waitcnt vmcnt(36)
    v_mov_b32_dpp v12, v30 row_newbcast:0 row_mask:0xf bank_mask:0x3
    v_mov_b32_dpp v12, v30 row_newbcast:8 row_mask:0xf bank_mask:0xc
    v_lshlrev_b32 v13, 16, v12
    v_dot2c_f32_bf16 v37, v112, v12
    v_dot2c_f32_bf16 v38, v112, v13
    v_dot2c_f32_bf16 v39, v113, v12
    v_dot2c_f32_bf16 v40, v113, v13
    v_dot2c_f32_bf16 v41, v114, v12
    v_dot2c_f32_bf16 v42, v114, v13
    v_dot2c_f32_bf16 v43, v115, v12
    v_dot2c_f32_bf16 v44, v115, v13
    v_dot2c_f32_bf16 v45, v116, v12
    v_dot2c_f32_bf16 v46, v116, v13
    v_dot2c_f32_bf16 v47, v117, v12
    v_dot2c_f32_bf16 v48, v117, v13
    v_dot2c_f32_bf16 v49, v118, v12
    v_dot2c_f32_bf16 v50, v118, v13
    v_dot2c_f32_bf16 v51, v119, v12
    v_dot2c_f32_bf16 v52, v119, v13
    v_dot2c_f32_bf16 v53, v120, v12
    v_dot2c_f32_bf16 v54, v120, v13
    v_dot2c_f32_bf16 v55, v121, v12
    v_dot2c_f32_bf16 v56, v121, v13
    v_dot2c_f32_bf16 v57, v122, v12
    v_dot2c_f32_bf16 v58, v122, v13
    v_dot2c_f32_bf16 v59, v123, v12
    v_dot2c_f32_bf16 v60, v123, v13
    v_mov_b32_dpp v61, v30 row_newbcast:1 row_mask:0xf bank_mask:0x3
    v_mov_b32_dpp v61, v30 row_newbcast:9 row_mask:0xf bank_mask:0xc
    v_lshlrev_b32 v62, 16, v61
    v_dot2c_f32_bf16 v37, v124, v61
    v_dot2c_f32_bf16 v38, v124, v62
    v_dot2c_f32_bf16 v39, v125, v61
    v_dot2c_f32_bf16 v40, v125, v62
    v_dot2c_f32_bf16 v41, v126, v61
    v_dot2c_f32_bf16 v42, v126, v62
    v_dot2c_f32_bf16 v43, v127, v61
    v_dot2c_f32_bf16 v44, v127, v62
    v_dot2c_f32_bf16 v45, v128, v61
    v_dot2c_f32_bf16 v46, v128, v62
    v_dot2c_f32_bf16 v47, v129, v61
    v_dot2c_f32_bf16 v48, v129, v62
    v_dot2c_f32_bf16 v49, v130, v61
    v_dot2c_f32_bf16 v50, v130, v62
    v_dot2c_f32_bf16 v51, v131, v61
    v_dot2c_f32_bf16 v52, v131, v62
    v_dot2c_f32_bf16 v53, v132, v61
    v_dot2c_f32_bf16 v54, v132, v62
    v_dot2c_f32_bf16 v55, v133, v61
    v_dot2c_f32_bf16 v56, v133, v62
    v_dot2c_f32_bf16 v57, v134, v61
    v_dot2c_f32_bf16 v58, v134, v62
    v_dot2c_f32_bf16 v59, v135, v61
    v_dot2c_f32_bf16 v60, v135, v62
    v_mov_b32_dpp v12, v30 row_newbcast:2 row_mask:0xf bank_mask:0x3
    v_mov_b32_dpp v12, v30 row_newbcast:10 row_mask:0xf bank_mask:0xc
    v_lshlrev_b32 v13, 16, v12
    v_dot2c_f32_bf16 v37, v136, v12
    v_dot2c_f32_bf16 v38, v136, v13
    v_dot2c_f32_bf16 v39, v137, v12
    v_dot2c_f32_bf16 v40, v137, v13
    v_dot2c_f32_bf16 v41, v138, v12
    v_dot2c_f32_bf16 v42, v138, v13
    v_dot2c_f32_bf16 v43, v139, v12
    v_dot2c_f32_bf16 v44, v139, v13
    v_dot2c_f32_bf16 v45, v140, v12
    v_dot2c_f32_bf16 v46, v140, v13
    v_dot2c_f32_bf16 v47, v141, v12
    v_dot2c_f32_bf16 v48, v141, v13
    v_dot2c_f32_bf16 v49, v142, v12
    v_dot2c_f32_bf16 v50, v142, v13
    v_dot2c_f32_bf16 v51, v143, v12
    v_dot2c_f32_bf16 v52, v143, v13
    v_dot2c_f32_bf16 v53, v144, v12
    v_dot2c_f32_bf16 v54, v144, v13
    v_dot2c_f32_bf16 v55, v145, v12
    v_dot2c_f32_bf16 v56, v145, v13
    v_dot2c_f32_bf16 v57, v146, v12
    v_dot2c_f32_bf16 v58, v146, v13
    v_dot2c_f32_bf16 v59, v147, v12
    v_dot2c_f32_bf16 v60, v147, v13
    v_mov_b32_dpp v61, v30 row_newbcast:3 row_mask:0xf bank_mask:0x3
    v_mov_b32_dpp v61, v30 row_newbcast:11 row_mask:0xf bank_mask:0xc
    v_lshlrev_b32 v62, 16, v61
    v_dot2c_f32_bf16 v37, v148, v61
    v_dot2c_f32_bf16 v38, v148, v62
    v_dot2c_f32_bf16 v39, v149, v61
    v_dot2c_f32_bf16 v40, v149, v62
    v_dot2c_f32_bf16 v41, v150, v61
    v_dot2c_f32_bf16 v42, v150, v62
    v_dot2c_f32_bf16 v43, v151, v61
    v_dot2c_f32_bf16 v44, v151, v62
    v_dot2c_f32_bf16 v45, v152, v61
    v_dot2c_f32_bf16 v46, v152, v62
    v_dot2c_f32_bf16 v47, v153, v61
    v_dot2c_f32_bf16 v48, v153, v62
    v_dot2c_f32_bf16 v49, v154, v61
    v_dot2c_f32_bf16 v50, v154, v62
    v_dot2c_f32_bf16 v51, v155, v61
    v_dot2c_f32_bf16 v52, v155, v62
    v_dot2c_f32_bf16 v53, v156, v61
    v_dot2c_f32_bf16 v54, v156, v62
    v_dot2c_f32_bf16 v55, v157, v61
    v_dot2c_f32_bf16 v56, v157, v62
    v_dot2c_f32_bf16 v57, v158, v61
    v_dot2c_f32_bf16 v58, v158, v62
    v_dot2c_f32_bf16 v59, v159, v61
    v_dot2c_f32_bf16 v60, v159, v62
    buffer_load_dwordx4 v[112:115], v2, s[52:55], s60 offen offset:0 nt
    buffer_load_dwordx4 v[116:119], v2, s[52:55], s60 offen offset:128 nt
    buffer_load_dwordx4 v[120:123], v2, s[52:55], s60 offen offset:256 nt
    s_add_u32 s60, s60, 24576
    buffer_load_dwordx4 v[124:127], v2, s[52:55], s60 offen offset:0 nt
    buffer_load_dwordx4 v[128:131], v2, s[52:55], s60 offen offset:128 nt
    buffer_load_dwordx4 v[132:135], v2, s[52:55], s60 offen offset:256 nt
    s_add_u32 s60, s60, 24576
    buffer_load_dwordx4 v[136:139], v2, s[52:55], s60 offen offset:0 nt
    buffer_load_dwordx4 v[140:143], v2, s[52:55], s60 offen offset:128 nt
    buffer_load_dwordx4 v[144:147], v2, s[52:55], s60 offen offset:256 nt
    s_add_u32 s60, s60, 24576
    buffer_load_dwordx4 v[148:151], v2, s[52:55], s60 offen offset:0 nt
    buffer_load_dwordx4 v[152:155], v2, s[52:55], s60 offen offset:128 nt
    buffer_load_dwordx4 v[156:159], v2, s[52:55], s60 offen offset:256 nt
    s_add_u32 s60, s60, 24576
    s_waitcnt vmcnt(36)
    v_mov_b32_dpp v12, v30 row_newbcast:4 row_mask:0xf bank_mask:0x3
    v_mov_b32_dpp v12, v30 row_newbcast:12 row_mask:0xf bank_mask:0xc
    v_lshlrev_b32 v13, 16, v12
    v_dot2c_f32_bf16 v37, v160, v12
    v_dot2c_f32_bf16 v38, v160, v13
    v_dot2c_f32_bf16 v39, v161, v12
    v_dot2c_f32_bf16 v40, v161, v13
    v_dot2c_f32_bf16 v41, v162, v12
    v_dot2c_f32_bf16 v42, v162, v13
    v_dot2c_f32_bf16 v43, v163, v12
    v_dot2c_f32_bf16 v44, v163, v13
    v_dot2c_f32_bf16 v45, v164, v12
    v_dot2c_f32_bf16 v46, v164, v13
    v_dot2c_f32_bf16 v47, v165, v12
    v_dot2c_f32_bf16 v48, v165, v13
    v_dot2c_f32_bf16 v49, v166, v12
    v_dot2c_f32_bf16 v50, v166, v13
    v_dot2c_f32_bf16 v51, v167, v12
    v_dot2c_f32_bf16 v52, v167, v13
    v_dot2c_f32_bf16 v53, v168, v12
    v_dot2c_f32_bf16 v54, v168, v13
    v_dot2c_f32_bf16 v55, v169, v12
    v_dot2c_f32_bf16 v56, v169, v13
    v_dot2c_f32_bf16 v57, v170, v12
    v_dot2c_f32_bf16 v58, v170, v13
    v_dot2c_f32_bf16 v59, v171, v12
    v_dot2c_f32_bf16 v60, v171, v13
    v_mov_b32_dpp v61, v30 row_newbcast:5 row_mask:0xf bank_mask:0x3
    v_mov_b32_dpp v61, v30 row_newbcast:13 row_mask:0xf bank_mask:0xc
    v_lshlrev_b32 v62, 16, v61
    v_dot2c_f32_bf16 v37, v172, v61
    v_dot2c_f32_bf16 v38, v172, v62
    v_dot2c_f32_bf16 v39, v173, v61
    v_dot2c_f32_bf16 v40, v173, v62
    v_dot2c_f32_bf16 v41, v174, v61
    v_dot2c_f32_bf16 v42, v174, v62
    v_dot2c_f32_bf16 v43, v175, v61
    v_dot2c_f32_bf16 v44, v175, v62
    v_dot2c_f32_bf16 v45, v176, v61
    v_dot2c_f32_bf16 v46, v176, v62
    v_dot2c_f32_bf16 v47, v177, v61
    v_dot2c_f32_bf16 v48, v177, v62
    v_dot2c_f32_bf16 v49, v178, v61
    v_dot2c_f32_bf16 v50, v178, v62
    v_dot2c_f32_bf16 v51, v179, v61
    v_dot2c_f32_bf16 v52, v179, v62
    v_dot2c_f32_bf16 v53, v180, v61
    v_dot2c_f32_bf16 v54, v180, v62
    v_dot2c_f32_bf16 v55, v181, v61
    v_dot2c_f32_bf16 v56, v181, v62
    v_dot2c_f32_bf16 v57, v182, v61
    v_dot2c_f32_bf16 v58, v182, v62
    v_dot2c_f32_bf16 v59, v183, v61
    v_dot2c_f32_bf16 v60, v183, v62
    v_mov_b32_dpp v12, v30 row_newbcast:6 row_mask:0xf bank_mask:0x3
    v_mov_b32_dpp v12, v30 row_newbcast:14 row_mask:0xf bank_mask:0xc
    v_lshlrev_b32 v13, 16, v12
    v_dot2c_f32_bf16 v37, v184, v12
    v_dot2c_f32_bf16 v38, v184, v13
    v_dot2c_f32_bf16 v39, v185, v12
    v_dot2c_f32_bf16 v40, v185, v13
    v_dot2c_f32_bf16 v41, v186, v12
    v_dot2c_f32_bf16 v42, v186, v13
    v_dot2c_f32_bf16 v43, v187, v12
    v_dot2c_f32_bf16 v44, v187, v13
    v_dot2c_f32_bf16 v45, v188, v12
    v_dot2c_f32_bf16 v46, v188, v13
    v_dot2c_f32_bf16 v47, v189, v12
    v_dot2c_f32_bf16 v48, v189, v13
    v_dot2c_f32_bf16 v49, v190, v12
    v_dot2c_f32_bf16 v50, v190, v13
    v_dot2c_f32_bf16 v51, v191, v12
    v_dot2c_f32_bf16 v52, v191, v13
    v_dot2c_f32_bf16 v53, v192, v12
    v_dot2c_f32_bf16 v54, v192, v13
    v_dot2c_f32_bf16 v55, v193, v12
    v_dot2c_f32_bf16 v56, v193, v13
    v_dot2c_f32_bf16 v57, v194, v12
    v_dot2c_f32_bf16 v58, v194, v13
    v_dot2c_f32_bf16 v59, v195, v12
    v_dot2c_f32_bf16 v60, v195, v13
    v_mov_b32_dpp v61, v30 row_newbcast:7 row_mask:0xf bank_mask:0x3
    v_mov_b32_dpp v61, v30 row_newbcast:15 row_mask:0xf bank_mask:0xc
    v_lshlrev_b32 v62, 16, v61
    v_dot2c_f32_bf16 v37, v196, v61
    v_dot2c_f32_bf16 v38, v196, v62
    v_dot2c_f32_bf16 v39, v197, v61
    v_dot2c_f32_bf16 v40, v197, v62
    v_dot2c_f32_bf16 v41, v198, v61
    v_dot2c_f32_bf16 v42, v198, v62
    v_dot2c_f32_bf16 v43, v199, v61
    v_dot2c_f32_bf16 v44, v199, v62
    v_dot2c_f32_bf16 v45, v200, v61
    v_dot2c_f32_bf16 v46, v200, v62
    v_dot2c_f32_bf16 v47, v201, v61
    v_dot2c_f32_bf16 v48, v201, v62
    v_dot2c_f32_bf16 v49, v202, v61
    v_dot2c_f32_bf16 v50, v202, v62
    v_dot2c_f32_bf16 v51, v203, v61
    v_dot2c_f32_bf16 v52, v203, v62
    v_dot2c_f32_bf16 v53, v204, v61
    v_dot2c_f32_bf16 v54, v204, v62
    v_dot2c_f32_bf16 v55, v205, v61
    v_dot2c_f32_bf16 v56, v205, v62
    v_dot2c_f32_bf16 v57, v206, v61
    v_dot2c_f32_bf16 v58, v206, v62
    v_dot2c_f32_bf16 v59, v207, v61
    v_dot2c_f32_bf16 v60, v207, v62
    buffer_load_dwordx4 v[160:163], v2, s[52:55], s60 offen offset:0 nt
    buffer_load_dwordx4 v[164:167], v2, s[52:55], s60 offen offset:128 nt
    buffer_load_dwordx4 v[168:171], v2, s[52:55], s60 offen offset:256 nt
    s_add_u32 s60, s60, 24576
    buffer_load_dwordx4 v[172:175], v2, s[52:55], s60 offen offset:0 nt
    buffer_load_dwordx4 v[176:179], v2, s[52:55], s60 offen offset:128 nt
    buffer_load_dwordx4 v[180:183], v2, s[52:55], s60 offen offset:256 nt
    s_add_u32 s60, s60, 24576
    buffer_load_dwordx4 v[184:187], v2, s[52:55], s60 offen offset:0 nt
    buffer_load_dwordx4 v[188:191], v2, s[52:55], s60 offen offset:128 nt
    buffer_load_dwordx4 v[192:195], v2, s[52:55], s60 offen offset:256 nt
    s_add_u32 s60, s60, 24576
    buffer_load_dwordx4 v[196:199], v2, s[52:55], s60 offen offset:0 nt
    buffer_load_dwordx4 v[200:203], v2, s[52:55], s60 offen offset:128 nt
    buffer_load_dwordx4 v[204:207], v2, s[52:55], s60 offen offset:256 nt
    s_add_u32 s60, s60, 24576
    s_waitcnt vmcnt(36)
    v_mov_b32_dpp v12, v31 row_newbcast:0 row_mask:0xf bank_mask:0x3
    v_mov_b32_dpp v12, v31 row_newbcast:8 row_mask:0xf bank_mask:0xc
    v_lshlrev_b32 v13, 16, v12
    v_dot2c_f32_bf16 v37, v208, v12
    v_dot2c_f32_bf16 v38, v208, v13
    v_dot2c_f32_bf16 v39, v209, v12
    v_dot2c_f32_bf16 v40, v209, v13
    v_dot2c_f32_bf16 v41, v210, v12
    v_dot2c_f32_bf16 v42, v210, v13
    v_dot2c_f32_bf16 v43, v211, v12
    v_dot2c_f32_bf16 v44, v211, v13
    v_dot2c_f32_bf16 v45, v212, v12
    v_dot2c_f32_bf16 v46, v212, v13
    v_dot2c_f32_bf16 v47, v213, v12
    v_dot2c_f32_bf16 v48, v213, v13
    v_dot2c_f32_bf16 v49, v214, v12
    v_dot2c_f32_bf16 v50, v214, v13
    v_dot2c_f32_bf16 v51, v215, v12
    v_dot2c_f32_bf16 v52, v215, v13
    v_dot2c_f32_bf16 v53, v216, v12
    v_dot2c_f32_bf16 v54, v216, v13
    v_dot2c_f32_bf16 v55, v217, v12
    v_dot2c_f32_bf16 v56, v217, v13
    v_dot2c_f32_bf16 v57, v218, v12
    v_dot2c_f32_bf16 v58, v218, v13
    v_dot2c_f32_bf16 v59, v219, v12
    v_dot2c_f32_bf16 v60, v219, v13
    v_mov_b32_dpp v61, v31 row_newbcast:1 row_mask:0xf bank_mask:0x3
    v_mov_b32_dpp v61, v31 row_newbcast:9 row_mask:0xf bank_mask:0xc
    v_lshlrev_b32 v62, 16, v61
    v_dot2c_f32_bf16 v37, v220, v61
    v_dot2c_f32_bf16 v38, v220, v62
    v_dot2c_f32_bf16 v39, v221, v61
    v_dot2c_f32_bf16 v40, v221, v62
    v_dot2c_f32_bf16 v41, v222, v61
    v_dot2c_f32_bf16 v42, v222, v62
    v_dot2c_f32_bf16 v43, v223, v61
    v_dot2c_f32_bf16 v44, v223, v62
    v_dot2c_f32_bf16 v45, v224, v61
    v_dot2c_f32_bf16 v46, v224, v62
    v_dot2c_f32_bf16 v47, v225, v61
    v_dot2c_f32_bf16 v48, v225, v62
    v_dot2c_f32_bf16 v49, v226, v61
    v_dot2c_f32_bf16 v50, v226, v62
    v_dot2c_f32_bf16 v51, v227, v61
    v_dot2c_f32_bf16 v52, v227, v62
    v_dot2c_f32_bf16 v53, v228, v61
    v_dot2c_f32_bf16 v54, v228, v62
    v_dot2c_f32_bf16 v55, v229, v61
    v_dot2c_f32_bf16 v56, v229, v62
    v_dot2c_f32_bf16 v57, v230, v61
    v_dot2c_f32_bf16 v58, v230, v62
    v_dot2c_f32_bf16 v59, v231, v61
    v_dot2c_f32_bf16 v60, v231, v62
    v_mov_b32_dpp v12, v31 row_newbcast:2 row_mask:0xf bank_mask:0x3
    v_mov_b32_dpp v12, v31 row_newbcast:10 row_mask:0xf bank_mask:0xc
    v_lshlrev_b32 v13, 16, v12
    v_dot2c_f32_bf16 v37, v232, v12
    v_dot2c_f32_bf16 v38, v232, v13
    v_dot2c_f32_bf16 v39, v233, v12
    v_dot2c_f32_bf16 v40, v233, v13
    v_dot2c_f32_bf16 v41, v234, v12
    v_dot2c_f32_bf16 v42, v234, v13
    v_dot2c_f32_bf16 v43, v235, v12
    v_dot2c_f32_bf16 v44, v235, v13
    v_dot2c_f32_bf16 v45, v236, v12
    v_dot2c_f32_bf16 v46, v236, v13
    v_dot2c_f32_bf16 v47, v237, v12
    v_dot2c_f32_bf16 v48, v237, v13
    v_dot2c_f32_bf16 v49, v238, v12
    v_dot2c_f32_bf16 v50, v238, v13
    v_dot2c_f32_bf16 v51, v239, v12
    v_dot2c_f32_bf16 v52, v239, v13
    v_dot2c_f32_bf16 v53, v240, v12
    v_dot2c_f32_bf16 v54, v240, v13
    v_dot2c_f32_bf16 v55, v241, v12
    v_dot2c_f32_bf16 v56, v241, v13
    v_dot2c_f32_bf16 v57, v242, v12
    v_dot2c_f32_bf16 v58, v242, v13
    v_dot2c_f32_bf16 v59, v243, v12
    v_dot2c_f32_bf16 v60, v243, v13
    v_mov_b32_dpp v61, v31 row_newbcast:3 row_mask:0xf bank_mask:0x3
    v_mov_b32_dpp v61, v31 row_newbcast:11 row_mask:0xf bank_mask:0xc
    v_lshlrev_b32 v62, 16, v61
    v_dot2c_f32_bf16 v37, v244, v61
    v_dot2c_f32_bf16 v38, v244, v62
    v_dot2c_f32_bf16 v39, v245, v61
    v_dot2c_f32_bf16 v40, v245, v62
    v_dot2c_f32_bf16 v41, v246, v61
    v_dot2c_f32_bf16 v42, v246, v62
    v_dot2c_f32_bf16 v43, v247, v61
    v_dot2c_f32_bf16 v44, v247, v62
    v_dot2c_f32_bf16 v45, v248, v61
    v_dot2c_f32_bf16 v46, v248, v62
    v_dot2c_f32_bf16 v47, v249, v61
    v_dot2c_f32_bf16 v48, v249, v62
    v_dot2c_f32_bf16 v49, v250, v61
    v_dot2c_f32_bf16 v50, v250, v62
    v_dot2c_f32_bf16 v51, v251, v61
    v_dot2c_f32_bf16 v52, v251, v62
    v_dot2c_f32_bf16 v53, v252, v61
    v_dot2c_f32_bf16 v54, v252, v62
    v_dot2c_f32_bf16 v55, v253, v61
    v_dot2c_f32_bf16 v56, v253, v62
    v_dot2c_f32_bf16 v57, v254, v61
    v_dot2c_f32_bf16 v58, v254, v62
    v_dot2c_f32_bf16 v59, v255, v61
    v_dot2c_f32_bf16 v60, v255, v62
    buffer_load_dwordx4 v[208:211], v2, s[52:55], s60 offen offset:0 nt
    buffer_load_dwordx4 v[212:215], v2, s[52:55], s60 offen offset:128 nt
    buffer_load_dwordx4 v[216:219], v2, s[52:55], s60 offen offset:256 nt
    s_add_u32 s60, s60, 24576
    buffer_load_dwordx4 v[220:223], v2, s[52:55], s60 offen offset:0 nt
    buffer_load_dwordx4 v[224:227], v2, s[52:55], s60 offen offset:128 nt
    buffer_load_dwordx4 v[228:231], v2, s[52:55], s60 offen offset:256 nt
    s_add_u32 s60, s60, 24576
    buffer_load_dwordx4 v[232:235], v2, s[52:55], s60 offen offset:0 nt
    buffer_load_dwordx4 v[236:239], v2, s[52:55], s60 offen offset:128 nt
    buffer_load_dwordx4 v[240:243], v2, s[52:55], s60 offen offset:256 nt
    s_add_u32 s60, s60, 24576
    buffer_load_dwordx4 v[244:247], v2, s[52:55], s60 offen offset:0 nt
    buffer_load_dwordx4 v[248:251], v2, s[52:55], s60 offen offset:128 nt
    buffer_load_dwordx4 v[252:255], v2, s[52:55], s60 offen offset:256 nt
    s_add_u32 s60, s60, 24576
    s_waitcnt vmcnt(36)
    v_mov_b32_dpp v12, v31 row_newbcast:4 row_mask:0xf bank_mask:0x3
    v_mov_b32_dpp v12, v31 row_newbcast:12 row_mask:0xf bank_mask:0xc
    v_lshlrev_b32 v13, 16, v12
    v_dot2c_f32_bf16 v37, v64, v12
    v_dot2c_f32_bf16 v38, v64, v13
    v_dot2c_f32_bf16 v39, v65, v12
    v_dot2c_f32_bf16 v40, v65, v13
    v_dot2c_f32_bf16 v41, v66, v12
    v_dot2c_f32_bf16 v42, v66, v13
    v_dot2c_f32_bf16 v43, v67, v12
    v_dot2c_f32_bf16 v44, v67, v13
    v_dot2c_f32_bf16 v45, v68, v12
    v_dot2c_f32_bf16 v46, v68, v13
    v_dot2c_f32_bf16 v47, v69, v12
    v_dot2c_f32_bf16 v48, v69, v13
    v_dot2c_f32_bf16 v49, v70, v12
    v_dot2c_f32_bf16 v50, v70, v13
    v_dot2c_f32_bf16 v51, v71, v12
    v_dot2c_f32_bf16 v52, v71, v13
    v_dot2c_f32_bf16 v53, v72, v12
    v_dot2c_f32_bf16 v54, v72, v13
    v_dot2c_f32_bf16 v55, v73, v12
    v_dot2c_f32_bf16 v56, v73, v13
    v_dot2c_f32_bf16 v57, v74, v12
    v_dot2c_f32_bf16 v58, v74, v13
    v_dot2c_f32_bf16 v59, v75, v12
    v_dot2c_f32_bf16 v60, v75, v13
    v_mov_b32_dpp v61, v31 row_newbcast:5 row_mask:0xf bank_mask:0x3
    v_mov_b32_dpp v61, v31 row_newbcast:13 row_mask:0xf bank_mask:0xc
    v_lshlrev_b32 v62, 16, v61
    v_dot2c_f32_bf16 v37, v76, v61
    v_dot2c_f32_bf16 v38, v76, v62
    v_dot2c_f32_bf16 v39, v77, v61
    v_dot2c_f32_bf16 v40, v77, v62
    v_dot2c_f32_bf16 v41, v78, v61
    v_dot2c_f32_bf16 v42, v78, v62
    v_dot2c_f32_bf16 v43, v79, v61
    v_dot2c_f32_bf16 v44, v79, v62
    v_dot2c_f32_bf16 v45, v80, v61
    v_dot2c_f32_bf16 v46, v80, v62
    v_dot2c_f32_bf16 v47, v81, v61
    v_dot2c_f32_bf16 v48, v81, v62
    v_dot2c_f32_bf16 v49, v82, v61
    v_dot2c_f32_bf16 v50, v82, v62
    v_dot2c_f32_bf16 v51, v83, v61
    v_dot2c_f32_bf16 v52, v83, v62
    v_dot2c_f32_bf16 v53, v84, v61
    v_dot2c_f32_bf16 v54, v84, v62
    v_dot2c_f32_bf16 v55, v85, v61
    v_dot2c_f32_bf16 v56, v85, v62
    v_dot2c_f32_bf16 v57, v86, v61
    v_dot2c_f32_bf16 v58, v86, v62
    v_dot2c_f32_bf16 v59, v87, v61
    v_dot2c_f32_bf16 v60, v87, v62
    v_mov_b32_dpp v12, v31 row_newbcast:6 row_mask:0xf bank_mask:0x3
    v_mov_b32_dpp v12, v31 row_newbcast:14 row_mask:0xf bank_mask:0xc
    v_lshlrev_b32 v13, 16, v12
    v_dot2c_f32_bf16 v37, v88, v12
    v_dot2c_f32_bf16 v38, v88, v13
    v_dot2c_f32_bf16 v39, v89, v12
    v_dot2c_f32_bf16 v40, v89, v13
    v_dot2c_f32_bf16 v41, v90, v12
    v_dot2c_f32_bf16 v42, v90, v13
    v_dot2c_f32_bf16 v43, v91, v12
    v_dot2c_f32_bf16 v44, v91, v13
    v_dot2c_f32_bf16 v45, v92, v12
    v_dot2c_f32_bf16 v46, v92, v13
    v_dot2c_f32_bf16 v47, v93, v12
    v_dot2c_f32_bf16 v48, v93, v13
    v_dot2c_f32_bf16 v49, v94, v12
    v_dot2c_f32_bf16 v50, v94, v13
    v_dot2c_f32_bf16 v51, v95, v12
    v_dot2c_f32_bf16 v52, v95, v13
    v_dot2c_f32_bf16 v53, v96, v12
    v_dot2c_f32_bf16 v54, v96, v13
    v_dot2c_f32_bf16 v55, v97, v12
    v_dot2c_f32_bf16 v56, v97, v13
    v_dot2c_f32_bf16 v57, v98, v12
    v_dot2c_f32_bf16 v58, v98, v13
    v_dot2c_f32_bf16 v59, v99, v12
    v_dot2c_f32_bf16 v60, v99, v13
    v_mov_b32_dpp v61, v31 row_newbcast:7 row_mask:0xf bank_mask:0x3
    v_mov_b32_dpp v61, v31 row_newbcast:15 row_mask:0xf bank_mask:0xc
    v_lshlrev_b32 v62, 16, v61
    v_dot2c_f32_bf16 v37, v100, v61
    v_dot2c_f32_bf16 v38, v100, v62
    v_dot2c_f32_bf16 v39, v101, v61
    v_dot2c_f32_bf16 v40, v101, v62
    v_dot2c_f32_bf16 v41, v102, v61
    v_dot2c_f32_bf16 v42, v102, v62
    v_dot2c_f32_bf16 v43, v103, v61
    v_dot2c_f32_bf16 v44, v103, v62
    v_dot2c_f32_bf16 v45, v104, v61
    v_dot2c_f32_bf16 v46, v104, v62
    v_dot2c_f32_bf16 v47, v105, v61
    v_dot2c_f32_bf16 v48, v105, v62
    v_dot2c_f32_bf16 v49, v106, v61
    v_dot2c_f32_bf16 v50, v106, v62
    v_dot2c_f32_bf16 v51, v107, v61
    v_dot2c_f32_bf16 v52, v107, v62
    v_dot2c_f32_bf16 v53, v108, v61
    v_dot2c_f32_bf16 v54, v108, v62
    v_dot2c_f32_bf16 v55, v109, v61
    v_dot2c_f32_bf16 v56, v109, v62
    v_dot2c_f32_bf16 v57, v110, v61
    v_dot2c_f32_bf16 v58, v110, v62
    v_dot2c_f32_bf16 v59, v111, v61
    v_dot2c_f32_bf16 v60, v111, v62
    buffer_load_dwordx4 v[64:67], v2, s[52:55], s60 offen offset:0 nt
    buffer_load_dwordx4 v[68:71], v2, s[52:55], s60 offen offset:128 nt
    buffer_load_dwordx4 v[72:75], v2, s[52:55], s60 offen offset:256 nt
    s_add_u32 s60, s60, 24576
    buffer_load_dwordx4 v[76:79], v2, s[52:55], s60 offen offset:0 nt
    buffer_load_dwordx4 v[80:83], v2, s[52:55], s60 offen offset:128 nt
    buffer_load_dwordx4 v[84:87], v2, s[52:55], s60 offen offset:256 nt
    s_add_u32 s60, s60, 24576
    buffer_load_dwordx4 v[88:91], v2, s[52:55], s60 offen offset:0 nt
    buffer_load_dwordx4 v[92:95], v2, s[52:55], s60 offen offset:128 nt
    buffer_load_dwordx4 v[96:99], v2, s[52:55], s60 offen offset:256 nt
    s_add_u32 s60, s60, 24576
    buffer_load_dwordx4 v[100:103], v2, s[52:55], s60 offen offset:0 nt
    buffer_load_dwordx4 v[104:107], v2, s[52:55], s60 offen offset:128 nt
    buffer_load_dwordx4 v[108:111], v2, s[52:55], s60 offen offset:256 nt
    s_add_u32 s60, s60, 24576
    s_waitcnt vmcnt(36)
    v_mov_b32_dpp v12, v32 row_newbcast:0 row_mask:0xf bank_mask:0x3
    v_mov_b32_dpp v12, v32 row_newbcast:8 row_mask:0xf bank_mask:0xc
    v_lshlrev_b32 v13, 16, v12
    v_dot2c_f32_bf16 v37, v112, v12
    v_dot2c_f32_bf16 v38, v112, v13
    v_dot2c_f32_bf16 v39, v113, v12
    v_dot2c_f32_bf16 v40, v113, v13
    v_dot2c_f32_bf16 v41, v114, v12
    v_dot2c_f32_bf16 v42, v114, v13
    v_dot2c_f32_bf16 v43, v115, v12
    v_dot2c_f32_bf16 v44, v115, v13
    v_dot2c_f32_bf16 v45, v116, v12
    v_dot2c_f32_bf16 v46, v116, v13
    v_dot2c_f32_bf16 v47, v117, v12
    v_dot2c_f32_bf16 v48, v117, v13
    v_dot2c_f32_bf16 v49, v118, v12
    v_dot2c_f32_bf16 v50, v118, v13
    v_dot2c_f32_bf16 v51, v119, v12
    v_dot2c_f32_bf16 v52, v119, v13
    v_dot2c_f32_bf16 v53, v120, v12
    v_dot2c_f32_bf16 v54, v120, v13
    v_dot2c_f32_bf16 v55, v121, v12
    v_dot2c_f32_bf16 v56, v121, v13
    v_dot2c_f32_bf16 v57, v122, v12
    v_dot2c_f32_bf16 v58, v122, v13
    v_dot2c_f32_bf16 v59, v123, v12
    v_dot2c_f32_bf16 v60, v123, v13
    v_mov_b32_dpp v61, v32 row_newbcast:1 row_mask:0xf bank_mask:0x3
    v_mov_b32_dpp v61, v32 row_newbcast:9 row_mask:0xf bank_mask:0xc
    v_lshlrev_b32 v62, 16, v61
    v_dot2c_f32_bf16 v37, v124, v61
    v_dot2c_f32_bf16 v38, v124, v62
    v_dot2c_f32_bf16 v39, v125, v61
    v_dot2c_f32_bf16 v40, v125, v62
    v_dot2c_f32_bf16 v41, v126, v61
    v_dot2c_f32_bf16 v42, v126, v62
    v_dot2c_f32_bf16 v43, v127, v61
    v_dot2c_f32_bf16 v44, v127, v62
    v_dot2c_f32_bf16 v45, v128, v61
    v_dot2c_f32_bf16 v46, v128, v62
    v_dot2c_f32_bf16 v47, v129, v61
    v_dot2c_f32_bf16 v48, v129, v62
    v_dot2c_f32_bf16 v49, v130, v61
    v_dot2c_f32_bf16 v50, v130, v62
    v_dot2c_f32_bf16 v51, v131, v61
    v_dot2c_f32_bf16 v52, v131, v62
    v_dot2c_f32_bf16 v53, v132, v61
    v_dot2c_f32_bf16 v54, v132, v62
    v_dot2c_f32_bf16 v55, v133, v61
    v_dot2c_f32_bf16 v56, v133, v62
    v_dot2c_f32_bf16 v57, v134, v61
    v_dot2c_f32_bf16 v58, v134, v62
    v_dot2c_f32_bf16 v59, v135, v61
    v_dot2c_f32_bf16 v60, v135, v62
    v_mov_b32_dpp v12, v32 row_newbcast:2 row_mask:0xf bank_mask:0x3
    v_mov_b32_dpp v12, v32 row_newbcast:10 row_mask:0xf bank_mask:0xc
    v_lshlrev_b32 v13, 16, v12
    v_dot2c_f32_bf16 v37, v136, v12
    v_dot2c_f32_bf16 v38, v136, v13
    v_dot2c_f32_bf16 v39, v137, v12
    v_dot2c_f32_bf16 v40, v137, v13
    v_dot2c_f32_bf16 v41, v138, v12
    v_dot2c_f32_bf16 v42, v138, v13
    v_dot2c_f32_bf16 v43, v139, v12
    v_dot2c_f32_bf16 v44, v139, v13
    v_dot2c_f32_bf16 v45, v140, v12
    v_dot2c_f32_bf16 v46, v140, v13
    v_dot2c_f32_bf16 v47, v141, v12
    v_dot2c_f32_bf16 v48, v141, v13
    v_dot2c_f32_bf16 v49, v142, v12
    v_dot2c_f32_bf16 v50, v142, v13
    v_dot2c_f32_bf16 v51, v143, v12
    v_dot2c_f32_bf16 v52, v143, v13
    v_dot2c_f32_bf16 v53, v144, v12
    v_dot2c_f32_bf16 v54, v144, v13
    v_dot2c_f32_bf16 v55, v145, v12
    v_dot2c_f32_bf16 v56, v145, v13
    v_dot2c_f32_bf16 v57, v146, v12
    v_dot2c_f32_bf16 v58, v146, v13
    v_dot2c_f32_bf16 v59, v147, v12
    v_dot2c_f32_bf16 v60, v147, v13
    v_mov_b32_dpp v61, v32 row_newbcast:3 row_mask:0xf bank_mask:0x3
    v_mov_b32_dpp v61, v32 row_newbcast:11 row_mask:0xf bank_mask:0xc
    v_lshlrev_b32 v62, 16, v61
    v_dot2c_f32_bf16 v37, v148, v61
    v_dot2c_f32_bf16 v38, v148, v62
    v_dot2c_f32_bf16 v39, v149, v61
    v_dot2c_f32_bf16 v40, v149, v62
    v_dot2c_f32_bf16 v41, v150, v61
    v_dot2c_f32_bf16 v42, v150, v62
    v_dot2c_f32_bf16 v43, v151, v61
    v_dot2c_f32_bf16 v44, v151, v62
    v_dot2c_f32_bf16 v45, v152, v61
    v_dot2c_f32_bf16 v46, v152, v62
    v_dot2c_f32_bf16 v47, v153, v61
    v_dot2c_f32_bf16 v48, v153, v62
    v_dot2c_f32_bf16 v49, v154, v61
    v_dot2c_f32_bf16 v50, v154, v62
    v_dot2c_f32_bf16 v51, v155, v61
    v_dot2c_f32_bf16 v52, v155, v62
    v_dot2c_f32_bf16 v53, v156, v61
    v_dot2c_f32_bf16 v54, v156, v62
    v_dot2c_f32_bf16 v55, v157, v61
    v_dot2c_f32_bf16 v56, v157, v62
    v_dot2c_f32_bf16 v57, v158, v61
    v_dot2c_f32_bf16 v58, v158, v62
    v_dot2c_f32_bf16 v59, v159, v61
    v_dot2c_f32_bf16 v60, v159, v62
    buffer_load_dwordx4 v[112:115], v2, s[52:55], s60 offen offset:0 nt
    buffer_load_dwordx4 v[116:119], v2, s[52:55], s60 offen offset:128 nt
    buffer_load_dwordx4 v[120:123], v2, s[52:55], s60 offen offset:256 nt
    s_add_u32 s60, s60, 24576
    buffer_load_dwordx4 v[124:127], v2, s[52:55], s60 offen offset:0 nt
    buffer_load_dwordx4 v[128:131], v2, s[52:55], s60 offen offset:128 nt
    buffer_load_dwordx4 v[132:135], v2, s[52:55], s60 offen offset:256 nt
    s_add_u32 s60, s60, 24576
    buffer_load_dwordx4 v[136:139], v2, s[52:55], s60 offen offset:0 nt
    buffer_load_dwordx4 v[140:143], v2, s[52:55], s60 offen offset:128 nt
    buffer_load_dwordx4 v[144:147], v2, s[52:55], s60 offen offset:256 nt
    s_add_u32 s60, s60, 24576
    buffer_load_dwordx4 v[148:151], v2, s[52:55], s60 offen offset:0 nt
    buffer_load_dwordx4 v[152:155], v2, s[52:55], s60 offen offset:128 nt
    buffer_load_dwordx4 v[156:159], v2, s[52:55], s60 offen offset:256 nt
    s_add_u32 s60, s60, 24576
    s_waitcnt vmcnt(36)
    v_mov_b32_dpp v12, v32 row_newbcast:4 row_mask:0xf bank_mask:0x3
    v_mov_b32_dpp v12, v32 row_newbcast:12 row_mask:0xf bank_mask:0xc
    v_lshlrev_b32 v13, 16, v12
    v_dot2c_f32_bf16 v37, v160, v12
    v_dot2c_f32_bf16 v38, v160, v13
    v_dot2c_f32_bf16 v39, v161, v12
    v_dot2c_f32_bf16 v40, v161, v13
    v_dot2c_f32_bf16 v41, v162, v12
    v_dot2c_f32_bf16 v42, v162, v13
    v_dot2c_f32_bf16 v43, v163, v12
    v_dot2c_f32_bf16 v44, v163, v13
    v_dot2c_f32_bf16 v45, v164, v12
    v_dot2c_f32_bf16 v46, v164, v13
    v_dot2c_f32_bf16 v47, v165, v12
    v_dot2c_f32_bf16 v48, v165, v13
    v_dot2c_f32_bf16 v49, v166, v12
    v_dot2c_f32_bf16 v50, v166, v13
    v_dot2c_f32_bf16 v51, v167, v12
    v_dot2c_f32_bf16 v52, v167, v13
    v_dot2c_f32_bf16 v53, v168, v12
    v_dot2c_f32_bf16 v54, v168, v13
    v_dot2c_f32_bf16 v55, v169, v12
    v_dot2c_f32_bf16 v56, v169, v13
    v_dot2c_f32_bf16 v57, v170, v12
    v_dot2c_f32_bf16 v58, v170, v13
    v_dot2c_f32_bf16 v59, v171, v12
    v_dot2c_f32_bf16 v60, v171, v13
    v_mov_b32_dpp v61, v32 row_newbcast:5 row_mask:0xf bank_mask:0x3
    v_mov_b32_dpp v61, v32 row_newbcast:13 row_mask:0xf bank_mask:0xc
    v_lshlrev_b32 v62, 16, v61
    v_dot2c_f32_bf16 v37, v172, v61
    v_dot2c_f32_bf16 v38, v172, v62
    v_dot2c_f32_bf16 v39, v173, v61
    v_dot2c_f32_bf16 v40, v173, v62
    v_dot2c_f32_bf16 v41, v174, v61
    v_dot2c_f32_bf16 v42, v174, v62
    v_dot2c_f32_bf16 v43, v175, v61
    v_dot2c_f32_bf16 v44, v175, v62
    v_dot2c_f32_bf16 v45, v176, v61
    v_dot2c_f32_bf16 v46, v176, v62
    v_dot2c_f32_bf16 v47, v177, v61
    v_dot2c_f32_bf16 v48, v177, v62
    v_dot2c_f32_bf16 v49, v178, v61
    v_dot2c_f32_bf16 v50, v178, v62
    v_dot2c_f32_bf16 v51, v179, v61
    v_dot2c_f32_bf16 v52, v179, v62
    v_dot2c_f32_bf16 v53, v180, v61
    v_dot2c_f32_bf16 v54, v180, v62
    v_dot2c_f32_bf16 v55, v181, v61
    v_dot2c_f32_bf16 v56, v181, v62
    v_dot2c_f32_bf16 v57, v182, v61
    v_dot2c_f32_bf16 v58, v182, v62
    v_dot2c_f32_bf16 v59, v183, v61
    v_dot2c_f32_bf16 v60, v183, v62
    v_mov_b32_dpp v12, v32 row_newbcast:6 row_mask:0xf bank_mask:0x3
    v_mov_b32_dpp v12, v32 row_newbcast:14 row_mask:0xf bank_mask:0xc
    v_lshlrev_b32 v13, 16, v12
    v_dot2c_f32_bf16 v37, v184, v12
    v_dot2c_f32_bf16 v38, v184, v13
    v_dot2c_f32_bf16 v39, v185, v12
    v_dot2c_f32_bf16 v40, v185, v13
    v_dot2c_f32_bf16 v41, v186, v12
    v_dot2c_f32_bf16 v42, v186, v13
    v_dot2c_f32_bf16 v43, v187, v12
    v_dot2c_f32_bf16 v44, v187, v13
    v_dot2c_f32_bf16 v45, v188, v12
    v_dot2c_f32_bf16 v46, v188, v13
    v_dot2c_f32_bf16 v47, v189, v12
    v_dot2c_f32_bf16 v48, v189, v13
    v_dot2c_f32_bf16 v49, v190, v12
    v_dot2c_f32_bf16 v50, v190, v13
    v_dot2c_f32_bf16 v51, v191, v12
    v_dot2c_f32_bf16 v52, v191, v13
    v_dot2c_f32_bf16 v53, v192, v12
    v_dot2c_f32_bf16 v54, v192, v13
    v_dot2c_f32_bf16 v55, v193, v12
    v_dot2c_f32_bf16 v56, v193, v13
    v_dot2c_f32_bf16 v57, v194, v12
    v_dot2c_f32_bf16 v58, v194, v13
    v_dot2c_f32_bf16 v59, v195, v12
    v_dot2c_f32_bf16 v60, v195, v13
    v_mov_b32_dpp v61, v32 row_newbcast:7 row_mask:0xf bank_mask:0x3
    v_mov_b32_dpp v61, v32 row_newbcast:15 row_mask:0xf bank_mask:0xc
    v_lshlrev_b32 v62, 16, v61
    v_dot2c_f32_bf16 v37, v196, v61
    v_dot2c_f32_bf16 v38, v196, v62
    v_dot2c_f32_bf16 v39, v197, v61
    v_dot2c_f32_bf16 v40, v197, v62
    v_dot2c_f32_bf16 v41, v198, v61
    v_dot2c_f32_bf16 v42, v198, v62
    v_dot2c_f32_bf16 v43, v199, v61
    v_dot2c_f32_bf16 v44, v199, v62
    v_dot2c_f32_bf16 v45, v200, v61
    v_dot2c_f32_bf16 v46, v200, v62
    v_dot2c_f32_bf16 v47, v201, v61
    v_dot2c_f32_bf16 v48, v201, v62
    v_dot2c_f32_bf16 v49, v202, v61
    v_dot2c_f32_bf16 v50, v202, v62
    v_dot2c_f32_bf16 v51, v203, v61
    v_dot2c_f32_bf16 v52, v203, v62
    v_dot2c_f32_bf16 v53, v204, v61
    v_dot2c_f32_bf16 v54, v204, v62
    v_dot2c_f32_bf16 v55, v205, v61
    v_dot2c_f32_bf16 v56, v205, v62
    v_dot2c_f32_bf16 v57, v206, v61
    v_dot2c_f32_bf16 v58, v206, v62
    v_dot2c_f32_bf16 v59, v207, v61
    v_dot2c_f32_bf16 v60, v207, v62
    buffer_load_dwordx4 v[160:163], v2, s[52:55], s60 offen offset:0 nt
    buffer_load_dwordx4 v[164:167], v2, s[52:55], s60 offen offset:128 nt
    buffer_load_dwordx4 v[168:171], v2, s[52:55], s60 offen offset:256 nt
    s_add_u32 s60, s60, 24576
    buffer_load_dwordx4 v[172:175], v2, s[52:55], s60 offen offset:0 nt
    buffer_load_dwordx4 v[176:179], v2, s[52:55], s60 offen offset:128 nt
    buffer_load_dwordx4 v[180:183], v2, s[52:55], s60 offen offset:256 nt
    s_add_u32 s60, s60, 24576
    buffer_load_dwordx4 v[184:187], v2, s[52:55], s60 offen offset:0 nt
    buffer_load_dwordx4 v[188:191], v2, s[52:55], s60 offen offset:128 nt
    buffer_load_dwordx4 v[192:195], v2, s[52:55], s60 offen offset:256 nt
    s_add_u32 s60, s60, 24576
    buffer_load_dwordx4 v[196:199], v2, s[52:55], s60 offen offset:0 nt
    buffer_load_dwordx4 v[200:203], v2, s[52:55], s60 offen offset:128 nt
    buffer_load_dwordx4 v[204:207], v2, s[52:55], s60 offen offset:256 nt
    s_add_u32 s60, s60, 24576
    s_waitcnt vmcnt(36)
    v_mov_b32_dpp v12, v33 row_newbcast:0 row_mask:0xf bank_mask:0x3
    v_mov_b32_dpp v12, v33 row_newbcast:8 row_mask:0xf bank_mask:0xc
    v_lshlrev_b32 v13, 16, v12
    v_dot2c_f32_bf16 v37, v208, v12
    v_dot2c_f32_bf16 v38, v208, v13
    v_dot2c_f32_bf16 v39, v209, v12
    v_dot2c_f32_bf16 v40, v209, v13
    v_dot2c_f32_bf16 v41, v210, v12
    v_dot2c_f32_bf16 v42, v210, v13
    v_dot2c_f32_bf16 v43, v211, v12
    v_dot2c_f32_bf16 v44, v211, v13
    v_dot2c_f32_bf16 v45, v212, v12
    v_dot2c_f32_bf16 v46, v212, v13
    v_dot2c_f32_bf16 v47, v213, v12
    v_dot2c_f32_bf16 v48, v213, v13
    v_dot2c_f32_bf16 v49, v214, v12
    v_dot2c_f32_bf16 v50, v214, v13
    v_dot2c_f32_bf16 v51, v215, v12
    v_dot2c_f32_bf16 v52, v215, v13
    v_dot2c_f32_bf16 v53, v216, v12
    v_dot2c_f32_bf16 v54, v216, v13
    v_dot2c_f32_bf16 v55, v217, v12
    v_dot2c_f32_bf16 v56, v217, v13
    v_dot2c_f32_bf16 v57, v218, v12
    v_dot2c_f32_bf16 v58, v218, v13
    v_dot2c_f32_bf16 v59, v219, v12
    v_dot2c_f32_bf16 v60, v219, v13
    v_mov_b32_dpp v61, v33 row_newbcast:1 row_mask:0xf bank_mask:0x3
    v_mov_b32_dpp v61, v33 row_newbcast:9 row_mask:0xf bank_mask:0xc
    v_lshlrev_b32 v62, 16, v61
    v_dot2c_f32_bf16 v37, v220, v61
    v_dot2c_f32_bf16 v38, v220, v62
    v_dot2c_f32_bf16 v39, v221, v61
    v_dot2c_f32_bf16 v40, v221, v62
    v_dot2c_f32_bf16 v41, v222, v61
    v_dot2c_f32_bf16 v42, v222, v62
    v_dot2c_f32_bf16 v43, v223, v61
    v_dot2c_f32_bf16 v44, v223, v62
    v_dot2c_f32_bf16 v45, v224, v61
    v_dot2c_f32_bf16 v46, v224, v62
    v_dot2c_f32_bf16 v47, v225, v61
    v_dot2c_f32_bf16 v48, v225, v62
    v_dot2c_f32_bf16 v49, v226, v61
    v_dot2c_f32_bf16 v50, v226, v62
    v_dot2c_f32_bf16 v51, v227, v61
    v_dot2c_f32_bf16 v52, v227, v62
    v_dot2c_f32_bf16 v53, v228, v61
    v_dot2c_f32_bf16 v54, v228, v62
    v_dot2c_f32_bf16 v55, v229, v61
    v_dot2c_f32_bf16 v56, v229, v62
    v_dot2c_f32_bf16 v57, v230, v61
    v_dot2c_f32_bf16 v58, v230, v62
    v_dot2c_f32_bf16 v59, v231, v61
    v_dot2c_f32_bf16 v60, v231, v62
    v_mov_b32_dpp v12, v33 row_newbcast:2 row_mask:0xf bank_mask:0x3
    v_mov_b32_dpp v12, v33 row_newbcast:10 row_mask:0xf bank_mask:0xc
    v_lshlrev_b32 v13, 16, v12
    v_dot2c_f32_bf16 v37, v232, v12
    v_dot2c_f32_bf16 v38, v232, v13
    v_dot2c_f32_bf16 v39, v233, v12
    v_dot2c_f32_bf16 v40, v233, v13
    v_dot2c_f32_bf16 v41, v234, v12
    v_dot2c_f32_bf16 v42, v234, v13
    v_dot2c_f32_bf16 v43, v235, v12
    v_dot2c_f32_bf16 v44, v235, v13
    v_dot2c_f32_bf16 v45, v236, v12
    v_dot2c_f32_bf16 v46, v236, v13
    v_dot2c_f32_bf16 v47, v237, v12
    v_dot2c_f32_bf16 v48, v237, v13
    v_dot2c_f32_bf16 v49, v238, v12
    v_dot2c_f32_bf16 v50, v238, v13
    v_dot2c_f32_bf16 v51, v239, v12
    v_dot2c_f32_bf16 v52, v239, v13
    v_dot2c_f32_bf16 v53, v240, v12
    v_dot2c_f32_bf16 v54, v240, v13
    v_dot2c_f32_bf16 v55, v241, v12
    v_dot2c_f32_bf16 v56, v241, v13
    v_dot2c_f32_bf16 v57, v242, v12
    v_dot2c_f32_bf16 v58, v242, v13
    v_dot2c_f32_bf16 v59, v243, v12
    v_dot2c_f32_bf16 v60, v243, v13
    v_mov_b32_dpp v61, v33 row_newbcast:3 row_mask:0xf bank_mask:0x3
    v_mov_b32_dpp v61, v33 row_newbcast:11 row_mask:0xf bank_mask:0xc
    v_lshlrev_b32 v62, 16, v61
    v_dot2c_f32_bf16 v37, v244, v61
    v_dot2c_f32_bf16 v38, v244, v62
    v_dot2c_f32_bf16 v39, v245, v61
    v_dot2c_f32_bf16 v40, v245, v62
    v_dot2c_f32_bf16 v41, v246, v61
    v_dot2c_f32_bf16 v42, v246, v62
    v_dot2c_f32_bf16 v43, v247, v61
    v_dot2c_f32_bf16 v44, v247, v62
    v_dot2c_f32_bf16 v45, v248, v61
    v_dot2c_f32_bf16 v46, v248, v62
    v_dot2c_f32_bf16 v47, v249, v61
    v_dot2c_f32_bf16 v48, v249, v62
    v_dot2c_f32_bf16 v49, v250, v61
    v_dot2c_f32_bf16 v50, v250, v62
    v_dot2c_f32_bf16 v51, v251, v61
    v_dot2c_f32_bf16 v52, v251, v62
    v_dot2c_f32_bf16 v53, v252, v61
    v_dot2c_f32_bf16 v54, v252, v62
    v_dot2c_f32_bf16 v55, v253, v61
    v_dot2c_f32_bf16 v56, v253, v62
    v_dot2c_f32_bf16 v57, v254, v61
    v_dot2c_f32_bf16 v58, v254, v62
    v_dot2c_f32_bf16 v59, v255, v61
    v_dot2c_f32_bf16 v60, v255, v62
    buffer_load_dwordx4 v[208:211], v2, s[52:55], s60 offen offset:0 nt
    buffer_load_dwordx4 v[212:215], v2, s[52:55], s60 offen offset:128 nt
    buffer_load_dwordx4 v[216:219], v2, s[52:55], s60 offen offset:256 nt
    s_add_u32 s60, s60, 24576
    buffer_load_dwordx4 v[220:223], v2, s[52:55], s60 offen offset:0 nt
    buffer_load_dwordx4 v[224:227], v2, s[52:55], s60 offen offset:128 nt
    buffer_load_dwordx4 v[228:231], v2, s[52:55], s60 offen offset:256 nt
    s_add_u32 s60, s60, 24576
    buffer_load_dwordx4 v[232:235], v2, s[52:55], s60 offen offset:0 nt
    buffer_load_dwordx4 v[236:239], v2, s[52:55], s60 offen offset:128 nt
    buffer_load_dwordx4 v[240:243], v2, s[52:55], s60 offen offset:256 nt
    s_add_u32 s60, s60, 24576
    buffer_load_dwordx4 v[244:247], v2, s[52:55], s60 offen offset:0 nt
    buffer_load_dwordx4 v[248:251], v2, s[52:55], s60 offen offset:128 nt
    buffer_load_dwordx4 v[252:255], v2, s[52:55], s60 offen offset:256 nt
    s_add_u32 s60, s60, 24576
    s_waitcnt vmcnt(36)
    v_mov_b32_dpp v12, v33 row_newbcast:4 row_mask:0xf bank_mask:0x3
    v_mov_b32_dpp v12, v33 row_newbcast:12 row_mask:0xf bank_mask:0xc
    v_lshlrev_b32 v13, 16, v12
    v_dot2c_f32_bf16 v37, v64, v12
    v_dot2c_f32_bf16 v38, v64, v13
    v_dot2c_f32_bf16 v39, v65, v12
    v_dot2c_f32_bf16 v40, v65, v13
    v_dot2c_f32_bf16 v41, v66, v12
    v_dot2c_f32_bf16 v42, v66, v13
    v_dot2c_f32_bf16 v43, v67, v12
    v_dot2c_f32_bf16 v44, v67, v13
    v_dot2c_f32_bf16 v45, v68, v12
    v_dot2c_f32_bf16 v46, v68, v13
    v_dot2c_f32_bf16 v47, v69, v12
    v_dot2c_f32_bf16 v48, v69, v13
    v_dot2c_f32_bf16 v49, v70, v12
    v_dot2c_f32_bf16 v50, v70, v13
    v_dot2c_f32_bf16 v51, v71, v12
    v_dot2c_f32_bf16 v52, v71, v13
    v_dot2c_f32_bf16 v53, v72, v12
    v_dot2c_f32_bf16 v54, v72, v13
    v_dot2c_f32_bf16 v55, v73, v12
    v_dot2c_f32_bf16 v56, v73, v13
    v_dot2c_f32_bf16 v57, v74, v12
    v_dot2c_f32_bf16 v58, v74, v13
    v_dot2c_f32_bf16 v59, v75, v12
    v_dot2c_f32_bf16 v60, v75, v13
    v_mov_b32_dpp v61, v33 row_newbcast:5 row_mask:0xf bank_mask:0x3
    v_mov_b32_dpp v61, v33 row_newbcast:13 row_mask:0xf bank_mask:0xc
    v_lshlrev_b32 v62, 16, v61
    v_dot2c_f32_bf16 v37, v76, v61
    v_dot2c_f32_bf16 v38, v76, v62
    v_dot2c_f32_bf16 v39, v77, v61
    v_dot2c_f32_bf16 v40, v77, v62
    v_dot2c_f32_bf16 v41, v78, v61
    v_dot2c_f32_bf16 v42, v78, v62
    v_dot2c_f32_bf16 v43, v79, v61
    v_dot2c_f32_bf16 v44, v79, v62
    v_dot2c_f32_bf16 v45, v80, v61
    v_dot2c_f32_bf16 v46, v80, v62
    v_dot2c_f32_bf16 v47, v81, v61
    v_dot2c_f32_bf16 v48, v81, v62
    v_dot2c_f32_bf16 v49, v82, v61
    v_dot2c_f32_bf16 v50, v82, v62
    v_dot2c_f32_bf16 v51, v83, v61
    v_dot2c_f32_bf16 v52, v83, v62
    v_dot2c_f32_bf16 v53, v84, v61
    v_dot2c_f32_bf16 v54, v84, v62
    v_dot2c_f32_bf16 v55, v85, v61
    v_dot2c_f32_bf16 v56, v85, v62
    v_dot2c_f32_bf16 v57, v86, v61
    v_dot2c_f32_bf16 v58, v86, v62
    v_dot2c_f32_bf16 v59, v87, v61
    v_dot2c_f32_bf16 v60, v87, v62
    v_mov_b32_dpp v12, v33 row_newbcast:6 row_mask:0xf bank_mask:0x3
    v_mov_b32_dpp v12, v33 row_newbcast:14 row_mask:0xf bank_mask:0xc
    v_lshlrev_b32 v13, 16, v12
    v_dot2c_f32_bf16 v37, v88, v12
    v_dot2c_f32_bf16 v38, v88, v13
    v_dot2c_f32_bf16 v39, v89, v12
    v_dot2c_f32_bf16 v40, v89, v13
    v_dot2c_f32_bf16 v41, v90, v12
    v_dot2c_f32_bf16 v42, v90, v13
    v_dot2c_f32_bf16 v43, v91, v12
    v_dot2c_f32_bf16 v44, v91, v13
    v_dot2c_f32_bf16 v45, v92, v12
    v_dot2c_f32_bf16 v46, v92, v13
    v_dot2c_f32_bf16 v47, v93, v12
    v_dot2c_f32_bf16 v48, v93, v13
    v_dot2c_f32_bf16 v49, v94, v12
    v_dot2c_f32_bf16 v50, v94, v13
    v_dot2c_f32_bf16 v51, v95, v12
    v_dot2c_f32_bf16 v52, v95, v13
    v_dot2c_f32_bf16 v53, v96, v12
    v_dot2c_f32_bf16 v54, v96, v13
    v_dot2c_f32_bf16 v55, v97, v12
    v_dot2c_f32_bf16 v56, v97, v13
    v_dot2c_f32_bf16 v57, v98, v12
    v_dot2c_f32_bf16 v58, v98, v13
    v_dot2c_f32_bf16 v59, v99, v12
    v_dot2c_f32_bf16 v60, v99, v13
    v_mov_b32_dpp v61, v33 row_newbcast:7 row_mask:0xf bank_mask:0x3
    v_mov_b32_dpp v61, v33 row_newbcast:15 row_mask:0xf bank_mask:0xc
    v_lshlrev_b32 v62, 16, v61
    v_dot2c_f32_bf16 v37, v100, v61
    v_dot2c_f32_bf16 v38, v100, v62
    v_dot2c_f32_bf16 v39, v101, v61
    v_dot2c_f32_bf16 v40, v101, v62
    v_dot2c_f32_bf16 v41, v102, v61
    v_dot2c_f32_bf16 v42, v102, v62
    v_dot2c_f32_bf16 v43, v103, v61
    v_dot2c_f32_bf16 v44, v103, v62
    v_dot2c_f32_bf16 v45, v104, v61
    v_dot2c_f32_bf16 v46, v104, v62
    v_dot2c_f32_bf16 v47, v105, v61
    v_dot2c_f32_bf16 v48, v105, v62
    v_dot2c_f32_bf16 v49, v106, v61
    v_dot2c_f32_bf16 v50, v106, v62
    v_dot2c_f32_bf16 v51, v107, v61
    v_dot2c_f32_bf16 v52, v107, v62
    v_dot2c_f32_bf16 v53, v108, v61
    v_dot2c_f32_bf16 v54, v108, v62
    v_dot2c_f32_bf16 v55, v109, v61
    v_dot2c_f32_bf16 v56, v109, v62
    v_dot2c_f32_bf16 v57, v110, v61
    v_dot2c_f32_bf16 v58, v110, v62
    v_dot2c_f32_bf16 v59, v111, v61
    v_dot2c_f32_bf16 v60, v111, v62
    buffer_load_dwordx4 v[64:67], v2, s[52:55], s60 offen offset:0 nt
    buffer_load_dwordx4 v[68:71], v2, s[52:55], s60 offen offset:128 nt
    buffer_load_dwordx4 v[72:75], v2, s[52:55], s60 offen offset:256 nt
    s_add_u32 s60, s60, 24576
    buffer_load_dwordx4 v[76:79], v2, s[52:55], s60 offen offset:0 nt
    buffer_load_dwordx4 v[80:83], v2, s[52:55], s60 offen offset:128 nt
    buffer_load_dwordx4 v[84:87], v2, s[52:55], s60 offen offset:256 nt
    s_add_u32 s60, s60, 24576
    buffer_load_dwordx4 v[88:91], v2, s[52:55], s60 offen offset:0 nt
    buffer_load_dwordx4 v[92:95], v2, s[52:55], s60 offen offset:128 nt
    buffer_load_dwordx4 v[96:99], v2, s[52:55], s60 offen offset:256 nt
    s_add_u32 s60, s60, 24576
    buffer_load_dwordx4 v[100:103], v2, s[52:55], s60 offen offset:0 nt
    buffer_load_dwordx4 v[104:107], v2, s[52:55], s60 offen offset:128 nt
    buffer_load_dwordx4 v[108:111], v2, s[52:55], s60 offen offset:256 nt
    s_add_u32 s60, s60, 24576
    s_waitcnt vmcnt(36)
    v_mov_b32_dpp v12, v34 row_newbcast:0 row_mask:0xf bank_mask:0x3
    v_mov_b32_dpp v12, v34 row_newbcast:8 row_mask:0xf bank_mask:0xc
    v_lshlrev_b32 v13, 16, v12
    v_dot2c_f32_bf16 v37, v112, v12
    v_dot2c_f32_bf16 v38, v112, v13
    v_dot2c_f32_bf16 v39, v113, v12
    v_dot2c_f32_bf16 v40, v113, v13
    v_dot2c_f32_bf16 v41, v114, v12
    v_dot2c_f32_bf16 v42, v114, v13
    v_dot2c_f32_bf16 v43, v115, v12
    v_dot2c_f32_bf16 v44, v115, v13
    v_dot2c_f32_bf16 v45, v116, v12
    v_dot2c_f32_bf16 v46, v116, v13
    v_dot2c_f32_bf16 v47, v117, v12
    v_dot2c_f32_bf16 v48, v117, v13
    v_dot2c_f32_bf16 v49, v118, v12
    v_dot2c_f32_bf16 v50, v118, v13
    v_dot2c_f32_bf16 v51, v119, v12
    v_dot2c_f32_bf16 v52, v119, v13
    v_dot2c_f32_bf16 v53, v120, v12
    v_dot2c_f32_bf16 v54, v120, v13
    v_dot2c_f32_bf16 v55, v121, v12
    v_dot2c_f32_bf16 v56, v121, v13
    v_dot2c_f32_bf16 v57, v122, v12
    v_dot2c_f32_bf16 v58, v122, v13
    v_dot2c_f32_bf16 v59, v123, v12
    v_dot2c_f32_bf16 v60, v123, v13
    v_mov_b32_dpp v61, v34 row_newbcast:1 row_mask:0xf bank_mask:0x3
    v_mov_b32_dpp v61, v34 row_newbcast:9 row_mask:0xf bank_mask:0xc
    v_lshlrev_b32 v62, 16, v61
    v_dot2c_f32_bf16 v37, v124, v61
    v_dot2c_f32_bf16 v38, v124, v62
    v_dot2c_f32_bf16 v39, v125, v61
    v_dot2c_f32_bf16 v40, v125, v62
    v_dot2c_f32_bf16 v41, v126, v61
    v_dot2c_f32_bf16 v42, v126, v62
    v_dot2c_f32_bf16 v43, v127, v61
    v_dot2c_f32_bf16 v44, v127, v62
    v_dot2c_f32_bf16 v45, v128, v61
    v_dot2c_f32_bf16 v46, v128, v62
    v_dot2c_f32_bf16 v47, v129, v61
    v_dot2c_f32_bf16 v48, v129, v62
    v_dot2c_f32_bf16 v49, v130, v61
    v_dot2c_f32_bf16 v50, v130, v62
    v_dot2c_f32_bf16 v51, v131, v61
    v_dot2c_f32_bf16 v52, v131, v62
    v_dot2c_f32_bf16 v53, v132, v61
    v_dot2c_f32_bf16 v54, v132, v62
    v_dot2c_f32_bf16 v55, v133, v61
    v_dot2c_f32_bf16 v56, v133, v62
    v_dot2c_f32_bf16 v57, v134, v61
    v_dot2c_f32_bf16 v58, v134, v62
    v_dot2c_f32_bf16 v59, v135, v61
    v_dot2c_f32_bf16 v60, v135, v62
    v_mov_b32_dpp v12, v34 row_newbcast:2 row_mask:0xf bank_mask:0x3
    v_mov_b32_dpp v12, v34 row_newbcast:10 row_mask:0xf bank_mask:0xc
    v_lshlrev_b32 v13, 16, v12
    v_dot2c_f32_bf16 v37, v136, v12
    v_dot2c_f32_bf16 v38, v136, v13
    v_dot2c_f32_bf16 v39, v137, v12
    v_dot2c_f32_bf16 v40, v137, v13
    v_dot2c_f32_bf16 v41, v138, v12
    v_dot2c_f32_bf16 v42, v138, v13
    v_dot2c_f32_bf16 v43, v139, v12
    v_dot2c_f32_bf16 v44, v139, v13
    v_dot2c_f32_bf16 v45, v140, v12
    v_dot2c_f32_bf16 v46, v140, v13
    v_dot2c_f32_bf16 v47, v141, v12
    v_dot2c_f32_bf16 v48, v141, v13
    v_dot2c_f32_bf16 v49, v142, v12
    v_dot2c_f32_bf16 v50, v142, v13
    v_dot2c_f32_bf16 v51, v143, v12
    v_dot2c_f32_bf16 v52, v143, v13
    v_dot2c_f32_bf16 v53, v144, v12
    v_dot2c_f32_bf16 v54, v144, v13
    v_dot2c_f32_bf16 v55, v145, v12
    v_dot2c_f32_bf16 v56, v145, v13
    v_dot2c_f32_bf16 v57, v146, v12
    v_dot2c_f32_bf16 v58, v146, v13
    v_dot2c_f32_bf16 v59, v147, v12
    v_dot2c_f32_bf16 v60, v147, v13
    v_mov_b32_dpp v61, v34 row_newbcast:3 row_mask:0xf bank_mask:0x3
    v_mov_b32_dpp v61, v34 row_newbcast:11 row_mask:0xf bank_mask:0xc
    v_lshlrev_b32 v62, 16, v61
    v_dot2c_f32_bf16 v37, v148, v61
    v_dot2c_f32_bf16 v38, v148, v62
    v_dot2c_f32_bf16 v39, v149, v61
    v_dot2c_f32_bf16 v40, v149, v62
    v_dot2c_f32_bf16 v41, v150, v61
    v_dot2c_f32_bf16 v42, v150, v62
    v_dot2c_f32_bf16 v43, v151, v61
    v_dot2c_f32_bf16 v44, v151, v62
    v_dot2c_f32_bf16 v45, v152, v61
    v_dot2c_f32_bf16 v46, v152, v62
    v_dot2c_f32_bf16 v47, v153, v61
    v_dot2c_f32_bf16 v48, v153, v62
    v_dot2c_f32_bf16 v49, v154, v61
    v_dot2c_f32_bf16 v50, v154, v62
    v_dot2c_f32_bf16 v51, v155, v61
    v_dot2c_f32_bf16 v52, v155, v62
    v_dot2c_f32_bf16 v53, v156, v61
    v_dot2c_f32_bf16 v54, v156, v62
    v_dot2c_f32_bf16 v55, v157, v61
    v_dot2c_f32_bf16 v56, v157, v62
    v_dot2c_f32_bf16 v57, v158, v61
    v_dot2c_f32_bf16 v58, v158, v62
    v_dot2c_f32_bf16 v59, v159, v61
    v_dot2c_f32_bf16 v60, v159, v62
    buffer_load_dwordx4 v[112:115], v2, s[52:55], s60 offen offset:0 nt
    buffer_load_dwordx4 v[116:119], v2, s[52:55], s60 offen offset:128 nt
    buffer_load_dwordx4 v[120:123], v2, s[52:55], s60 offen offset:256 nt
    s_add_u32 s60, s60, 24576
    buffer_load_dwordx4 v[124:127], v2, s[52:55], s60 offen offset:0 nt
    buffer_load_dwordx4 v[128:131], v2, s[52:55], s60 offen offset:128 nt
    buffer_load_dwordx4 v[132:135], v2, s[52:55], s60 offen offset:256 nt
    s_add_u32 s60, s60, 24576
    buffer_load_dwordx4 v[136:139], v2, s[52:55], s60 offen offset:0 nt
    buffer_load_dwordx4 v[140:143], v2, s[52:55], s60 offen offset:128 nt
    buffer_load_dwordx4 v[144:147], v2, s[52:55], s60 offen offset:256 nt
    s_add_u32 s60, s60, 24576
    buffer_load_dwordx4 v[148:151], v2, s[52:55], s60 offen offset:0 nt
    buffer_load_dwordx4 v[152:155], v2, s[52:55], s60 offen offset:128 nt
    buffer_load_dwordx4 v[156:159], v2, s[52:55], s60 offen offset:256 nt
    s_add_u32 s60, s60, 24576
    s_waitcnt vmcnt(36)
    v_mov_b32_dpp v12, v34 row_newbcast:4 row_mask:0xf bank_mask:0x3
    v_mov_b32_dpp v12, v34 row_newbcast:12 row_mask:0xf bank_mask:0xc
    v_lshlrev_b32 v13, 16, v12
    v_dot2c_f32_bf16 v37, v160, v12
    v_dot2c_f32_bf16 v38, v160, v13
    v_dot2c_f32_bf16 v39, v161, v12
    v_dot2c_f32_bf16 v40, v161, v13
    v_dot2c_f32_bf16 v41, v162, v12
    v_dot2c_f32_bf16 v42, v162, v13
    v_dot2c_f32_bf16 v43, v163, v12
    v_dot2c_f32_bf16 v44, v163, v13
    v_dot2c_f32_bf16 v45, v164, v12
    v_dot2c_f32_bf16 v46, v164, v13
    v_dot2c_f32_bf16 v47, v165, v12
    v_dot2c_f32_bf16 v48, v165, v13
    v_dot2c_f32_bf16 v49, v166, v12
    v_dot2c_f32_bf16 v50, v166, v13
    v_dot2c_f32_bf16 v51, v167, v12
    v_dot2c_f32_bf16 v52, v167, v13
    v_dot2c_f32_bf16 v53, v168, v12
    v_dot2c_f32_bf16 v54, v168, v13
    v_dot2c_f32_bf16 v55, v169, v12
    v_dot2c_f32_bf16 v56, v169, v13
    v_dot2c_f32_bf16 v57, v170, v12
    v_dot2c_f32_bf16 v58, v170, v13
    v_dot2c_f32_bf16 v59, v171, v12
    v_dot2c_f32_bf16 v60, v171, v13
    v_mov_b32_dpp v61, v34 row_newbcast:5 row_mask:0xf bank_mask:0x3
    v_mov_b32_dpp v61, v34 row_newbcast:13 row_mask:0xf bank_mask:0xc
    v_lshlrev_b32 v62, 16, v61
    v_dot2c_f32_bf16 v37, v172, v61
    v_dot2c_f32_bf16 v38, v172, v62
    v_dot2c_f32_bf16 v39, v173, v61
    v_dot2c_f32_bf16 v40, v173, v62
    v_dot2c_f32_bf16 v41, v174, v61
    v_dot2c_f32_bf16 v42, v174, v62
    v_dot2c_f32_bf16 v43, v175, v61
    v_dot2c_f32_bf16 v44, v175, v62
    v_dot2c_f32_bf16 v45, v176, v61
    v_dot2c_f32_bf16 v46, v176, v62
    v_dot2c_f32_bf16 v47, v177, v61
    v_dot2c_f32_bf16 v48, v177, v62
    v_dot2c_f32_bf16 v49, v178, v61
    v_dot2c_f32_bf16 v50, v178, v62
    v_dot2c_f32_bf16 v51, v179, v61
    v_dot2c_f32_bf16 v52, v179, v62
    v_dot2c_f32_bf16 v53, v180, v61
    v_dot2c_f32_bf16 v54, v180, v62
    v_dot2c_f32_bf16 v55, v181, v61
    v_dot2c_f32_bf16 v56, v181, v62
    v_dot2c_f32_bf16 v57, v182, v61
    v_dot2c_f32_bf16 v58, v182, v62
    v_dot2c_f32_bf16 v59, v183, v61
    v_dot2c_f32_bf16 v60, v183, v62
    v_mov_b32_dpp v12, v34 row_newbcast:6 row_mask:0xf bank_mask:0x3
    v_mov_b32_dpp v12, v34 row_newbcast:14 row_mask:0xf bank_mask:0xc
    v_lshlrev_b32 v13, 16, v12
    v_dot2c_f32_bf16 v37, v184, v12
    v_dot2c_f32_bf16 v38, v184, v13
    v_dot2c_f32_bf16 v39, v185, v12
    v_dot2c_f32_bf16 v40, v185, v13
    v_dot2c_f32_bf16 v41, v186, v12
    v_dot2c_f32_bf16 v42, v186, v13
    v_dot2c_f32_bf16 v43, v187, v12
    v_dot2c_f32_bf16 v44, v187, v13
    v_dot2c_f32_bf16 v45, v188, v12
    v_dot2c_f32_bf16 v46, v188, v13
    v_dot2c_f32_bf16 v47, v189, v12
    v_dot2c_f32_bf16 v48, v189, v13
    v_dot2c_f32_bf16 v49, v190, v12
    v_dot2c_f32_bf16 v50, v190, v13
    v_dot2c_f32_bf16 v51, v191, v12
    v_dot2c_f32_bf16 v52, v191, v13
    v_dot2c_f32_bf16 v53, v192, v12
    v_dot2c_f32_bf16 v54, v192, v13
    v_dot2c_f32_bf16 v55, v193, v12
    v_dot2c_f32_bf16 v56, v193, v13
    v_dot2c_f32_bf16 v57, v194, v12
    v_dot2c_f32_bf16 v58, v194, v13
    v_dot2c_f32_bf16 v59, v195, v12
    v_dot2c_f32_bf16 v60, v195, v13
    v_mov_b32_dpp v61, v34 row_newbcast:7 row_mask:0xf bank_mask:0x3
    v_mov_b32_dpp v61, v34 row_newbcast:15 row_mask:0xf bank_mask:0xc
    v_lshlrev_b32 v62, 16, v61
    v_dot2c_f32_bf16 v37, v196, v61
    v_dot2c_f32_bf16 v38, v196, v62
    v_dot2c_f32_bf16 v39, v197, v61
    v_dot2c_f32_bf16 v40, v197, v62
    v_dot2c_f32_bf16 v41, v198, v61
    v_dot2c_f32_bf16 v42, v198, v62
    v_dot2c_f32_bf16 v43, v199, v61
    v_dot2c_f32_bf16 v44, v199, v62
    v_dot2c_f32_bf16 v45, v200, v61
    v_dot2c_f32_bf16 v46, v200, v62
    v_dot2c_f32_bf16 v47, v201, v61
    v_dot2c_f32_bf16 v48, v201, v62
    v_dot2c_f32_bf16 v49, v202, v61
    v_dot2c_f32_bf16 v50, v202, v62
    v_dot2c_f32_bf16 v51, v203, v61
    v_dot2c_f32_bf16 v52, v203, v62
    v_dot2c_f32_bf16 v53, v204, v61
    v_dot2c_f32_bf16 v54, v204, v62
    v_dot2c_f32_bf16 v55, v205, v61
    v_dot2c_f32_bf16 v56, v205, v62
    v_dot2c_f32_bf16 v57, v206, v61
    v_dot2c_f32_bf16 v58, v206, v62
    v_dot2c_f32_bf16 v59, v207, v61
    v_dot2c_f32_bf16 v60, v207, v62
    v_lshrrev_b32 v3, 1, v0
    v_min_u32 v3, 159, v3
    v_lshlrev_b32 v4, 4, v3
    s_add_u32 s10, s42, 5120
    s_addc_u32 s11, s43, 0
    global_load_dwordx4 v[200:203], v4, s[10:11] sc1
    global_load_dwordx4 v[192:195], v4, s[10:11] offset:2560 sc1
    s_add_u32 s10, s42, 10240
    s_addc_u32 s11, s43, 0
    global_load_dwordx4 v[196:199], v4, s[10:11] sc1
    v_lshlrev_b32 v4, 3, v3
    global_load_dwordx2 v[204:205], v4, s[16:17]
    s_min_u32 s97, s93, 9
    s_lshl_b32 s97, s97, 8
    v_lshl_add_u32 v4, v1, 2, s97
    global_load_dword v206, v4, s[10:11] offset:2560 sc1
    s_add_u32 s10, s42, 5120
    s_addc_u32 s11, s43, 0
    global_load_dword v207, v4, s[10:11] sc1
    v_lshrrev_b32 v4, 1, v4
    global_load_ushort v191, v4, s[16:17]
    s_waitcnt vmcnt(31)
    v_mov_b32_dpp v12, v35 row_newbcast:0 row_mask:0xf bank_mask:0x3
    v_mov_b32_dpp v12, v35 row_newbcast:8 row_mask:0xf bank_mask:0xc
    v_lshlrev_b32 v13, 16, v12
    v_dot2c_f32_bf16 v37, v208, v12
    v_dot2c_f32_bf16 v38, v208, v13
    v_dot2c_f32_bf16 v39, v209, v12
    v_dot2c_f32_bf16 v40, v209, v13
    v_dot2c_f32_bf16 v41, v210, v12
    v_dot2c_f32_bf16 v42, v210, v13
    v_dot2c_f32_bf16 v43, v211, v12
    v_dot2c_f32_bf16 v44, v211, v13
    v_dot2c_f32_bf16 v45, v212, v12
    v_dot2c_f32_bf16 v46, v212, v13
    v_dot2c_f32_bf16 v47, v213, v12
    v_dot2c_f32_bf16 v48, v213, v13
    v_dot2c_f32_bf16 v49, v214, v12
    v_dot2c_f32_bf16 v50, v214, v13
    v_dot2c_f32_bf16 v51, v215, v12
    v_dot2c_f32_bf16 v52, v215, v13
    v_dot2c_f32_bf16 v53, v216, v12
    v_dot2c_f32_bf16 v54, v216, v13
    v_dot2c_f32_bf16 v55, v217, v12
    v_dot2c_f32_bf16 v56, v217, v13
    v_dot2c_f32_bf16 v57, v218, v12
    v_dot2c_f32_bf16 v58, v218, v13
    v_dot2c_f32_bf16 v59, v219, v12
    v_dot2c_f32_bf16 v60, v219, v13
    v_mov_b32_dpp v61, v35 row_newbcast:1 row_mask:0xf bank_mask:0x3
    v_mov_b32_dpp v61, v35 row_newbcast:9 row_mask:0xf bank_mask:0xc
    v_lshlrev_b32 v62, 16, v61
    v_dot2c_f32_bf16 v37, v220, v61
    v_dot2c_f32_bf16 v38, v220, v62
    v_dot2c_f32_bf16 v39, v221, v61
    v_dot2c_f32_bf16 v40, v221, v62
    v_dot2c_f32_bf16 v41, v222, v61
    v_dot2c_f32_bf16 v42, v222, v62
    v_dot2c_f32_bf16 v43, v223, v61
    v_dot2c_f32_bf16 v44, v223, v62
    v_dot2c_f32_bf16 v45, v224, v61
    v_dot2c_f32_bf16 v46, v224, v62
    v_dot2c_f32_bf16 v47, v225, v61
    v_dot2c_f32_bf16 v48, v225, v62
    v_dot2c_f32_bf16 v49, v226, v61
    v_dot2c_f32_bf16 v50, v226, v62
    v_dot2c_f32_bf16 v51, v227, v61
    v_dot2c_f32_bf16 v52, v227, v62
    v_dot2c_f32_bf16 v53, v228, v61
    v_dot2c_f32_bf16 v54, v228, v62
    v_dot2c_f32_bf16 v55, v229, v61
    v_dot2c_f32_bf16 v56, v229, v62
    v_dot2c_f32_bf16 v57, v230, v61
    v_dot2c_f32_bf16 v58, v230, v62
    v_dot2c_f32_bf16 v59, v231, v61
    v_dot2c_f32_bf16 v60, v231, v62
    v_mov_b32_dpp v12, v35 row_newbcast:2 row_mask:0xf bank_mask:0x3
    v_mov_b32_dpp v12, v35 row_newbcast:10 row_mask:0xf bank_mask:0xc
    v_lshlrev_b32 v13, 16, v12
    v_dot2c_f32_bf16 v37, v232, v12
    v_dot2c_f32_bf16 v38, v232, v13
    v_dot2c_f32_bf16 v39, v233, v12
    v_dot2c_f32_bf16 v40, v233, v13
    v_dot2c_f32_bf16 v41, v234, v12
    v_dot2c_f32_bf16 v42, v234, v13
    v_dot2c_f32_bf16 v43, v235, v12
    v_dot2c_f32_bf16 v44, v235, v13
    v_dot2c_f32_bf16 v45, v236, v12
    v_dot2c_f32_bf16 v46, v236, v13
    v_dot2c_f32_bf16 v47, v237, v12
    v_dot2c_f32_bf16 v48, v237, v13
    v_dot2c_f32_bf16 v49, v238, v12
    v_dot2c_f32_bf16 v50, v238, v13
    v_dot2c_f32_bf16 v51, v239, v12
    v_dot2c_f32_bf16 v52, v239, v13
    v_dot2c_f32_bf16 v53, v240, v12
    v_dot2c_f32_bf16 v54, v240, v13
    v_dot2c_f32_bf16 v55, v241, v12
    v_dot2c_f32_bf16 v56, v241, v13
    v_dot2c_f32_bf16 v57, v242, v12
    v_dot2c_f32_bf16 v58, v242, v13
    v_dot2c_f32_bf16 v59, v243, v12
    v_dot2c_f32_bf16 v60, v243, v13
    v_mov_b32_dpp v61, v35 row_newbcast:3 row_mask:0xf bank_mask:0x3
    v_mov_b32_dpp v61, v35 row_newbcast:11 row_mask:0xf bank_mask:0xc
    v_lshlrev_b32 v62, 16, v61
    v_dot2c_f32_bf16 v37, v244, v61
    v_dot2c_f32_bf16 v38, v244, v62
    v_dot2c_f32_bf16 v39, v245, v61
    v_dot2c_f32_bf16 v40, v245, v62
    v_dot2c_f32_bf16 v41, v246, v61
    v_dot2c_f32_bf16 v42, v246, v62
    v_dot2c_f32_bf16 v43, v247, v61
    v_dot2c_f32_bf16 v44, v247, v62
    v_dot2c_f32_bf16 v45, v248, v61
    v_dot2c_f32_bf16 v46, v248, v62
    v_dot2c_f32_bf16 v47, v249, v61
    v_dot2c_f32_bf16 v48, v249, v62
    v_dot2c_f32_bf16 v49, v250, v61
    v_dot2c_f32_bf16 v50, v250, v62
    v_dot2c_f32_bf16 v51, v251, v61
    v_dot2c_f32_bf16 v52, v251, v62
    v_dot2c_f32_bf16 v53, v252, v61
    v_dot2c_f32_bf16 v54, v252, v62
    v_dot2c_f32_bf16 v55, v253, v61
    v_dot2c_f32_bf16 v56, v253, v62
    v_dot2c_f32_bf16 v57, v254, v61
    v_dot2c_f32_bf16 v58, v254, v62
    v_dot2c_f32_bf16 v59, v255, v61
    v_dot2c_f32_bf16 v60, v255, v62
    s_waitcnt vmcnt(19)
    v_mov_b32_dpp v12, v35 row_newbcast:4 row_mask:0xf bank_mask:0x3
    v_mov_b32_dpp v12, v35 row_newbcast:12 row_mask:0xf bank_mask:0xc
    v_lshlrev_b32 v13, 16, v12
    v_dot2c_f32_bf16 v37, v64, v12
    v_dot2c_f32_bf16 v38, v64, v13
    v_dot2c_f32_bf16 v39, v65, v12
    v_dot2c_f32_bf16 v40, v65, v13
    v_dot2c_f32_bf16 v41, v66, v12
    v_dot2c_f32_bf16 v42, v66, v13
    v_dot2c_f32_bf16 v43, v67, v12
    v_dot2c_f32_bf16 v44, v67, v13
    v_dot2c_f32_bf16 v45, v68, v12
    v_dot2c_f32_bf16 v46, v68, v13
    v_dot2c_f32_bf16 v47, v69, v12
    v_dot2c_f32_bf16 v48, v69, v13
    v_dot2c_f32_bf16 v49, v70, v12
    v_dot2c_f32_bf16 v50, v70, v13
    v_dot2c_f32_bf16 v51, v71, v12
    v_dot2c_f32_bf16 v52, v71, v13
    v_dot2c_f32_bf16 v53, v72, v12
    v_dot2c_f32_bf16 v54, v72, v13
    v_dot2c_f32_bf16 v55, v73, v12
    v_dot2c_f32_bf16 v56, v73, v13
    v_dot2c_f32_bf16 v57, v74, v12
    v_dot2c_f32_bf16 v58, v74, v13
    v_dot2c_f32_bf16 v59, v75, v12
    v_dot2c_f32_bf16 v60, v75, v13
    v_mov_b32_dpp v61, v35 row_newbcast:5 row_mask:0xf bank_mask:0x3
    v_mov_b32_dpp v61, v35 row_newbcast:13 row_mask:0xf bank_mask:0xc
    v_lshlrev_b32 v62, 16, v61
    v_dot2c_f32_bf16 v37, v76, v61
    v_dot2c_f32_bf16 v38, v76, v62
    v_dot2c_f32_bf16 v39, v77, v61
    v_dot2c_f32_bf16 v40, v77, v62
    v_dot2c_f32_bf16 v41, v78, v61
    v_dot2c_f32_bf16 v42, v78, v62
    v_dot2c_f32_bf16 v43, v79, v61
    v_dot2c_f32_bf16 v44, v79, v62
    v_dot2c_f32_bf16 v45, v80, v61
    v_dot2c_f32_bf16 v46, v80, v62
    v_dot2c_f32_bf16 v47, v81, v61
    v_dot2c_f32_bf16 v48, v81, v62
    v_dot2c_f32_bf16 v49, v82, v61
    v_dot2c_f32_bf16 v50, v82, v62
    v_dot2c_f32_bf16 v51, v83, v61
    v_dot2c_f32_bf16 v52, v83, v62
    v_dot2c_f32_bf16 v53, v84, v61
    v_dot2c_f32_bf16 v54, v84, v62
    v_dot2c_f32_bf16 v55, v85, v61
    v_dot2c_f32_bf16 v56, v85, v62
    v_dot2c_f32_bf16 v57, v86, v61
    v_dot2c_f32_bf16 v58, v86, v62
    v_dot2c_f32_bf16 v59, v87, v61
    v_dot2c_f32_bf16 v60, v87, v62
    v_mov_b32_dpp v12, v35 row_newbcast:6 row_mask:0xf bank_mask:0x3
    v_mov_b32_dpp v12, v35 row_newbcast:14 row_mask:0xf bank_mask:0xc
    v_lshlrev_b32 v13, 16, v12
    v_dot2c_f32_bf16 v37, v88, v12
    v_dot2c_f32_bf16 v38, v88, v13
    v_dot2c_f32_bf16 v39, v89, v12
    v_dot2c_f32_bf16 v40, v89, v13
    v_dot2c_f32_bf16 v41, v90, v12
    v_dot2c_f32_bf16 v42, v90, v13
    v_dot2c_f32_bf16 v43, v91, v12
    v_dot2c_f32_bf16 v44, v91, v13
    v_dot2c_f32_bf16 v45, v92, v12
    v_dot2c_f32_bf16 v46, v92, v13
    v_dot2c_f32_bf16 v47, v93, v12
    v_dot2c_f32_bf16 v48, v93, v13
    v_dot2c_f32_bf16 v49, v94, v12
    v_dot2c_f32_bf16 v50, v94, v13
    v_dot2c_f32_bf16 v51, v95, v12
    v_dot2c_f32_bf16 v52, v95, v13
    v_dot2c_f32_bf16 v53, v96, v12
    v_dot2c_f32_bf16 v54, v96, v13
    v_dot2c_f32_bf16 v55, v97, v12
    v_dot2c_f32_bf16 v56, v97, v13
    v_dot2c_f32_bf16 v57, v98, v12
    v_dot2c_f32_bf16 v58, v98, v13
    v_dot2c_f32_bf16 v59, v99, v12
    v_dot2c_f32_bf16 v60, v99, v13
    v_mov_b32_dpp v61, v35 row_newbcast:7 row_mask:0xf bank_mask:0x3
    v_mov_b32_dpp v61, v35 row_newbcast:15 row_mask:0xf bank_mask:0xc
    v_lshlrev_b32 v62, 16, v61
    v_dot2c_f32_bf16 v37, v100, v61
    v_dot2c_f32_bf16 v38, v100, v62
    v_dot2c_f32_bf16 v39, v101, v61
    v_dot2c_f32_bf16 v40, v101, v62
    v_dot2c_f32_bf16 v41, v102, v61
    v_dot2c_f32_bf16 v42, v102, v62
    v_dot2c_f32_bf16 v43, v103, v61
    v_dot2c_f32_bf16 v44, v103, v62
    v_dot2c_f32_bf16 v45, v104, v61
    v_dot2c_f32_bf16 v46, v104, v62
    v_dot2c_f32_bf16 v47, v105, v61
    v_dot2c_f32_bf16 v48, v105, v62
    v_dot2c_f32_bf16 v49, v106, v61
    v_dot2c_f32_bf16 v50, v106, v62
    v_dot2c_f32_bf16 v51, v107, v61
    v_dot2c_f32_bf16 v52, v107, v62
    v_dot2c_f32_bf16 v53, v108, v61
    v_dot2c_f32_bf16 v54, v108, v62
    v_dot2c_f32_bf16 v55, v109, v61
    v_dot2c_f32_bf16 v56, v109, v62
    v_dot2c_f32_bf16 v57, v110, v61
    v_dot2c_f32_bf16 v58, v110, v62
    v_dot2c_f32_bf16 v59, v111, v61
    v_dot2c_f32_bf16 v60, v111, v62
    s_waitcnt vmcnt(7)
    v_mov_b32_dpp v12, v36 row_newbcast:0 row_mask:0xf bank_mask:0x3
    v_mov_b32_dpp v12, v36 row_newbcast:8 row_mask:0xf bank_mask:0xc
    v_lshlrev_b32 v13, 16, v12
    v_dot2c_f32_bf16 v37, v112, v12
    v_dot2c_f32_bf16 v38, v112, v13
    v_dot2c_f32_bf16 v39, v113, v12
    v_dot2c_f32_bf16 v40, v113, v13
    v_dot2c_f32_bf16 v41, v114, v12
    v_dot2c_f32_bf16 v42, v114, v13
    v_dot2c_f32_bf16 v43, v115, v12
    v_dot2c_f32_bf16 v44, v115, v13
    v_dot2c_f32_bf16 v45, v116, v12
    v_dot2c_f32_bf16 v46, v116, v13
    v_dot2c_f32_bf16 v47, v117, v12
    v_dot2c_f32_bf16 v48, v117, v13
    v_dot2c_f32_bf16 v49, v118, v12
    v_dot2c_f32_bf16 v50, v118, v13
    v_dot2c_f32_bf16 v51, v119, v12
    v_dot2c_f32_bf16 v52, v119, v13
    v_dot2c_f32_bf16 v53, v120, v12
    v_dot2c_f32_bf16 v54, v120, v13
    v_dot2c_f32_bf16 v55, v121, v12
    v_dot2c_f32_bf16 v56, v121, v13
    v_dot2c_f32_bf16 v57, v122, v12
    v_dot2c_f32_bf16 v58, v122, v13
    v_dot2c_f32_bf16 v59, v123, v12
    v_dot2c_f32_bf16 v60, v123, v13
    v_mov_b32_dpp v61, v36 row_newbcast:1 row_mask:0xf bank_mask:0x3
    v_mov_b32_dpp v61, v36 row_newbcast:9 row_mask:0xf bank_mask:0xc
    v_lshlrev_b32 v62, 16, v61
    v_dot2c_f32_bf16 v37, v124, v61
    v_dot2c_f32_bf16 v38, v124, v62
    v_dot2c_f32_bf16 v39, v125, v61
    v_dot2c_f32_bf16 v40, v125, v62
    v_dot2c_f32_bf16 v41, v126, v61
    v_dot2c_f32_bf16 v42, v126, v62
    v_dot2c_f32_bf16 v43, v127, v61
    v_dot2c_f32_bf16 v44, v127, v62
    v_dot2c_f32_bf16 v45, v128, v61
    v_dot2c_f32_bf16 v46, v128, v62
    v_dot2c_f32_bf16 v47, v129, v61
    v_dot2c_f32_bf16 v48, v129, v62
    v_dot2c_f32_bf16 v49, v130, v61
    v_dot2c_f32_bf16 v50, v130, v62
    v_dot2c_f32_bf16 v51, v131, v61
    v_dot2c_f32_bf16 v52, v131, v62
    v_dot2c_f32_bf16 v53, v132, v61
    v_dot2c_f32_bf16 v54, v132, v62
    v_dot2c_f32_bf16 v55, v133, v61
    v_dot2c_f32_bf16 v56, v133, v62
    v_dot2c_f32_bf16 v57, v134, v61
    v_dot2c_f32_bf16 v58, v134, v62
    v_dot2c_f32_bf16 v59, v135, v61
    v_dot2c_f32_bf16 v60, v135, v62
    v_mov_b32_dpp v12, v36 row_newbcast:2 row_mask:0xf bank_mask:0x3
    v_mov_b32_dpp v12, v36 row_newbcast:10 row_mask:0xf bank_mask:0xc
    v_lshlrev_b32 v13, 16, v12
    v_dot2c_f32_bf16 v37, v136, v12
    v_dot2c_f32_bf16 v38, v136, v13
    v_dot2c_f32_bf16 v39, v137, v12
    v_dot2c_f32_bf16 v40, v137, v13
    v_dot2c_f32_bf16 v41, v138, v12
    v_dot2c_f32_bf16 v42, v138, v13
    v_dot2c_f32_bf16 v43, v139, v12
    v_dot2c_f32_bf16 v44, v139, v13
    v_dot2c_f32_bf16 v45, v140, v12
    v_dot2c_f32_bf16 v46, v140, v13
    v_dot2c_f32_bf16 v47, v141, v12
    v_dot2c_f32_bf16 v48, v141, v13
    v_dot2c_f32_bf16 v49, v142, v12
    v_dot2c_f32_bf16 v50, v142, v13
    v_dot2c_f32_bf16 v51, v143, v12
    v_dot2c_f32_bf16 v52, v143, v13
    v_dot2c_f32_bf16 v53, v144, v12
    v_dot2c_f32_bf16 v54, v144, v13
    v_dot2c_f32_bf16 v55, v145, v12
    v_dot2c_f32_bf16 v56, v145, v13
    v_dot2c_f32_bf16 v57, v146, v12
    v_dot2c_f32_bf16 v58, v146, v13
    v_dot2c_f32_bf16 v59, v147, v12
    v_dot2c_f32_bf16 v60, v147, v13
    v_mov_b32_dpp v61, v36 row_newbcast:3 row_mask:0xf bank_mask:0x3
    v_mov_b32_dpp v61, v36 row_newbcast:11 row_mask:0xf bank_mask:0xc
    v_lshlrev_b32 v62, 16, v61
    v_dot2c_f32_bf16 v37, v148, v61
    v_dot2c_f32_bf16 v38, v148, v62
    v_dot2c_f32_bf16 v39, v149, v61
    v_dot2c_f32_bf16 v40, v149, v62
    v_dot2c_f32_bf16 v41, v150, v61
    v_dot2c_f32_bf16 v42, v150, v62
    v_dot2c_f32_bf16 v43, v151, v61
    v_dot2c_f32_bf16 v44, v151, v62
    v_dot2c_f32_bf16 v45, v152, v61
    v_dot2c_f32_bf16 v46, v152, v62
    v_dot2c_f32_bf16 v47, v153, v61
    v_dot2c_f32_bf16 v48, v153, v62
    v_dot2c_f32_bf16 v49, v154, v61
    v_dot2c_f32_bf16 v50, v154, v62
    v_dot2c_f32_bf16 v51, v155, v61
    v_dot2c_f32_bf16 v52, v155, v62
    v_dot2c_f32_bf16 v53, v156, v61
    v_dot2c_f32_bf16 v54, v156, v62
    v_dot2c_f32_bf16 v55, v157, v61
    v_dot2c_f32_bf16 v56, v157, v62
    v_dot2c_f32_bf16 v57, v158, v61
    v_dot2c_f32_bf16 v58, v158, v62
    v_dot2c_f32_bf16 v59, v159, v61
    v_dot2c_f32_bf16 v60, v159, v62
    s_nop 2
    v_permlane32_swap_b32 v37, v49
    v_permlane32_swap_b32 v38, v50
    v_permlane32_swap_b32 v39, v51
    v_permlane32_swap_b32 v40, v52
    v_permlane32_swap_b32 v41, v53
    v_permlane32_swap_b32 v42, v54
    v_permlane32_swap_b32 v43, v55
    v_permlane32_swap_b32 v44, v56
    v_permlane32_swap_b32 v45, v57
    v_permlane32_swap_b32 v46, v58
    v_permlane32_swap_b32 v47, v59
    v_permlane32_swap_b32 v48, v60
    s_nop 1
    v_add_f32 v37, v37, v49
    v_add_f32 v38, v38, v50
    v_add_f32 v39, v39, v51
    v_add_f32 v40, v40, v52
    v_add_f32 v41, v41, v53
    v_add_f32 v42, v42, v54
    v_add_f32 v43, v43, v55
    v_add_f32 v44, v44, v56
    v_add_f32 v45, v45, v57
    v_add_f32 v46, v46, v58
    v_add_f32 v47, v47, v59
    v_add_f32 v48, v48, v60
    s_nop 2
    v_permlane16_swap_b32 v37, v43
    v_permlane16_swap_b32 v38, v44
    v_permlane16_swap_b32 v39, v45
    v_permlane16_swap_b32 v40, v46
    v_permlane16_swap_b32 v41, v47
    v_permlane16_swap_b32 v42, v48
    s_nop 1
    v_add_f32 v37, v37, v43
    v_add_f32 v38, v38, v44
    v_add_f32 v39, v39, v45
    v_add_f32 v40, v40, v46
    v_add_f32 v41, v41, v47
    v_add_f32 v42, v42, v48
    s_nop 1
    v_add_f32_dpp v37, v37, v37 row_ror:8 row_mask:0xf bank_mask:0xf
    v_add_f32_dpp v38, v38, v38 row_ror:8 row_mask:0xf bank_mask:0xf
    v_add_f32_dpp v39, v39, v39 row_ror:8 row_mask:0xf bank_mask:0xf
    v_add_f32_dpp v40, v40, v40 row_ror:8 row_mask:0xf bank_mask:0xf
    v_add_f32_dpp v41, v41, v41 row_ror:8 row_mask:0xf bank_mask:0xf
    v_add_f32_dpp v42, v42, v42 row_ror:8 row_mask:0xf bank_mask:0xf
    v_lshrrev_b32 v3, 4, v1
    v_mul_u32_u24 v3, 6, v3
    v_and_b32 v60, 7, v1
    v_lshlrev_b32 v60, 5, v60
    s_mul_i32 s97, s3, 768
    v_add_u32 v60, s97, v60
    v_and_b32 v61, 8, v1
    v_cmp_eq_u32 vcc, 0, v61
    s_and_saveexec_b64 s[4:5], vcc
    s_cbranch_execz L_m_58
    v_add_u32 v61, 0, v3
    v_lshrrev_b32 v62, 3, v61
    v_and_b32 v61, 7, v61
    v_lshlrev_b32 v62, 8, v62
    v_lshl_add_u32 v61, v61, 2, v62
    v_add_u32 v61, v61, v60
    ds_write_b32 v61, v37 offset:8192
    v_add_u32 v61, 1, v3
    v_lshrrev_b32 v62, 3, v61
    v_and_b32 v61, 7, v61
    v_lshlrev_b32 v62, 8, v62
    v_lshl_add_u32 v61, v61, 2, v62
    v_add_u32 v61, v61, v60
    ds_write_b32 v61, v38 offset:8192
    v_add_u32 v61, 2, v3
    v_lshrrev_b32 v62, 3, v61
    v_and_b32 v61, 7, v61
    v_lshlrev_b32 v62, 8, v62
    v_lshl_add_u32 v61, v61, 2, v62
    v_add_u32 v61, v61, v60
    ds_write_b32 v61, v39 offset:8192
    v_add_u32 v61, 3, v3
    v_lshrrev_b32 v62, 3, v61
    v_and_b32 v61, 7, v61
    v_lshlrev_b32 v62, 8, v62
    v_lshl_add_u32 v61, v61, 2, v62
    v_add_u32 v61, v61, v60
    ds_write_b32 v61, v40 offset:8192
    v_add_u32 v61, 4, v3
    v_lshrrev_b32 v62, 3, v61
    v_and_b32 v61, 7, v61
    v_lshlrev_b32 v62, 8, v62
    v_lshl_add_u32 v61, v61, 2, v62
    v_add_u32 v61, v61, v60
    ds_write_b32 v61, v41 offset:8192
    v_add_u32 v61, 5, v3
    v_lshrrev_b32 v62, 3, v61
    v_and_b32 v61, 7, v61
    v_lshlrev_b32 v62, 8, v62
    v_lshl_add_u32 v61, v61, 2, v62
    v_add_u32 v61, v61, v60
    ds_write_b32 v61, v42 offset:8192
L_m_58:
    s_mov_b64 exec, s[4:5]
    s_waitcnt lgkmcnt(0)
    v_lshlrev_b32 v3, 4, v0
    v_add_u32 v5, 0x10000, v3
    ds_read_b128 v[64:67], v3 offset:24576
    ds_read_b128 v[68:71], v3 offset:32768
    ds_read_b128 v[72:75], v3 offset:40960
    ds_read_b128 v[76:79], v3 offset:49152
    ds_read_b128 v[80:83], v3 offset:57344
    ds_read_b128 v[84:87], v5 offset:0
    ds_read_b128 v[88:91], v5 offset:8192
    ds_read_b128 v[92:95], v5 offset:16384
    ds_read_b128 v[96:99], v5 offset:24576
    ds_read_b128 v[100:103], v5 offset:32768
    s_barrier
    s_cmp_lg_u32 s3, 0
    s_cbranch_scc1 L_nw0_59
    v_lshlrev_b32 v3, 4, v1
    v_min_u32 v3, 0x2f0, v3
    ds_read_b128 v[208:211], v3 offset:8192
    ds_read_b128 v[212:215], v3 offset:8960
    ds_read_b128 v[216:219], v3 offset:9728
    ds_read_b128 v[220:223], v3 offset:10496
    ds_read_b128 v[224:227], v3 offset:11264
    ds_read_b128 v[228:231], v3 offset:12032
    ds_read_b128 v[232:235], v3 offset:12800
    ds_read_b128 v[236:239], v3 offset:13568
    s_waitcnt lgkmcnt(0)
    v_add_f32 v208, v208, v224
    v_add_f32 v209, v209, v225
    v_add_f32 v210, v210, v226
    v_add_f32 v211, v211, v227
    v_add_f32 v212, v212, v228
    v_add_f32 v213, v213, v229
    v_add_f32 v214, v214, v230
    v_add_f32 v215, v215, v231
    v_add_f32 v216, v216, v232
    v_add_f32 v217, v217, v233
    v_add_f32 v218, v218, v234
    v_add_f32 v219, v219, v235
    v_add_f32 v220, v220, v236
    v_add_f32 v221, v221, v237
    v_add_f32 v222, v222, v238
    v_add_f32 v223, v223, v239
    v_add_f32 v208, v208, v216
    v_add_f32 v209, v209, v217
    v_add_f32 v210, v210, v218
    v_add_f32 v211, v211, v219
    v_add_f32 v212, v212, v220
    v_add_f32 v213, v213, v221
    v_add_f32 v214, v214, v222
    v_add_f32 v215, v215, v223
    v_add_f32 v208, v208, v212
    v_add_f32 v209, v209, v213
    v_add_f32 v210, v210, v214
    v_add_f32 v211, v211, v215
    s_mul_i32 s97, s96, 768
    s_add_u32 s97, s97, 65536
    v_add_u32 v4, s97, v3
    v_cmp_gt_u32 vcc, 48, v1
    s_and_saveexec_b64 s[4:5], vcc
    s_cbranch_execz L_m_60
    global_store_dwordx4 v4, v[208:211], s[42:43] sc1
L_m_60:
    s_mov_b64 exec, s[4:5]
L_nw0_59:
    s_cmp_eq_u32 s92, 0
    s_cbranch_scc1 L_ffn
    s_cmp_eq_u32 s92, 2
    s_cbranch_scc1 L_fin
    s_cmp_eq_u32 s92, 3
    s_cbranch_scc1 L_done
    s_lshl_b32 s97, s94, 4
    v_min_u32 v3, 15, v1
    v_add_u32 v3, s97, v3
    v_mul_u32_u24 v3, 768, v3
    v_add_u32 v3, 66300, v3
    s_mov_b32 s63, 0
L_spin_61:
    global_load_dword v4, v3, s[42:43] sc1
    s_waitcnt vmcnt(0)
    v_cmp_eq_u32 vcc, -1, v4
    s_nop 1
    s_cbranch_vccz L_spun_62
    s_add_u32 s63, s63, 1
    s_cmp_ge_u32 s63, 65536
    s_cbranch_scc1 L_spun_62
    s_sleep 2
    s_branch L_spin_61
L_spun_62:
    v_min_u32 v3, 383, v0
    v_lshrrev_b32 v4, 2, v3
    v_and_b32 v5, 3, v3
    v_cmp_le_u32 vcc, 48, v4
    v_mov_b32 v6, 0
    v_mov_b32 v7, 8*768-48*16
    s_nop 0
    v_cndmask_b32 v6, v6, v7, vcc
    v_lshlrev_b32 v4, 4, v4
    v_add_u32 v4, v4, v6
    v_mul_u32_u24 v5, 768, v5
    v_add_u32 v4, v4, v5
    s_mul_i32 s97, s94, 12288
    s_add_u32 s97, s97, 65536
    v_add_u32 v4, s97, v4
    s_mov_b32 s63, 0
L_spin_63:
    global_load_dwordx4 v[152:155], v4, s[42:43] sc1
    global_load_dwordx4 v[156:159], v4, s[42:43] offset:3072 sc1
    s_waitcnt vmcnt(0)
    v_max_u32 v6, v152, v153
    v_max3_u32 v6, v6, v154, v155
    v_max3_u32 v6, v6, v156, v157
    v_max3_u32 v6, v6, v158, v159
    v_cmp_eq_u32 vcc, -1, v6
    s_nop 1
    s_cbranch_vccz L_spun_64
    s_add_u32 s63, s63, 1
    s_cmp_ge_u32 s63, 65536
    s_cbranch_scc1 L_spun_64
    s_branch L_spin_63
L_spun_64:
    v_add_f32 v152, v152, v156
    v_add_f32 v153, v153, v157
    v_add_f32 v154, v154, v158
    v_add_f32 v155, v155, v159
    v_add_f32_dpp v152, v152, v152 quad_perm:[1,0,3,2] row_mask:0xf bank_mask:0xf
    v_add_f32_dpp v153, v153, v153 quad_perm:[1,0,3,2] row_mask:0xf bank_mask:0xf
    v_add_f32_dpp v154, v154, v154 quad_perm:[1,0,3,2] row_mask:0xf bank_mask:0xf
    v_add_f32_dpp v155, v155, v155 quad_perm:[1,0,3,2] row_mask:0xf bank_mask:0xf
    v_add_f32_dpp v152, v152, v152 quad_perm:[2,3,0,1] row_mask:0xf bank_mask:0xf
    v_add_f32_dpp v153, v153, v153 quad_perm:[2,3,0,1] row_mask:0xf bank_mask:0xf
    v_add_f32_dpp v154, v154, v154 quad_perm:[2,3,0,1] row_mask:0xf bank_mask:0xf
    v_add_f32_dpp v155, v155, v155 quad_perm:[2,3,0,1] row_mask:0xf bank_mask:0xf
    v_cvt_pk_bf16_f32 v156, v152, v153
    v_cvt_pk_bf16_f32 v157, v154, v155
    v_lshrrev_b32 v3, 2, v0
    v_lshlrev_b32 v3, 3, v3
    v_and_b32 v4, 3, v0
    v_cmp_eq_u32 vcc, 0, v4
    v_mov_b32 v5, 384
    v_cmp_gt_u32 s[6:7], v5, v0
    s_and_b64 vcc, vcc, s[6:7]
    s_and_saveexec_b64 s[4:5], vcc
    s_cbranch_execz L_m_65
    ds_write_b64 v3, v[156:157] offset:14336
L_m_65:
    s_mov_b64 exec, s[4:5]
    s_waitcnt lgkmcnt(0)
    s_barrier
    v_lshrrev_b32 v3, 3, v0
    v_lshlrev_b32 v3, 1, v3
    ds_read_u16 v152, v3 offset:14336
    ds_read_u16 v153, v3 offset:14464
    ds_read_u16 v154, v3 offset:14592
    ds_read_u16 v155, v3 offset:14720
    ds_read_u16 v156, v3 offset:14848
    ds_read_u16 v157, v3 offset:14976
    v_mov_b32 v4, 0
    v_mov_b32 v5, 0
    v_mov_b32 v6, 0
    v_mov_b32 v7, 0
    v_mov_b32 v8, 0
    v_mov_b32 v9, 0
    v_mov_b32 v10, 0
    v_mov_b32 v11, 0
    s_waitcnt lgkmcnt(0)
    v_lshlrev_b32 v158, 16, v152
    v_dot2c_f32_bf16 v4, v64, v152
    v_dot2c_f32_bf16 v5, v64, v158
    v_dot2c_f32_bf16 v6, v65, v152
    v_dot2c_f32_bf16 v7, v65, v158
    v_dot2c_f32_bf16 v8, v66, v152
    v_dot2c_f32_bf16 v9, v66, v158
    v_dot2c_f32_bf16 v10, v67, v152
    v_dot2c_f32_bf16 v11, v67, v158
    v_lshlrev_b32 v158, 16, v153
    v_dot2c_f32_bf16 v4, v68, v153
    v_dot2c_f32_bf16 v5, v68, v158
    v_dot2c_f32_bf16 v6, v69, v153
    v_dot2c_f32_bf16 v7, v69, v158
    v_dot2c_f32_bf16 v8, v70, v153
    v_dot2c_f32_bf16 v9, v70, v158
    v_dot2c_f32_bf16 v10, v71, v153
    v_dot2c_f32_bf16 v11, v71, v158
    v_lshlrev_b32 v158, 16, v154
    v_dot2c_f32_bf16 v4, v72, v154
    v_dot2c_f32_bf16 v5, v72, v158
    v_dot2c_f32_bf16 v6, v73, v154
    v_dot2c_f32_bf16 v7, v73, v158
    v_dot2c_f32_bf16 v8, v74, v154
    v_dot2c_f32_bf16 v9, v74, v158
    v_dot2c_f32_bf16 v10, v75, v154
    v_dot2c_f32_bf16 v11, v75, v158
    v_lshlrev_b32 v158, 16, v155
    v_dot2c_f32_bf16 v4, v76, v155
    v_dot2c_f32_bf16 v5, v76, v158
    v_dot2c_f32_bf16 v6, v77, v155
    v_dot2c_f32_bf16 v7, v77, v158
    v_dot2c_f32_bf16 v8, v78, v155
    v_dot2c_f32_bf16 v9, v78, v158
    v_dot2c_f32_bf16 v10, v79, v155
    v_dot2c_f32_bf16 v11, v79, v158
    v_lshlrev_b32 v158, 16, v156
    v_dot2c_f32_bf16 v4, v80, v156
    v_dot2c_f32_bf16 v5, v80, v158
    v_dot2c_f32_bf16 v6, v81, v156
    v_dot2c_f32_bf16 v7, v81, v158
    v_dot2c_f32_bf16 v8, v82, v156
    v_dot2c_f32_bf16 v9, v82, v158
    v_dot2c_f32_bf16 v10, v83, v156
    v_dot2c_f32_bf16 v11, v83, v158
    v_lshlrev_b32 v158, 16, v157
    v_dot2c_f32_bf16 v4, v84, v157
    v_dot2c_f32_bf16 v5, v84, v158
    v_dot2c_f32_bf16 v6, v85, v157
    v_dot2c_f32_bf16 v7, v85, v158
    v_dot2c_f32_bf16 v8, v86, v157
    v_dot2c_f32_bf16 v9, v86, v158
    v_dot2c_f32_bf16 v10, v87, v157
    v_dot2c_f32_bf16 v11, v87, v158
    s_nop 2
    v_permlane32_swap_b32 v4, v8
    v_permlane32_swap_b32 v5, v9
    v_permlane32_swap_b32 v6, v10
    v_permlane32_swap_b32 v7, v11
    s_nop 1
    v_add_f32 v4, v4, v8
    v_add_f32 v5, v5, v9
    v_add_f32 v6, v6, v10
    v_add_f32 v7, v7, v11
    s_nop 2
    v_permlane16_swap_b32 v4, v6
    v_permlane16_swap_b32 v5, v7
    s_nop 1
    v_add_f32 v4, v4, v6
    v_add_f32 v5, v5, v7
    s_nop 1
    v_add_f32_dpp v4, v4, v4 row_ror:8 row_mask:0xf bank_mask:0xf
    v_add_f32_dpp v5, v5, v5 row_ror:8 row_mask:0xf bank_mask:0xf
    v_lshrrev_b32 v12, 4, v1
    v_lshlrev_b32 v12, 3, v12
    v_and_b32 v13, 7, v1
    v_lshl_add_u32 v12, v13, 5, v12
    s_lshl_b32 s97, s3, 8
    v_add_u32 v12, s97, v12
    v_and_b32 v13, 8, v1
    v_cmp_eq_u32 vcc, 0, v13
    s_and_saveexec_b64 s[4:5], vcc
    s_cbranch_execz L_m_66
    ds_write_b64 v12, v[4:5] offset:0
L_m_66:
    s_mov_b64 exec, s[4:5]
    s_waitcnt lgkmcnt(0)
    s_barrier
    s_cmp_lg_u32 s3, 0
    s_cbranch_scc1 L_nw0_67
    v_lshlrev_b32 v12, 2, v1
    ds_read_b32 v152, v12 offset:0
    ds_read_b32 v153, v12 offset:256
    ds_read_b32 v154, v12 offset:512
    ds_read_b32 v155, v12 offset:768
    ds_read_b32 v156, v12 offset:1024
    ds_read_b32 v157, v12 offset:1280
    ds_read_b32 v158, v12 offset:1536
    ds_read_b32 v159, v12 offset:1792
    s_waitcnt lgkmcnt(0)
    v_add_f32 v152, v152, v156
    v_add_f32 v153, v153, v157
    v_add_f32 v154, v154, v158
    v_add_f32 v155, v155, v159
    v_add_f32 v152, v152, v154
    v_add_f32 v153, v153, v155
    v_add_f32 v152, v152, v153
    s_mul_i32 s97, s94, 2560
    s_lshl_b32 s98, s95, 8
    s_add_u32 s97, s97, s98
    s_add_u32 s97, s97, 327680
    v_add_u32 v12, s97, v12
    global_store_dword v12, v152, s[42:43] sc1
L_nw0_67:
    s_branch L_done
L_ffn:
    s_cmp_ge_u32 s3, 5
    s_cbranch_scc1 L_sk_68
    v_lshlrev_b32 v3, 4, v0
    v_add_u32 v5, 106496, v3
    ds_read_b128 v[104:107], v5 offset:0
    ds_read_b128 v[108:111], v5 offset:5120
    ds_read_b128 v[112:115], v5 offset:10240
    ds_read_b128 v[116:119], v5 offset:15360
    ds_read_b128 v[120:123], v5 offset:20480
    ds_read_b128 v[124:127], v5 offset:25600
    ds_read_b128 v[128:131], v5 offset:30720
    ds_read_b128 v[132:135], v5 offset:35840
L_sk_68:
    s_mov_b32 s63, 0
L_spin_69:
    s_waitcnt vmcnt(0)
    v_max_u32 v6, v192, v193
    v_max3_u32 v6, v6, v194, v195
    v_max3_u32 v6, v6, v196, v197
    v_max3_u32 v6, v6, v198, v199
    v_max3_u32 v6, v6, v200, v201
    v_max3_u32 v6, v6, v202, v203
    v_cmp_eq_u32 vcc, -1, v6
    s_nop 1
    s_cbranch_vccz L_mok_70
    s_add_u32 s63, s63, 1
    s_cmp_ge_u32 s63, 65536
    s_cbranch_scc1 L_mok_70
    v_lshrrev_b32 v3, 1, v0
    v_min_u32 v3, 159, v3
    v_lshlrev_b32 v4, 4, v3
    s_add_u32 s10, s42, 5120
    s_addc_u32 s11, s43, 0
    global_load_dwordx4 v[200:203], v4, s[10:11] sc1
    global_load_dwordx4 v[192:195], v4, s[10:11] offset:2560 sc1
    s_add_u32 s10, s42, 10240
    s_addc_u32 s11, s43, 0
    global_load_dwordx4 v[196:199], v4, s[10:11] sc1
    v_lshlrev_b32 v4, 3, v3
    global_load_dwordx2 v[204:205], v4, s[16:17]
    s_min_u32 s97, s93, 9
    s_lshl_b32 s97, s97, 8
    v_lshl_add_u32 v4, v1, 2, s97
    global_load_dword v206, v4, s[10:11] offset:2560 sc1
    s_add_u32 s10, s42, 5120
    s_addc_u32 s11, s43, 0
    global_load_dword v207, v4, s[10:11] sc1
    v_lshrrev_b32 v4, 1, v4
    global_load_ushort v191, v4, s[16:17]
    s_branch L_spin_69
L_mok_70:
    v_lshrrev_b32 v3, 1, v0
    v_min_u32 v3, 159, v3
    v_lshlrev_b32 v3, 4, v3
    v_and_b32 v4, 1, v0
    v_mul_u32_u24 v4, 20480, v4
    v_add_u32 v3, v3, v4
    v_add_u32 v3, 327680, v3
    v_add_u32 v4, 5120, v3
    v_add_u32 v5, 10240, v3
    v_add_u32 v6, 15360, v3
    s_mov_b32 s63, 0
L_spin_71:
    global_load_dwordx4 v[152:155], v3, s[42:43] offset:0 sc1
    global_load_dwordx4 v[156:159], v3, s[42:43] offset:2560 sc1
    global_load_dwordx4 v[160:163], v4, s[42:43] offset:0 sc1
    global_load_dwordx4 v[164:167], v4, s[42:43] offset:2560 sc1
    global_load_dwordx4 v[168:171], v5, s[42:43] offset:0 sc1
    global_load_dwordx4 v[172:175], v5, s[42:43] offset:2560 sc1
    global_load_dwordx4 v[176:179], v6, s[42:43] offset:0 sc1
    global_load_dwordx4 v[180:183], v6, s[42:43] offset:2560 sc1
    s_waitcnt vmcnt(0)
    v_max_u32 v8, v152, v153
    v_max3_u32 v8, v8, v154, v155
    v_max3_u32 v8, v8, v156, v157
    v_max3_u32 v8, v8, v158, v159
    v_max3_u32 v8, v8, v160, v161
    v_max3_u32 v8, v8, v162, v163
    v_max3_u32 v8, v8, v164, v165
    v_max3_u32 v8, v8, v166, v167
    v_max3_u32 v8, v8, v168, v169
    v_max3_u32 v8, v8, v170, v171
    v_max3_u32 v8, v8, v172, v173
    v_max3_u32 v8, v8, v174, v175
    v_max3_u32 v8, v8, v176, v177
    v_max3_u32 v8, v8, v178, v179
    v_max3_u32 v8, v8, v180, v181
    v_max3_u32 v8, v8, v182, v183
    v_cmp_eq_u32 vcc, -1, v8
    s_nop 1
    s_cbranch_vccz L_spun_72
    s_add_u32 s63, s63, 1
    s_cmp_ge_u32 s63, 65536
    s_cbranch_scc1 L_spun_72
    s_sleep 4
    s_branch L_spin_71
L_spun_72:
    v_add_f32 v152, v152, v168
    v_add_f32 v153, v153, v169
    v_add_f32 v154, v154, v170
    v_add_f32 v155, v155, v171
    v_add_f32 v156, v156, v172
    v_add_f32 v157, v157, v173
    v_add_f32 v158, v158, v174
    v_add_f32 v159, v159, v175
    v_add_f32 v160, v160, v176
    v_add_f32 v161, v161, v177
    v_add_f32 v162, v162, v178
    v_add_f32 v163, v163, v179
    v_add_f32 v164, v164, v180
    v_add_f32 v165, v165, v181
    v_add_f32 v166, v166, v182
    v_add_f32 v167, v167, v183
    v_add_f32 v152, v152, v160
    v_add_f32 v153, v153, v161
    v_add_f32 v154, v154, v162
    v_add_f32 v155, v155, v163
    v_add_f32 v156, v156, v164
    v_add_f32 v157, v157, v165
    v_add_f32 v158, v158, v166
    v_add_f32 v159, v159, v167
    v_add_f32 v152, v152, v156
    v_add_f32 v153, v153, v157
    v_add_f32 v154, v154, v158
    v_add_f32 v155, v155, v159
    v_add_f32_dpp v152, v152, v152 quad_perm:[1,0,3,2] row_mask:0xf bank_mask:0xf
    v_add_f32_dpp v153, v153, v153 quad_perm:[1,0,3,2] row_mask:0xf bank_mask:0xf
    v_add_f32_dpp v154, v154, v154 quad_perm:[1,0,3,2] row_mask:0xf bank_mask:0xf
    v_add_f32_dpp v155, v155, v155 quad_perm:[1,0,3,2] row_mask:0xf bank_mask:0xf
    v_lshlrev_b32 v156, 16, v204
    v_and_b32 v157, 0xffff0000, v204
    v_lshlrev_b32 v158, 16, v205
    v_and_b32 v159, 0xffff0000, v205
    v_cvt_pk_bf16_f32 v152, v152, v152
    v_and_b32 v152, 0xffff0000, v152
    v_mul_f32 v152, v152, v200
    v_cvt_pk_bf16_f32 v152, v152, v152
    v_and_b32 v152, 0xffff0000, v152
    v_add_f32 v152, v152, v156
    v_cvt_pk_bf16_f32 v152, v152, v152
    v_and_b32 v152, 0xffff0000, v152
    v_cvt_pk_bf16_f32 v153, v153, v153
    v_and_b32 v153, 0xffff0000, v153
    v_mul_f32 v153, v153, v201
    v_cvt_pk_bf16_f32 v153, v153, v153
    v_and_b32 v153, 0xffff0000, v153
    v_add_f32 v153, v153, v157
    v_cvt_pk_bf16_f32 v153, v153, v153
    v_and_b32 v153, 0xffff0000, v153
    v_cvt_pk_bf16_f32 v154, v154, v154
    v_and_b32 v154, 0xffff0000, v154
    v_mul_f32 v154, v154, v202
    v_cvt_pk_bf16_f32 v154, v154, v154
    v_and_b32 v154, 0xffff0000, v154
    v_add_f32 v154, v154, v158
    v_cvt_pk_bf16_f32 v154, v154, v154
    v_and_b32 v154, 0xffff0000, v154
    v_cvt_pk_bf16_f32 v155, v155, v155
    v_and_b32 v155, 0xffff0000, v155
    v_mul_f32 v155, v155, v203
    v_cvt_pk_bf16_f32 v155, v155, v155
    v_and_b32 v155, 0xffff0000, v155
    v_add_f32 v155, v155, v159
    v_cvt_pk_bf16_f32 v155, v155, v155
    v_and_b32 v155, 0xffff0000, v155
    v_add_f32 v160, v152, v153
    v_add_f32 v161, v154, v155
    v_add_f32 v160, v160, v161
    v_mul_f32 v161, v152, v152
    v_fmac_f32 v161, v153, v153
    v_fmac_f32 v161, v154, v154
    v_fmac_f32 v161, v155, v155
    v_and_b32 v4, 1, v0
    v_cmp_eq_u32 vcc, 0, v4
    v_mov_b32 v5, 320
    v_cmp_gt_u32 s[6:7], v5, v0
    s_and_b64 s[12:13], vcc, s[6:7]
    v_mov_b32 v4, 0
    s_nop 0
    v_cndmask_b32 v160, v4, v160, s[12:13]
    v_cndmask_b32 v161, v4, v161, s[12:13]
    s_nop 1
    v_add_f32_dpp v160, v160, v160 quad_perm:[1,0,3,2] row_mask:0xf bank_mask:0xf
    s_nop 1
    v_add_f32_dpp v160, v160, v160 quad_perm:[2,3,0,1] row_mask:0xf bank_mask:0xf
    s_nop 1
    v_add_f32_dpp v160, v160, v160 row_half_mirror row_mask:0xf bank_mask:0xf
    s_nop 1
    v_add_f32_dpp v160, v160, v160 row_mirror row_mask:0xf bank_mask:0xf
    v_mov_b32 v162, v160
    s_nop 1
    v_permlane16_swap_b32 v160, v162
    s_nop 1
    v_add_f32 v160, v160, v162
    v_mov_b32 v162, v160
    s_nop 1
    v_permlane32_swap_b32 v160, v162
    s_nop 1
    v_add_f32 v160, v160, v162
    s_nop 1
    v_add_f32_dpp v161, v161, v161 quad_perm:[1,0,3,2] row_mask:0xf bank_mask:0xf
    s_nop 1
    v_add_f32_dpp v161, v161, v161 quad_perm:[2,3,0,1] row_mask:0xf bank_mask:0xf
    s_nop 1
    v_add_f32_dpp v161, v161, v161 row_half_mirror row_mask:0xf bank_mask:0xf
    s_nop 1
    v_add_f32_dpp v161, v161, v161 row_mirror row_mask:0xf bank_mask:0xf
    v_mov_b32 v162, v161
    s_nop 1
    v_permlane16_swap_b32 v161, v162
    s_nop 1
    v_add_f32 v161, v161, v162
    v_mov_b32 v162, v161
    s_nop 1
    v_permlane32_swap_b32 v161, v162
    s_nop 1
    v_add_f32 v161, v161, v162
    s_lshl_b32 s97, s3, 3
    v_mov_b32 v3, s97
    v_cmp_eq_u32 vcc, 0, v1
    s_and_saveexec_b64 s[4:5], vcc
    s_cbranch_execz L_m_73
    ds_write_b64 v3, v[160:161] offset:17920
L_m_73:
    s_mov_b64 exec, s[4:5]
    s_waitcnt lgkmcnt(0)
    s_barrier
    v_mov_b32 v3, 0
    ds_read_b128 v[160:163], v3 offset:17920
    ds_read_b128 v[164:167], v3 offset:17936
    ds_read_b128 v[168:171], v3 offset:17952
    ds_read_b128 v[172:175], v3 offset:17968
    s_waitcnt lgkmcnt(0)
    v_add_f32 v160, v160, v162
    v_add_f32 v161, v161, v163
    v_add_f32 v160, v160, v164
    v_add_f32 v161, v161, v165
    v_add_f32 v160, v160, v166
    v_add_f32 v161, v161, v167
    v_add_f32 v160, v160, v168
    v_add_f32 v161, v161, v169
    v_add_f32 v160, v160, v170
    v_add_f32 v161, v161, v171
    v_add_f32 v160, v160, v172
    v_add_f32 v161, v161, v173
    v_add_f32 v160, v160, v174
    v_add_f32 v161, v161, v175
    v_mul_f32 v160, 0x3acccccd, v160
    v_mul_f32 v161, 0x3acccccd, v161
    v_fma_f32 v161, -v160, v160, v161
    v_cvt_pk_bf16_f32 v160, v160, v160
    v_and_b32 v160, 0xffff0000, v160
    v_cvt_pk_bf16_f32 v161, v161, v161
    v_and_b32 v161, 0xffff0000, v161
    v_add_f32 v161, 0x3727c5ac, v161
    v_cvt_pk_bf16_f32 v161, v161, v161
    v_and_b32 v161, 0xffff0000, v161
    v_sqrt_f32 v162, v161
    s_nop 0
    v_rcp_f32 v163, v162
    v_fma_f32 v164, -v162, v162, v161
    v_mul_f32 v163, 0.5, v163
    v_fma_f32 v161, v164, v163, v162
    v_cvt_pk_bf16_f32 v161, v161, v161
    v_and_b32 v161, 0xffff0000, v161
    v_sub_f32 v152, v152, v160
    v_cvt_pk_bf16_f32 v152, v152, v152
    v_and_b32 v152, 0xffff0000, v152
    v_rcp_f32 v163, v161
    s_nop 0
    v_mul_f32 v164, v152, v163
    v_fma_f32 v162, -v164, v161, v152
    v_fma_f32 v162, v162, v163, v164
    v_cvt_pk_bf16_f32 v152, v162, v162
    v_and_b32 v152, 0xffff0000, v152
    v_add_f32 v162, 1.0, v196
    v_cvt_pk_bf16_f32 v162, v162, v162
    v_and_b32 v162, 0xffff0000, v162
    v_mul_f32 v152, v152, v162
    v_cvt_pk_bf16_f32 v152, v152, v152
    v_and_b32 v152, 0xffff0000, v152
    v_add_f32 v152, v152, v192
    v_cvt_pk_bf16_f32 v152, v152, v152
    v_and_b32 v152, 0xffff0000, v152
    v_sub_f32 v153, v153, v160
    v_cvt_pk_bf16_f32 v153, v153, v153
    v_and_b32 v153, 0xffff0000, v153
    v_rcp_f32 v163, v161
    s_nop 0
    v_mul_f32 v164, v153, v163
    v_fma_f32 v162, -v164, v161, v153
    v_fma_f32 v162, v162, v163, v164
    v_cvt_pk_bf16_f32 v153, v162, v162
    v_and_b32 v153, 0xffff0000, v153
    v_add_f32 v162, 1.0, v197
    v_cvt_pk_bf16_f32 v162, v162, v162
    v_and_b32 v162, 0xffff0000, v162
    v_mul_f32 v153, v153, v162
    v_cvt_pk_bf16_f32 v153, v153, v153
    v_and_b32 v153, 0xffff0000, v153
    v_add_f32 v153, v153, v193
    v_cvt_pk_bf16_f32 v153, v153, v153
    v_and_b32 v153, 0xffff0000, v153
    v_sub_f32 v154, v154, v160
    v_cvt_pk_bf16_f32 v154, v154, v154
    v_and_b32 v154, 0xffff0000, v154
    v_rcp_f32 v163, v161
    s_nop 0
    v_mul_f32 v164, v154, v163
    v_fma_f32 v162, -v164, v161, v154
    v_fma_f32 v162, v162, v163, v164
    v_cvt_pk_bf16_f32 v154, v162, v162
    v_and_b32 v154, 0xffff0000, v154
    v_add_f32 v162, 1.0, v198
    v_cvt_pk_bf16_f32 v162, v162, v162
    v_and_b32 v162, 0xffff0000, v162
    v_mul_f32 v154, v154, v162
    v_cvt_pk_bf16_f32 v154, v154, v154
    v_and_b32 v154, 0xffff0000, v154
    v_add_f32 v154, v154, v194
    v_cvt_pk_bf16_f32 v154, v154, v154
    v_and_b32 v154, 0xffff0000, v154
    v_sub_f32 v155, v155, v160
    v_cvt_pk_bf16_f32 v155, v155, v155
    v_and_b32 v155, 0xffff0000, v155
    v_rcp_f32 v163, v161
    s_nop 0
    v_mul_f32 v164, v155, v163
    v_fma_f32 v162, -v164, v161, v155
    v_fma_f32 v162, v162, v163, v164
    v_cvt_pk_bf16_f32 v155, v162, v162
    v_and_b32 v155, 0xffff0000, v155
    v_add_f32 v162, 1.0, v199
    v_cvt_pk_bf16_f32 v162, v162, v162
    v_and_b32 v162, 0xffff0000, v162
    v_mul_f32 v155, v155, v162
    v_cvt_pk_bf16_f32 v155, v155, v155
    v_and_b32 v155, 0xffff0000, v155
    v_add_f32 v155, v155, v195
    v_cvt_pk_bf16_f32 v155, v155, v155
    v_and_b32 v155, 0xffff0000, v155
    v_cvt_pk_bf16_f32 v156, v152, v153
    v_cvt_pk_bf16_f32 v157, v154, v155
    v_lshrrev_b32 v3, 1, v0
    v_lshlrev_b32 v3, 3, v3
    s_mov_b64 vcc, s[12:13]
    s_and_saveexec_b64 s[4:5], vcc
    s_cbranch_execz L_m_74
    ds_write_b64 v3, v[156:157] offset:18048
L_m_74:
    s_mov_b64 exec, s[4:5]
    s_waitcnt lgkmcnt(0)
    s_barrier
    v_lshrrev_b32 v3, 2, v0
    v_and_b32 v3, 63, v3
    v_lshlrev_b32 v3, 1, v3
    ds_read_u16 v152, v3 offset:18048
    ds_read_u16 v153, v3 offset:18176
    ds_read_u16 v154, v3 offset:18304
    ds_read_u16 v155, v3 offset:18432
    ds_read_u16 v156, v3 offset:18560
    ds_read_u16 v157, v3 offset:18688
    ds_read_u16 v158, v3 offset:18816
    ds_read_u16 v159, v3 offset:18944
    ds_read_u16 v160, v3 offset:19072
    ds_read_u16 v161, v3 offset:19200
    v_mov_b32 v4, 0
    v_mov_b32 v5, 0
    v_mov_b32 v6, 0
    v_mov_b32 v7, 0
    v_mov_b32 v8, 0
    v_mov_b32 v9, 0
    v_mov_b32 v10, 0
    v_mov_b32 v11, 0
    s_waitcnt lgkmcnt(0)
    v_lshlrev_b32 v162, 16, v152
    v_dot2c_f32_bf16 v4, v64, v152
    v_dot2c_f32_bf16 v5, v64, v162
    v_dot2c_f32_bf16 v6, v65, v152
    v_dot2c_f32_bf16 v7, v65, v162
    v_dot2c_f32_bf16 v8, v66, v152
    v_dot2c_f32_bf16 v9, v66, v162
    v_dot2c_f32_bf16 v10, v67, v152
    v_dot2c_f32_bf16 v11, v67, v162
    v_lshlrev_b32 v162, 16, v153
    v_dot2c_f32_bf16 v4, v68, v153
    v_dot2c_f32_bf16 v5, v68, v162
    v_dot2c_f32_bf16 v6, v69, v153
    v_dot2c_f32_bf16 v7, v69, v162
    v_dot2c_f32_bf16 v8, v70, v153
    v_dot2c_f32_bf16 v9, v70, v162
    v_dot2c_f32_bf16 v10, v71, v153
    v_dot2c_f32_bf16 v11, v71, v162
    v_lshlrev_b32 v162, 16, v154
    v_dot2c_f32_bf16 v4, v72, v154
    v_dot2c_f32_bf16 v5, v72, v162
    v_dot2c_f32_bf16 v6, v73, v154
    v_dot2c_f32_bf16 v7, v73, v162
    v_dot2c_f32_bf16 v8, v74, v154
    v_dot2c_f32_bf16 v9, v74, v162
    v_dot2c_f32_bf16 v10, v75, v154
    v_dot2c_f32_bf16 v11, v75, v162
    v_lshlrev_b32 v162, 16, v155
    v_dot2c_f32_bf16 v4, v76, v155
    v_dot2c_f32_bf16 v5, v76, v162
    v_dot2c_f32_bf16 v6, v77, v155
    v_dot2c_f32_bf16 v7, v77, v162
    v_dot2c_f32_bf16 v8, v78, v155
    v_dot2c_f32_bf16 v9, v78, v162
    v_dot2c_f32_bf16 v10, v79, v155
    v_dot2c_f32_bf16 v11, v79, v162
    v_lshlrev_b32 v162, 16, v156
    v_dot2c_f32_bf16 v4, v80, v156
    v_dot2c_f32_bf16 v5, v80, v162
    v_dot2c_f32_bf16 v6, v81, v156
    v_dot2c_f32_bf16 v7, v81, v162
    v_dot2c_f32_bf16 v8, v82, v156
    v_dot2c_f32_bf16 v9, v82, v162
    v_dot2c_f32_bf16 v10, v83, v156
    v_dot2c_f32_bf16 v11, v83, v162
    v_lshlrev_b32 v162, 16, v157
    v_dot2c_f32_bf16 v4, v84, v157
    v_dot2c_f32_bf16 v5, v84, v162
    v_dot2c_f32_bf16 v6, v85, v157
    v_dot2c_f32_bf16 v7, v85, v162
    v_dot2c_f32_bf16 v8, v86, v157
    v_dot2c_f32_bf16 v9, v86, v162
    v_dot2c_f32_bf16 v10, v87, v157
    v_dot2c_f32_bf16 v11, v87, v162
    v_lshlrev_b32 v162, 16, v158
    v_dot2c_f32_bf16 v4, v88, v158
    v_dot2c_f32_bf16 v5, v88, v162
    v_dot2c_f32_bf16 v6, v89, v158
    v_dot2c_f32_bf16 v7, v89, v162
    v_dot2c_f32_bf16 v8, v90, v158
    v_dot2c_f32_bf16 v9, v90, v162
    v_dot2c_f32_bf16 v10, v91, v158
    v_dot2c_f32_bf16 v11, v91, v162
    v_lshlrev_b32 v162, 16, v159
    v_dot2c_f32_bf16 v4, v92, v159
    v_dot2c_f32_bf16 v5, v92, v162
    v_dot2c_f32_bf16 v6, v93, v159
    v_dot2c_f32_bf16 v7, v93, v162
    v_dot2c_f32_bf16 v8, v94, v159
    v_dot2c_f32_bf16 v9, v94, v162
    v_dot2c_f32_bf16 v10, v95, v159
    v_dot2c_f32_bf16 v11, v95, v162
    v_lshlrev_b32 v162, 16, v160
    v_dot2c_f32_bf16 v4, v96, v160
    v_dot2c_f32_bf16 v5, v96, v162
    v_dot2c_f32_bf16 v6, v97, v160
    v_dot2c_f32_bf16 v7, v97, v162
    v_dot2c_f32_bf16 v8, v98, v160
    v_dot2c_f32_bf16 v9, v98, v162
    v_dot2c_f32_bf16 v10, v99, v160
    v_dot2c_f32_bf16 v11, v99, v162
    v_lshlrev_b32 v162, 16, v161
    v_dot2c_f32_bf16 v4, v100, v161
    v_dot2c_f32_bf16 v5, v100, v162
    v_dot2c_f32_bf16 v6, v101, v161
    v_dot2c_f32_bf16 v7, v101, v162
    v_dot2c_f32_bf16 v8, v102, v161
    v_dot2c_f32_bf16 v9, v102, v162
    v_dot2c_f32_bf16 v10, v103, v161
    v_dot2c_f32_bf16 v11, v103, v162
    v_add_f32_dpp v4, v4, v4 row_ror:4 row_mask:0xf bank_mask:0xf
    v_add_f32_dpp v5, v5, v5 row_ror:4 row_mask:0xf bank_mask:0xf
    v_add_f32_dpp v6, v6, v6 row_ror:4 row_mask:0xf bank_mask:0xf
    v_add_f32_dpp v7, v7, v7 row_ror:4 row_mask:0xf bank_mask:0xf
    v_add_f32_dpp v8, v8, v8 row_ror:4 row_mask:0xf bank_mask:0xf
    v_add_f32_dpp v9, v9, v9 row_ror:4 row_mask:0xf bank_mask:0xf
    v_add_f32_dpp v10, v10, v10 row_ror:4 row_mask:0xf bank_mask:0xf
    v_add_f32_dpp v11, v11, v11 row_ror:4 row_mask:0xf bank_mask:0xf
    v_add_f32_dpp v4, v4, v4 row_ror:8 row_mask:0xf bank_mask:0xf
    v_add_f32_dpp v5, v5, v5 row_ror:8 row_mask:0xf bank_mask:0xf
    v_add_f32_dpp v6, v6, v6 row_ror:8 row_mask:0xf bank_mask:0xf
    v_add_f32_dpp v7, v7, v7 row_ror:8 row_mask:0xf bank_mask:0xf
    v_add_f32_dpp v8, v8, v8 row_ror:8 row_mask:0xf bank_mask:0xf
    v_add_f32_dpp v9, v9, v9 row_ror:8 row_mask:0xf bank_mask:0xf
    v_add_f32_dpp v10, v10, v10 row_ror:8 row_mask:0xf bank_mask:0xf
    v_add_f32_dpp v11, v11, v11 row_ror:8 row_mask:0xf bank_mask:0xf
    s_nop 2
    v_permlane32_swap_b32 v4, v8
    v_permlane32_swap_b32 v5, v9
    v_permlane32_swap_b32 v6, v10
    v_permlane32_swap_b32 v7, v11
    s_nop 1
    v_add_f32 v4, v4, v8
    v_add_f32 v5, v5, v9
    v_add_f32 v6, v6, v10
    v_add_f32 v7, v7, v11
    s_nop 2
    v_permlane16_swap_b32 v4, v6
    v_permlane16_swap_b32 v5, v7
    s_nop 1
    v_add_f32 v4, v4, v6
    v_add_f32 v5, v5, v7
    v_lshrrev_b32 v12, 4, v1
    v_lshlrev_b32 v12, 3, v12
    v_and_b32 v13, 3, v1
    v_lshl_add_u32 v12, v13, 5, v12
    s_lshl_b32 s97, s3, 7
    v_add_u32 v12, s97, v12
    v_and_b32 v13, 15, v1
    v_cmp_gt_u32 vcc, 4, v13
    s_and_saveexec_b64 s[4:5], vcc
    s_cbranch_execz L_m_75
    ds_write_b64 v12, v[4:5] offset:19456
L_m_75:
    s_mov_b64 exec, s[4:5]
    s_waitcnt lgkmcnt(0)
    s_barrier
    s_cmp_lg_u32 s3, 0
    s_cbranch_scc1 L_nw0_76
    v_and_b32 v3, 31, v1
    v_lshlrev_b32 v3, 2, v3
    ds_read_b32 v152, v3 offset:19456
    ds_read_b32 v153, v3 offset:19584
    ds_read_b32 v154, v3 offset:19712
    ds_read_b32 v155, v3 offset:19840
    ds_read_b32 v156, v3 offset:19968
    ds_read_b32 v157, v3 offset:20096
    ds_read_b32 v158, v3 offset:20224
    ds_read_b32 v159, v3 offset:20352
    s_waitcnt lgkmcnt(0)
    v_add_f32 v152, v152, v153
    v_add_f32 v154, v154, v155
    v_add_f32 v152, v152, v154
    v_add_f32 v156, v156, v157
    v_add_f32 v158, v158, v159
    v_add_f32 v156, v156, v158
    v_cvt_pk_bf16_f32 v152, v152, v152
    v_and_b32 v152, 0xffff0000, v152
    v_cvt_pk_bf16_f32 v156, v156, v156
    v_and_b32 v156, 0xffff0000, v156
    v_sub_f32 v163, 0, v152
    v_min_f32 v163, 0x42b00000, v163
    v_max_f32 v163, 0xc2b00000, v163
    v_mul_f32 v161, 0x3fb8aa3b, v163
    v_exp_f32 v162, v161
    s_mov_b32 s97, 0x3fb8aa3b
    v_fma_f32 v161, v163, s97, -v161
    s_mov_b32 s97, 0x32a57060
    v_fma_f32 v161, v163, s97, v161
    v_mul_f32 v161, 0x3f317218, v161
    v_fma_f32 v162, v162, v161, v162
    v_add_f32 v162, 1.0, v162
    v_rcp_f32 v161, v162
    s_nop 0
    v_mul_f32 v163, v152, v161
    v_fma_f32 v160, -v163, v162, v152
    v_fma_f32 v160, v160, v161, v163
    v_cvt_pk_bf16_f32 v160, v160, v160
    v_and_b32 v160, 0xffff0000, v160
    v_mul_f32 v160, v160, v156
    v_cvt_pk_bf16_f32 v160, v160, v160
    v_lshrrev_b32 v3, 1, v3
    v_cmp_gt_u32 vcc, 32, v1
    s_and_saveexec_b64 s[4:5], vcc
    s_cbranch_execz L_m_77
    ds_write_b16 v3, v160 offset:20480
L_m_77:
    s_mov_b64 exec, s[4:5]
    s_waitcnt lgkmcnt(0)
L_nw0_76:
    s_barrier
    s_cmp_ge_u32 s3, 5
    s_cbranch_scc1 L_sk_78
    v_mul_u32_u24 v3, 205, v0
    v_lshrrev_b32 v3, 14, v3
    v_lshlrev_b32 v4, 1, v3
    ds_read_u16 v152, v4 offset:20480
    ds_read_u16 v153, v4 offset:20488
    ds_read_u16 v154, v4 offset:20496
    ds_read_u16 v155, v4 offset:20504
    ds_read_u16 v156, v4 offset:20512
    ds_read_u16 v157, v4 offset:20520
    ds_read_u16 v158, v4 offset:20528
    ds_read_u16 v159, v4 offset:20536
    v_mov_b32 v4, 0
    v_mov_b32 v5, 0
    v_mov_b32 v6, 0
    v_mov_b32 v7, 0
    v_mov_b32 v8, 0
    v_mov_b32 v9, 0
    v_mov_b32 v10, 0
    v_mov_b32 v11, 0
    s_waitcnt lgkmcnt(0)
    v_lshlrev_b32 v162, 16, v152
    v_dot2c_f32_bf16 v4, v104, v152
    v_dot2c_f32_bf16 v5, v104, v162
    v_dot2c_f32_bf16 v6, v105, v152
    v_dot2c_f32_bf16 v7, v105, v162
    v_dot2c_f32_bf16 v8, v106, v152
    v_dot2c_f32_bf16 v9, v106, v162
    v_dot2c_f32_bf16 v10, v107, v152
    v_dot2c_f32_bf16 v11, v107, v162
    v_lshlrev_b32 v162, 16, v153
    v_dot2c_f32_bf16 v4, v108, v153
    v_dot2c_f32_bf16 v5, v108, v162
    v_dot2c_f32_bf16 v6, v109, v153
    v_dot2c_f32_bf16 v7, v109, v162
    v_dot2c_f32_bf16 v8, v110, v153
    v_dot2c_f32_bf16 v9, v110, v162
    v_dot2c_f32_bf16 v10, v111, v153
    v_dot2c_f32_bf16 v11, v111, v162
    v_lshlrev_b32 v162, 16, v154
    v_dot2c_f32_bf16 v4, v112, v154
    v_dot2c_f32_bf16 v5, v112, v162
    v_dot2c_f32_bf16 v6, v113, v154
    v_dot2c_f32_bf16 v7, v113, v162
    v_dot2c_f32_bf16 v8, v114, v154
    v_dot2c_f32_bf16 v9, v114, v162
    v_dot2c_f32_bf16 v10, v115, v154
    v_dot2c_f32_bf16 v11, v115, v162
    v_lshlrev_b32 v162, 16, v155
    v_dot2c_f32_bf16 v4, v116, v155
    v_dot2c_f32_bf16 v5, v116, v162
    v_dot2c_f32_bf16 v6, v117, v155
    v_dot2c_f32_bf16 v7, v117, v162
    v_dot2c_f32_bf16 v8, v118, v155
    v_dot2c_f32_bf16 v9, v118, v162
    v_dot2c_f32_bf16 v10, v119, v155
    v_dot2c_f32_bf16 v11, v119, v162
    v_lshlrev_b32 v162, 16, v156
    v_dot2c_f32_bf16 v4, v120, v156
    v_dot2c_f32_bf16 v5, v120, v162
    v_dot2c_f32_bf16 v6, v121, v156
    v_dot2c_f32_bf16 v7, v121, v162
    v_dot2c_f32_bf16 v8, v122, v156
    v_dot2c_f32_bf16 v9, v122, v162
    v_dot2c_f32_bf16 v10, v123, v156
    v_dot2c_f32_bf16 v11, v123, v162
    v_lshlrev_b32 v162, 16, v157
    v_dot2c_f32_bf16 v4, v124, v157
    v_dot2c_f32_bf16 v5, v124, v162
    v_dot2c_f32_bf16 v6, v125, v157
    v_dot2c_f32_bf16 v7, v125, v162
    v_dot2c_f32_bf16 v8, v126, v157
    v_dot2c_f32_bf16 v9, v126, v162
    v_dot2c_f32_bf16 v10, v127, v157
    v_dot2c_f32_bf16 v11, v127, v162
    v_lshlrev_b32 v162, 16, v158
    v_dot2c_f32_bf16 v4, v128, v158
    v_dot2c_f32_bf16 v5, v128, v162
    v_dot2c_f32_bf16 v6, v129, v158
    v_dot2c_f32_bf16 v7, v129, v162
    v_dot2c_f32_bf16 v8, v130, v158
    v_dot2c_f32_bf16 v9, v130, v162
    v_dot2c_f32_bf16 v10, v131, v158
    v_dot2c_f32_bf16 v11, v131, v162
    v_lshlrev_b32 v162, 16, v159
    v_dot2c_f32_bf16 v4, v132, v159
    v_dot2c_f32_bf16 v5, v132, v162
    v_dot2c_f32_bf16 v6, v133, v159
    v_dot2c_f32_bf16 v7, v133, v162
    v_dot2c_f32_bf16 v8, v134, v159
    v_dot2c_f32_bf16 v9, v134, v162
    v_dot2c_f32_bf16 v10, v135, v159
    v_dot2c_f32_bf16 v11, v135, v162
    v_lshlrev_b32 v12, 5, v0
    s_nop 2
    ds_write_b128 v12, v[4:7] offset:4096
    ds_write_b128 v12, v[8:11] offset:4112
    s_waitcnt lgkmcnt(0)
L_sk_78:
    s_barrier
    s_cmp_ge_u32 s3, 3
    s_cbranch_scc1 L_sk_79
    v_min_u32 v3, 159, v0
    v_lshlrev_b32 v3, 4, v3
    ds_read_b128 v[152:155], v3 offset:4096
    ds_read_b128 v[156:159], v3 offset:6656
    ds_read_b128 v[160:163], v3 offset:9216
    ds_read_b128 v[164:167], v3 offset:11776
    s_waitcnt lgkmcnt(0)
    v_add_f32 v152, v152, v160
    v_add_f32 v153, v153, v161
    v_add_f32 v154, v154, v162
    v_add_f32 v155, v155, v163
    v_add_f32 v156, v156, v164
    v_add_f32 v157, v157, v165
    v_add_f32 v158, v158, v166
    v_add_f32 v159, v159, v167
    v_add_f32 v152, v152, v156
    v_add_f32 v153, v153, v157
    v_add_f32 v154, v154, v158
    v_add_f32 v155, v155, v159
    s_mul_i32 s97, s93, 2560
    s_add_u32 s97, s97, 720896
    v_add_u32 v3, s97, v3
    v_mov_b32 v5, 160
    v_cmp_gt_u32 vcc, v5, v0
    s_and_saveexec_b64 s[4:5], vcc
    s_cbranch_execz L_m_80
    global_store_dwordx4 v3, v[152:155], s[42:43] sc1
L_m_80:
    s_mov_b64 exec, s[4:5]
L_sk_79:
    s_branch L_done
L_fin:
    s_mov_b32 s63, 0
L_spin_81:
    s_waitcnt vmcnt(0)
    v_max_u32 v6, v206, v207
    v_cmp_eq_u32 vcc, -1, v6
    s_nop 1
    s_cbranch_vccz L_mok_82
    s_add_u32 s63, s63, 1
    s_cmp_ge_u32 s63, 65536
    s_cbranch_scc1 L_mok_82
    v_lshrrev_b32 v3, 1, v0
    v_min_u32 v3, 159, v3
    v_lshlrev_b32 v4, 4, v3
    s_add_u32 s10, s42, 5120
    s_addc_u32 s11, s43, 0
    global_load_dwordx4 v[200:203], v4, s[10:11] sc1
    global_load_dwordx4 v[192:195], v4, s[10:11] offset:2560 sc1
    s_add_u32 s10, s42, 10240
    s_addc_u32 s11, s43, 0
    global_load_dwordx4 v[196:199], v4, s[10:11] sc1
    v_lshlrev_b32 v4, 3, v3
    global_load_dwordx2 v[204:205], v4, s[16:17]
    s_min_u32 s97, s93, 9
    s_lshl_b32 s97, s97, 8
    v_lshl_add_u32 v4, v1, 2, s97
    global_load_dword v206, v4, s[10:11] offset:2560 sc1
    s_add_u32 s10, s42, 5120
    s_addc_u32 s11, s43, 0
    global_load_dword v207, v4, s[10:11] sc1
    v_lshrrev_b32 v4, 1, v4
    global_load_ushort v191, v4, s[16:17]
    s_branch L_spin_81
L_mok_82:
    v_lshlrev_b32 v165, 16, v191
    v_and_b32 v3, 255, v0
    v_lshrrev_b32 v4, 4, v3
    v_mul_u32_u24 v4, 2560, v4
    v_and_b32 v3, 15, v3
    v_lshl_add_u32 v3, v3, 4, v4
    s_lshl_b32 s97, s93, 8
    s_add_u32 s97, s97, 327680
    v_add_u32 v3, s97, v3
    s_mov_b32 s63, 0
L_spin_83:
    global_load_dwordx4 v[152:155], v3, s[42:43] sc1
    s_waitcnt vmcnt(0)
    v_max_u32 v6, v152, v153
    v_max3_u32 v6, v6, v154, v155
    v_cmp_eq_u32 vcc, -1, v6
    s_nop 1
    s_cbranch_vccz L_spun_84
    s_add_u32 s63, s63, 1
    s_cmp_ge_u32 s63, 65536
    s_cbranch_scc1 L_spun_84
    s_sleep 2
    s_branch L_spin_83
L_spun_84:
    v_mov_b32 v156, v152
    v_mov_b32 v157, v153
    v_mov_b32 v158, v154
    v_mov_b32 v159, v155
    s_nop 1
    v_permlane16_swap_b32 v152, v156
    v_permlane16_swap_b32 v153, v157
    v_permlane16_swap_b32 v154, v158
    v_permlane16_swap_b32 v155, v159
    s_nop 1
    v_add_f32 v152, v152, v156
    v_add_f32 v153, v153, v157
    v_add_f32 v154, v154, v158
    v_add_f32 v155, v155, v159
    v_mov_b32 v156, v152
    v_mov_b32 v157, v153
    v_mov_b32 v158, v154
    v_mov_b32 v159, v155
    s_nop 1
    v_permlane32_swap_b32 v152, v156
    v_permlane32_swap_b32 v153, v157
    v_permlane32_swap_b32 v154, v158
    v_permlane32_swap_b32 v155, v159
    s_nop 1
    v_add_f32 v152, v152, v156
    v_add_f32 v153, v153, v157
    v_add_f32 v154, v154, v158
    v_add_f32 v155, v155, v159
    v_lshlrev_b32 v4, 4, v1
    s_lshl_b32 s97, s3, 8
    v_add_u32 v4, s97, v4
    v_cmp_gt_u32 vcc, 16, v1
    s_and_saveexec_b64 s[4:5], vcc
    s_cbranch_execz L_m_85
    ds_write_b128 v4, v[152:155] offset:2048
L_m_85:
    s_mov_b64 exec, s[4:5]
    s_waitcnt lgkmcnt(0)
    v_lshrrev_b32 v4, 4, v0
    v_add_u32 v5, 32, v4
    v_min_u32 v5, 47, v5
    v_and_b32 v3, 15, v0
    v_lshlrev_b32 v3, 4, v3
    s_lshl_b32 s97, s93, 8
    s_add_u32 s97, s97, 720896
    v_add_u32 v3, s97, v3
    v_mul_u32_u24 v4, 2560, v4
    v_add_u32 v4, v4, v3
    v_mul_u32_u24 v5, 2560, v5
    v_add_u32 v5, v5, v3
    s_mov_b32 s63, 0
L_spin_86:
    global_load_dwordx4 v[152:155], v4, s[42:43] sc1
    global_load_dwordx4 v[156:159], v5, s[42:43] sc1
    s_waitcnt vmcnt(0)
    v_max_u32 v6, v152, v153
    v_max3_u32 v6, v6, v154, v155
    v_max3_u32 v6, v6, v156, v157
    v_max3_u32 v6, v6, v158, v159
    v_cmp_eq_u32 vcc, -1, v6
    s_nop 1
    s_cbranch_vccz L_spun_87
    s_add_u32 s63, s63, 1
    s_cmp_ge_u32 s63, 65536
    s_cbranch_scc1 L_spun_87
    s_branch L_spin_86
L_spun_87:
    s_cmp_ge_u32 s3, 4
    s_cbranch_scc1 L_sk_88
    v_add_f32 v152, v152, v156
    v_add_f32 v153, v153, v157
    v_add_f32 v154, v154, v158
    v_add_f32 v155, v155, v159
L_sk_88:
    v_mov_b32 v156, v152
    v_mov_b32 v157, v153
    v_mov_b32 v158, v154
    v_mov_b32 v159, v155
    s_nop 1
    v_permlane16_swap_b32 v152, v156
    v_permlane16_swap_b32 v153, v157
    v_permlane16_swap_b32 v154, v158
    v_permlane16_swap_b32 v155, v159
    s_nop 1
    v_add_f32 v152, v152, v156
    v_add_f32 v153, v153, v157
    v_add_f32 v154, v154, v158
    v_add_f32 v155, v155, v159
    v_mov_b32 v156, v152
    v_mov_b32 v157, v153
    v_mov_b32 v158, v154
    v_mov_b32 v159, v155
    s_nop 1
    v_permlane32_swap_b32 v152, v156
    v_permlane32_swap_b32 v153, v157
    v_permlane32_swap_b32 v154, v158
    v_permlane32_swap_b32 v155, v159
    s_nop 1
    v_add_f32 v152, v152, v156
    v_add_f32 v153, v153, v157
    v_add_f32 v154, v154, v158
    v_add_f32 v155, v155, v159
    v_lshlrev_b32 v4, 4, v1
    s_lshl_b32 s97, s3, 8
    v_add_u32 v4, s97, v4
    v_cmp_gt_u32 vcc, 16, v1
    s_and_saveexec_b64 s[4:5], vcc
    s_cbranch_execz L_m_89
    ds_write_b128 v4, v[152:155] offset:0
L_m_89:
    s_mov_b64 exec, s[4:5]
    s_waitcnt lgkmcnt(0)
    s_barrier
    s_cmp_lg_u32 s3, 0
    s_cbranch_scc1 L_nw0_90
    v_lshlrev_b32 v3, 2, v1
    ds_read_b32 v152, v3 offset:0
    ds_read_b32 v153, v3 offset:256
    ds_read_b32 v154, v3 offset:512
    ds_read_b32 v155, v3 offset:768
    ds_read_b32 v156, v3 offset:1024
    ds_read_b32 v157, v3 offset:1280
    ds_read_b32 v158, v3 offset:1536
    ds_read_b32 v159, v3 offset:1792
    ds_read_b32 v160, v3 offset:2048
    ds_read_b32 v161, v3 offset:2304
    ds_read_b32 v162, v3 offset:2560
    ds_read_b32 v163, v3 offset:2816
    s_waitcnt lgkmcnt(0)
    v_add_f32 v152, v152, v156
    v_add_f32 v153, v153, v157
    v_add_f32 v154, v154, v158
    v_add_f32 v155, v155, v159
    v_add_f32 v152, v152, v154
    v_add_f32 v153, v153, v155
    v_add_f32 v152, v152, v153
    v_add_f32 v160, v160, v162
    v_add_f32 v161, v161, v163
    v_add_f32 v160, v160, v161
    v_cvt_pk_bf16_f32 v160, v160, v160
    v_and_b32 v160, 0xffff0000, v160
    v_mul_f32 v160, v160, v207
    v_cvt_pk_bf16_f32 v160, v160, v160
    v_and_b32 v160, 0xffff0000, v160
    v_add_f32 v160, v160, v165
    v_cvt_pk_bf16_f32 v160, v160, v160
    v_and_b32 v160, 0xffff0000, v160
    v_cvt_pk_bf16_f32 v152, v152, v152
    v_and_b32 v152, 0xffff0000, v152
    v_mul_f32 v152, v152, v206
    v_cvt_pk_bf16_f32 v152, v152, v152
    v_and_b32 v152, 0xffff0000, v152
    v_add_f32 v152, v152, v160
    v_cvt_pk_bf16_f32 v152, v152, v152
    s_lshl_b32 s97, s93, 7
    v_lshl_add_u32 v3, v1, 1, s97
    global_store_short v3, v152, s[38:39]
    s_cmp_lg_u32 s93, 0
    s_cbranch_scc1 L_ep_91
    v_mov_b32 v3, 688128
    v_mov_b32 v4, s101
    v_cmp_eq_u32 vcc, 0, v1
    s_and_saveexec_b64 s[4:5], vcc
    s_cbranch_execz L_m_92
    global_store_dword v3, v4, s[42:43] sc1
L_m_92:
    s_mov_b64 exec, s[4:5]
L_ep_91:
L_nw0_90:
L_done:
L_exit:
    s_endpgm
L_code_end:
.section .rodata,"a"
.p2align 6
.amdhsa_kernel adaLN_cond__mha_block_cached__swiglu_ffn__decode_kernel
  .amdhsa_next_free_vgpr 256
  .amdhsa_next_free_sgpr 102
  .amdhsa_accum_offset 256
  .amdhsa_group_segment_fixed_size 0
  .amdhsa_kernarg_size 112
  .amdhsa_user_sgpr_count 2
  .amdhsa_user_sgpr_kernarg_segment_ptr 1
  .amdhsa_system_sgpr_workgroup_id_x 1
  .amdhsa_float_denorm_mode_32 3
.end_amdhsa_kernel
```
